```python
import torch

def _softmax(x, axis=-1):
    return torch.softmax(x, dim=axis)
def _gelu(x):
    return torch.nn.functional.gelu(x, approximate="tanh")
def _silu(x):
    return torch.nn.functional.silu(x)
def _sigmoid(x):
    return torch.sigmoid(x)
def _layernorm(x, axis=-1, eps=1e-5):
    m = x.mean(dim=axis, keepdim=True)
    v = x.var(dim=axis, keepdim=True, unbiased=False)
    return (x - m) / torch.sqrt(v + eps)
def _scatter_add(tgt, idx, src, axis=0):
    return tgt.clone().index_add_(axis, idx, src)
def _segment_sum(src, seg, n):
    out = torch.zeros((n,) + src.shape[1:], dtype=src.dtype)
    return out.index_add_(0, seg, src)
def _pad(x, pw):
    flat = tuple(v for pair in reversed(pw) for v in pair)
    return torch.nn.functional.pad(x, flat)

kernel_name = 'concat_heads__gqa_block_cached__gqa_block_cached__near_ridge'

def setup_inputs():

    _w = (lambda a: (lambda t: t.to(torch.bfloat16) if t.is_floating_point() else t)(torch.as_tensor(a)))
    def _A_setup():
        B, Sq, D = 16, 48, 640
        Hq, Hkv, Sk, Dh = 32, 32, 48, 192
        assert Hq % Hkv == 0, (Hq, Hkv)
        return {
            "x": _w((lambda *s: torch.randn(*s, dtype=torch.bfloat16) * 0.8)(B, Sq, D)),
            "k_cache": _w((lambda *s: torch.randn(*s, dtype=torch.bfloat16) * 0.8)(B, Hkv, Sk, Dh)),
            "v_cache": _w((lambda *s: torch.randn(*s, dtype=torch.bfloat16) * 0.05)(B, Hkv, Sk, Dh)),
            "wq": _w((lambda *s: torch.randn(*s, dtype=torch.bfloat16) * 0.8)(D, Hq * Dh) * (D ** -0.5)),
            "wo": _w((lambda *s: torch.randn(*s, dtype=torch.bfloat16) * 0.05)(Hq * Dh, D) * ((Hq * Dh) ** -0.5)),
        }
    _A_in = _A_setup()

    def _B_setup():
        B, Sq, D = 16, 48, 640
        Hq, Hkv, Sk, Dh = 32, 32, 48, 192
        assert Hq % Hkv == 0, (Hq, Hkv)
        return {
            "x": _w((lambda *s: torch.randn(*s, dtype=torch.bfloat16) * 0.8)(B, Sq, D)),
            "k_cache": _w((lambda *s: torch.randn(*s, dtype=torch.bfloat16) * 0.8)(B, Hkv, Sk, Dh)),
            "v_cache": _w((lambda *s: torch.randn(*s, dtype=torch.bfloat16) * 0.05)(B, Hkv, Sk, Dh)),
            "wq": _w((lambda *s: torch.randn(*s, dtype=torch.bfloat16) * 0.8)(D, Hq * Dh) * (D ** -0.5)),
            "wo": _w((lambda *s: torch.randn(*s, dtype=torch.bfloat16) * 0.05)(Hq * Dh, D) * ((Hq * Dh) ** -0.5)),
        }
    _B_in = _B_setup()

    return {
        "A_x": _A_in["x"],
        "A_k_cache": _A_in["k_cache"],
        "A_v_cache": _A_in["v_cache"],
        "A_wq": _A_in["wq"],
        "A_wo": _A_in["wo"],
        "B_x": _B_in["x"],
        "B_k_cache": _B_in["k_cache"],
        "B_v_cache": _B_in["v_cache"],
        "B_wq": _B_in["wq"],
        "B_wo": _B_in["wo"],
    }

def reference(A_x, A_k_cache, A_v_cache, A_wq, A_wo, B_x, B_k_cache, B_v_cache, B_wq, B_wo):
    def _A_ref(x, k_cache, v_cache, wq, wo):
        B, Sq, D = x.shape
        Hq, Dh = 32, 192
        Hkv = k_cache.shape[1]
        rep = Hq // Hkv
        q = (lambda x, *d: x.permute(*d))((x @ wq).reshape(B, Sq, Hq, Dh), 0, 2, 1, 3)
        k = (lambda x, n, axis: torch.repeat_interleave(x, n, dim=axis))(k_cache, rep, axis=1)
        v = (lambda x, n, axis: torch.repeat_interleave(x, n, dim=axis))(v_cache, rep, axis=1)
        scores = torch.einsum("bhqd,bhkd->bhqk", q, k) * (Dh ** -0.5)
        p = _softmax(scores, axis=-1)
        o = torch.einsum("bhqk,bhkd->bhqd", p, v)
        return (lambda x, *d: x.permute(*d))(o, 0, 2, 1, 3).reshape(B, Sq, Hq * Dh) @ wo

    def _B_ref(x, k_cache, v_cache, wq, wo):
        B, Sq, D = x.shape
        Hq, Dh = 32, 192
        Hkv = k_cache.shape[1]
        rep = Hq // Hkv
        q = (lambda x, *d: x.permute(*d))((x @ wq).reshape(B, Sq, Hq, Dh), 0, 2, 1, 3)
        k = (lambda x, n, axis: torch.repeat_interleave(x, n, dim=axis))(k_cache, rep, axis=1)
        v = (lambda x, n, axis: torch.repeat_interleave(x, n, dim=axis))(v_cache, rep, axis=1)
        scores = torch.einsum("bhqd,bhkd->bhqk", q, k) * (Dh ** -0.5)
        p = _softmax(scores, axis=-1)
        o = torch.einsum("bhqk,bhkd->bhqd", p, v)
        return (lambda x, *d: x.permute(*d))(o, 0, 2, 1, 3).reshape(B, Sq, Hq * Dh) @ wo

    a = _A_ref(A_x, A_k_cache, A_v_cache, A_wq, A_wo)
    b = _B_ref(B_x, B_k_cache, B_v_cache, B_wq, B_wo)
    return torch.concatenate([a, b], axis=-1)
```

```asm
; @launch grid=(256,1,1) block=(512,1,1) lds=163840
.amdgcn_target "amdgcn-amd-amdhsa--gfx950"
.text
.globl concat_heads__gqa_block_cached__gqa_block_cached__near_ridge_kernel
.p2align 8
.type concat_heads__gqa_block_cached__gqa_block_cached__near_ridge_kernel,@function
concat_heads__gqa_block_cached__gqa_block_cached__near_ridge_kernel:
  s_cmp_ge_u32 s2, 0x100
  s_cbranch_scc1 L_end
  s_load_dwordx16 s[8:23], s[0:1], 0x0
  s_load_dwordx8 s[24:31], s[0:1], 0x40
  s_load_dwordx2 s[32:33], s[0:1], 0x60
  s_bfe_u32 s42, s2, 0x40003
  s_mul_i32 s42, s42, 24
  v_add_u32 v3, s42, v0
  v_cmp_gt_u32 vcc, 24, v0
  s_and_saveexec_b64 s[4:5], vcc
  s_cbranch_execz L_nopf
  v_lshlrev_b32 v2, 7, v3
  s_getpc_b64 s[90:91]
L_pc1:
  s_sub_u32 s88, s90, (L_pc1 - concat_heads__gqa_block_cached__gqa_block_cached__near_ridge_kernel)
  s_subb_u32 s89, s91, 0
  s_mov_b32 s90, (L_code_end - concat_heads__gqa_block_cached__gqa_block_cached__near_ridge_kernel)
  s_mov_b32 s91, 0x20000
  s_mov_b32 s93, 0
  buffer_load_dword v255, v2, s[88:91], s93 offen
L_nopf:
  s_mov_b64 exec, s[4:5]
  v_lshrrev_b32 v2, 6, v0
  v_and_b32 v1, 63, v0
  v_readfirstlane_b32 s37, v2
  s_and_b32 s42, s2, 7
  s_lshr_b32 s43, s2, 3
  s_lshr_b32 s34, s42, 2
  s_and_b32 s42, s42, 3
  s_lshl_b32 s42, s42, 3
  s_and_b32 s35, s43, 7
  s_lshr_b32 s36, s43, 3
  s_add_u32 s35, s35, s42
  s_lshr_b32 s38, s35, 2
  s_and_b32 s41, s35, 3
  s_and_b32 s40, s41, 1
  s_lshl_b32 s39, s36, 1
  s_lshr_b32 s42, s41, 1
  s_add_u32 s39, s39, s42
  s_cmp_ge_u32 s37, 4
  s_cbranch_scc1 L_loader
L_compute:
  s_waitcnt lgkmcnt(0)
  s_add_u32 s52, s32, 0
  s_addc_u32 s53, s33, 0
  s_mov_b32 s54, 0x200c000
  s_mov_b32 s55, 0x20000
  s_lshl_b32 s59, s34, 2
  s_add_u32 s59, s59, s36
  s_lshl_b32 s59, s59, 3
  s_add_u32 s59, s59, s38
  s_lshl_b32 s59, s59, 8
  s_lshr_b32 s42, s37, 1
  s_lshl_b32 s42, s42, 7
  s_add_u32 s59, s59, s42
  s_and_b32 s42, s37, 1
  s_lshl_b32 s42, s42, 2
  s_add_u32 s59, s59, s42
  s_lshl_b32 s42, s41, 3
  s_add_u32 s59, s59, s42
  s_add_u32 s59, s59, 0x2000000
  s_lshl_b32 s60, s34, 3
  s_add_u32 s60, s60, s39
  s_lshl_b32 s60, s60, 1
  s_add_u32 s60, s60, s40
  s_lshl_b32 s60, s60, 2
  s_add_u32 s60, s60, s37
  s_lshl_b32 s60, s60, 7
  s_lshl_b32 s42, s38, 2
  s_add_u32 s60, s60, s42
  s_add_u32 s60, s60, 0x2004000
  s_cmp_lg_u32 s37, 0
  s_cbranch_scc1 L_noclear
  v_bfe_u32 v19, v1, 1, 1
  v_lshlrev_b32 v19, 7, v19
  v_and_b32 v20, 1, v1
  v_lshl_add_u32 v19, v20, 2, v19
  v_add_u32 v19, s59, v19
  v_and_b32 v20, 3, v1
  v_lshlrev_b32 v20, 7, v20
  v_add_u32 v20, s60, v20
  v_bfe_u32 v21, v1, 3, 1
  v_lshl_add_u32 v20, v21, 14, v20
  v_cmp_gt_u32 vcc, 4, v1
  s_nop 1
  v_cndmask_b32 v19, v20, v19, vcc
  v_mov_b32 v20, 0
  s_mov_b64 exec, 4095
  buffer_store_dword v20, v19, s[52:55], 0 offen sc1
  s_mov_b64 exec, -1
L_noclear:
  s_mul_i32 s56, s37, 0x1800
  v_lshrrev_b32 v19, 4, v1
  v_mul_u32_u24 v20, 0xc00, v19
  v_bfe_u32 v21, v1, 2, 2
  v_lshl_add_u32 v20, v21, 7, v20
  v_and_b32 v22, 3, v1
  v_lshl_add_u32 v20, v22, 3, v20
  v_lshrrev_b32 v21, 1, v21
  v_and_b32 v22, 1, v19
  v_lshl_or_b32 v21, v22, 1, v21
  v_xor_b32 v22, 0, v21
  v_lshl_add_u32 v2, v22, 5, v20
  v_xor_b32 v22, 1, v21
  v_lshl_add_u32 v3, v22, 5, v20
  v_xor_b32 v22, 2, v21
  v_lshl_add_u32 v4, v22, 5, v20
  v_xor_b32 v22, 3, v21
  v_lshl_add_u32 v5, v22, 5, v20
  v_and_b32 v20, 15, v1
  v_lshrrev_b32 v21, 1, v20
  v_xor_b32 v21, v21, v19
  v_lshlrev_b32 v20, 7, v20
  v_add_u32 v20, s56, v20
  v_xor_b32 v22, 0, v21
  v_lshl_add_u32 v6, v22, 4, v20
  v_add_u32 v6, 0x6000, v6
  v_xor_b32 v22, 4, v21
  v_lshl_add_u32 v7, v22, 4, v20
  v_add_u32 v7, 0x6000, v7
  s_add_u32 s42, s56, 0xc000
  v_and_b32 v20, 15, v1
  v_lshrrev_b32 v21, 1, v20
  v_lshrrev_b32 v22, 1, v19
  v_xor_b32 v21, v21, v22
  v_lshlrev_b32 v20, 7, v20
  v_and_b32 v22, 1, v19
  v_lshl_add_u32 v20, v22, 3, v20
  v_add_u32 v20, s42, v20
  v_xor_b32 v22, 0, v21
  v_lshl_add_u32 v8, v22, 4, v20
  v_xor_b32 v22, 2, v21
  v_lshl_add_u32 v9, v22, 4, v20
  v_xor_b32 v22, 4, v21
  v_lshl_add_u32 v10, v22, 4, v20
  v_xor_b32 v22, 6, v21
  v_lshl_add_u32 v11, v22, 4, v20
  v_lshlrev_b32 v12, 4, v1
  v_lshlrev_b32 v13, 3, v1
  s_mov_b32 s57, 0x3dd53b95
  s_lshl_b32 s42, s34, 3
  s_lshl_b32 s43, s36, 1
  s_add_u32 s42, s42, s43
  s_lshr_b32 s43, s37, 1
  s_add_u32 s42, s42, s43
  s_lshl_b32 s42, s42, 5
  s_add_u32 s42, s42, s35
  s_mul_i32 s42, s42, 0x2400
  s_and_b32 s43, s37, 1
  s_lshl_b32 s64, s43, 12
  s_lshl_b32 s58, s43, 9
  s_add_u32 s58, s58, 0x2000
  s_add_u32 s48, s32, s42
  s_addc_u32 s49, s33, 0
  s_mov_b32 s50, 0x2400
  s_mov_b32 s51, 0x20000
  s_lshr_b32 s62, s37, 1
  s_and_b32 s63, s37, 1
  v_bfe_u32 v15, v1, 2, 3
  v_lshrrev_b32 v16, 1, v15
  v_lshlrev_b32 v15, 7, v15
  v_and_b32 v17, 3, v1
  v_lshl_add_u32 v15, v17, 3, v15
  v_lshrrev_b32 v17, 5, v1
  v_mul_u32_u24 v14, 0x1400, v17
  v_add_u32 v14, v14, v15
  s_lshl_b32 s42, s62, 1
  s_add_u32 s43, s42, 0
  v_xor_b32 v18, s43, v16
  v_lshl_add_u32 v240, v18, 5, v14
  v_add_u32 v240, 0x1e000, v240
  s_add_u32 s43, s42, 1
  v_xor_b32 v18, s43, v16
  v_lshl_add_u32 v241, v18, 5, v14
  v_add_u32 v241, 0x1e000, v241
  v_lshl_add_u32 v15, v17, 10, v15
  s_mul_i32 s43, s63, 0x1800
  s_add_u32 s43, s43, 0x25000
  v_add_u32 v15, s43, v15
  v_xor_b32 v18, 0, v16
  v_lshl_add_u32 v242, v18, 5, v15
  v_xor_b32 v18, 1, v16
  v_lshl_add_u32 v243, v18, 5, v15
  v_xor_b32 v18, 2, v16
  v_lshl_add_u32 v244, v18, 5, v15
  v_xor_b32 v18, 3, v16
  v_lshl_add_u32 v245, v18, 5, v15
  s_lshl_b32 s42, s63, 12
  s_add_u32 s42, s42, 0x1a000
  v_add_u32 v246, s42, v12
  s_lshl_b32 s42, s63, 9
  s_add_u32 s42, s42, 0x1c000
  v_add_u32 v247, s42, v13
  v_and_b32 v18, 15, v1
  v_lshlrev_b32 v14, 7, v18
  v_add_u32 v14, s43, v14
  v_lshrrev_b32 v15, 4, v1
  v_lshl_add_u32 v14, v15, 3, v14
  v_bfe_u32 v18, v18, 1, 2
  v_xor_b32 v15, 0, v18
  v_lshl_add_u32 v248, v15, 5, v14
  v_xor_b32 v15, 1, v18
  v_lshl_add_u32 v249, v15, 5, v14
  v_xor_b32 v15, 2, v18
  v_lshl_add_u32 v250, v15, 5, v14
  v_xor_b32 v15, 3, v18
  v_lshl_add_u32 v251, v15, 5, v14
  s_lshl_b32 s42, s34, 3
  s_add_u32 s42, s42, s39
  s_lshl_b32 s42, s42, 1
  s_add_u32 s42, s42, s40
  s_lshl_b32 s42, s42, 2
  s_add_u32 s42, s42, s37
  s_mul_i32 s42, s42, 0x1e000
  s_lshl_b32 s43, s38, 10
  s_add_u32 s42, s42, s43
  s_add_u32 s42, s42, 0x800000
  s_add_u32 s68, s32, s42
  s_addc_u32 s69, s33, 0
  s_mov_b32 s70, 0x1c400
  s_mov_b32 s71, 0x20000
  s_mov_b32 s90, s57
  s_waitcnt vmcnt(0)
  s_barrier
  ds_read_b64_tr_b16 v[168:169], v2
  ds_read_b64_tr_b16 v[170:171], v2 offset:512
  ds_read_b128 v[216:219], v6
  ds_read_b128 v[220:223], v6 offset:2048
  ds_read_b128 v[224:227], v6 offset:4096
  ds_read_b64_tr_b16 v[172:173], v3
  ds_read_b64_tr_b16 v[174:175], v3 offset:512
  ds_read_b64_tr_b16 v[176:177], v4
  ds_read_b64_tr_b16 v[178:179], v4 offset:512
  ds_read_b64_tr_b16 v[180:181], v5
  ds_read_b64_tr_b16 v[182:183], v5 offset:512
  ds_read_b64_tr_b16 v[184:185], v2 offset:1024
  ds_read_b64_tr_b16 v[186:187], v2 offset:1536
  ds_read_b64_tr_b16 v[188:189], v3 offset:1024
  ds_read_b64_tr_b16 v[190:191], v3 offset:1536
  s_waitcnt lgkmcnt(12)
  v_mfma_f32_16x16x32_bf16 v[24:27], v[168:171], v[216:219], 0
  ds_read_b64_tr_b16 v[192:193], v4 offset:1024
  s_waitcnt lgkmcnt(12)
  v_mfma_f32_16x16x32_bf16 v[72:75], v[168:171], v[220:223], 0
  ds_read_b64_tr_b16 v[194:195], v4 offset:1536
  s_waitcnt lgkmcnt(12)
  v_mfma_f32_16x16x32_bf16 v[120:123], v[168:171], v[224:227], 0
  ds_read_b64_tr_b16 v[196:197], v5 offset:1024
  s_waitcnt lgkmcnt(11)
  v_mfma_f32_16x16x32_bf16 v[28:31], v[172:175], v[216:219], 0
  ds_read_b64_tr_b16 v[198:199], v5 offset:1536
  v_mfma_f32_16x16x32_bf16 v[76:79], v[172:175], v[220:223], 0
  ds_read_b64_tr_b16 v[200:201], v2 offset:2048
  v_mfma_f32_16x16x32_bf16 v[124:127], v[172:175], v[224:227], 0
  ds_read_b64_tr_b16 v[202:203], v2 offset:2560
  s_waitcnt lgkmcnt(12)
  v_mfma_f32_16x16x32_bf16 v[32:35], v[176:179], v[216:219], 0
  ds_read_b64_tr_b16 v[204:205], v3 offset:2048
  v_mfma_f32_16x16x32_bf16 v[80:83], v[176:179], v[220:223], 0
  ds_read_b64_tr_b16 v[206:207], v3 offset:2560
  v_mfma_f32_16x16x32_bf16 v[128:131], v[176:179], v[224:227], 0
  ds_read_b64_tr_b16 v[208:209], v4 offset:2048
  s_waitcnt lgkmcnt(13)
  v_mfma_f32_16x16x32_bf16 v[36:39], v[180:183], v[216:219], 0
  ds_read_b64_tr_b16 v[210:211], v4 offset:2560
  v_mfma_f32_16x16x32_bf16 v[84:87], v[180:183], v[220:223], 0
  ds_read_b64_tr_b16 v[212:213], v5 offset:2048
  v_mfma_f32_16x16x32_bf16 v[132:135], v[180:183], v[224:227], 0
  ds_read_b64_tr_b16 v[214:215], v5 offset:2560
  s_waitcnt lgkmcnt(14)
  v_mfma_f32_16x16x32_bf16 v[40:43], v[184:187], v[216:219], 0
  v_mfma_f32_16x16x32_bf16 v[88:91], v[184:187], v[220:223], 0
  v_mfma_f32_16x16x32_bf16 v[136:139], v[184:187], v[224:227], 0
  s_waitcnt lgkmcnt(12)
  v_mfma_f32_16x16x32_bf16 v[44:47], v[188:191], v[216:219], 0
  v_mfma_f32_16x16x32_bf16 v[92:95], v[188:191], v[220:223], 0
  v_mfma_f32_16x16x32_bf16 v[140:143], v[188:191], v[224:227], 0
  s_waitcnt lgkmcnt(10)
  v_mfma_f32_16x16x32_bf16 v[48:51], v[192:195], v[216:219], 0
  ds_read_b64_tr_b16 v[168:169], v2 offset:12288
  v_mfma_f32_16x16x32_bf16 v[96:99], v[192:195], v[220:223], 0
  ds_read_b64_tr_b16 v[170:171], v2 offset:12800
  v_mfma_f32_16x16x32_bf16 v[144:147], v[192:195], v[224:227], 0
  ds_read_b128 v[228:231], v7
  s_waitcnt lgkmcnt(11)
  v_mfma_f32_16x16x32_bf16 v[52:55], v[196:199], v[216:219], 0
  ds_read_b128 v[232:235], v7 offset:2048
  v_mfma_f32_16x16x32_bf16 v[100:103], v[196:199], v[220:223], 0
  ds_read_b128 v[236:239], v7 offset:4096
  v_mfma_f32_16x16x32_bf16 v[148:151], v[196:199], v[224:227], 0
  ds_read_b64_tr_b16 v[172:173], v3 offset:12288
  s_waitcnt lgkmcnt(12)
  v_mfma_f32_16x16x32_bf16 v[56:59], v[200:203], v[216:219], 0
  ds_read_b64_tr_b16 v[174:175], v3 offset:12800
  v_mfma_f32_16x16x32_bf16 v[104:107], v[200:203], v[220:223], 0
  ds_read_b64_tr_b16 v[176:177], v4 offset:12288
  v_mfma_f32_16x16x32_bf16 v[152:155], v[200:203], v[224:227], 0
  ds_read_b64_tr_b16 v[178:179], v4 offset:12800
  s_waitcnt lgkmcnt(13)
  v_mfma_f32_16x16x32_bf16 v[60:63], v[204:207], v[216:219], 0
  ds_read_b64_tr_b16 v[180:181], v5 offset:12288
  v_mfma_f32_16x16x32_bf16 v[108:111], v[204:207], v[220:223], 0
  ds_read_b64_tr_b16 v[182:183], v5 offset:12800
  v_mfma_f32_16x16x32_bf16 v[156:159], v[204:207], v[224:227], 0
  ds_read_b64_tr_b16 v[184:185], v2 offset:13312
  s_waitcnt lgkmcnt(14)
  v_mfma_f32_16x16x32_bf16 v[64:67], v[208:211], v[216:219], 0
  ds_read_b64_tr_b16 v[186:187], v2 offset:13824
  v_mfma_f32_16x16x32_bf16 v[112:115], v[208:211], v[220:223], 0
  ds_read_b64_tr_b16 v[188:189], v3 offset:13312
  v_mfma_f32_16x16x32_bf16 v[160:163], v[208:211], v[224:227], 0
  ds_read_b64_tr_b16 v[190:191], v3 offset:13824
  s_waitcnt lgkmcnt(15)
  v_mfma_f32_16x16x32_bf16 v[68:71], v[212:215], v[216:219], 0
  v_mfma_f32_16x16x32_bf16 v[116:119], v[212:215], v[220:223], 0
  v_mfma_f32_16x16x32_bf16 v[164:167], v[212:215], v[224:227], 0
  s_waitcnt lgkmcnt(12)
  v_mfma_f32_16x16x32_bf16 v[24:27], v[168:171], v[228:231], v[24:27]
  ds_read_b64_tr_b16 v[192:193], v4 offset:13312
  ds_read_b64_tr_b16 v[194:195], v4 offset:13824
  s_waitcnt lgkmcnt(13)
  v_mfma_f32_16x16x32_bf16 v[72:75], v[168:171], v[232:235], v[72:75]
  ds_read_b64_tr_b16 v[196:197], v5 offset:13312
  s_waitcnt lgkmcnt(13)
  v_mfma_f32_16x16x32_bf16 v[120:123], v[168:171], v[236:239], v[120:123]
  ds_read_b64_tr_b16 v[198:199], v5 offset:13824
  ds_read_b64_tr_b16 v[200:201], v2 offset:14336
  s_waitcnt lgkmcnt(13)
  v_mfma_f32_16x16x32_bf16 v[28:31], v[172:175], v[228:231], v[28:31]
  ds_read_b64_tr_b16 v[202:203], v2 offset:14848
  v_mfma_f32_16x16x32_bf16 v[76:79], v[172:175], v[232:235], v[76:79]
  ds_read_b64_tr_b16 v[204:205], v3 offset:14336
  ds_read_b64_tr_b16 v[206:207], v3 offset:14848
  v_mfma_f32_16x16x32_bf16 v[124:127], v[172:175], v[236:239], v[124:127]
  ds_read_b64_tr_b16 v[208:209], v4 offset:14336
  s_waitcnt lgkmcnt(15)
  v_mfma_f32_16x16x32_bf16 v[32:35], v[176:179], v[228:231], v[32:35]
  ds_read_b64_tr_b16 v[210:211], v4 offset:14848
  ds_read_b64_tr_b16 v[212:213], v5 offset:14336
  v_mfma_f32_16x16x32_bf16 v[80:83], v[176:179], v[232:235], v[80:83]
  ds_read_b64_tr_b16 v[214:215], v5 offset:14848
  v_mfma_f32_16x16x32_bf16 v[128:131], v[176:179], v[236:239], v[128:131]
  s_waitcnt lgkmcnt(15)
  v_mfma_f32_16x16x32_bf16 v[36:39], v[180:183], v[228:231], v[36:39]
  v_mfma_f32_16x16x32_bf16 v[84:87], v[180:183], v[232:235], v[84:87]
  v_add_u32 v2, 0xc000, v2
  v_mfma_f32_16x16x32_bf16 v[132:135], v[180:183], v[236:239], v[132:135]
  v_add_u32 v3, 0xc000, v3
  s_waitcnt lgkmcnt(14)
  v_mfma_f32_16x16x32_bf16 v[40:43], v[184:187], v[228:231], v[40:43]
  v_add_u32 v4, 0xc000, v4
  v_mfma_f32_16x16x32_bf16 v[88:91], v[184:187], v[232:235], v[88:91]
  v_add_u32 v5, 0xc000, v5
  v_mfma_f32_16x16x32_bf16 v[136:139], v[184:187], v[236:239], v[136:139]
  v_add_u32 v6, 0xc000, v6
  s_waitcnt lgkmcnt(12)
  v_mfma_f32_16x16x32_bf16 v[44:47], v[188:191], v[228:231], v[44:47]
  v_add_u32 v7, 0xc000, v7
  v_mfma_f32_16x16x32_bf16 v[92:95], v[188:191], v[232:235], v[92:95]
  v_mfma_f32_16x16x32_bf16 v[140:143], v[188:191], v[236:239], v[140:143]
  s_waitcnt lgkmcnt(0)
  s_barrier
  v_mfma_f32_16x16x32_bf16 v[48:51], v[192:195], v[228:231], v[48:51]
  ds_read_b64_tr_b16 v[168:169], v2
  v_mfma_f32_16x16x32_bf16 v[96:99], v[192:195], v[232:235], v[96:99]
  ds_read_b64_tr_b16 v[170:171], v2 offset:512
  v_mfma_f32_16x16x32_bf16 v[144:147], v[192:195], v[236:239], v[144:147]
  ds_read_b128 v[216:219], v6
  v_mfma_f32_16x16x32_bf16 v[52:55], v[196:199], v[228:231], v[52:55]
  ds_read_b128 v[220:223], v6 offset:2048
  v_mfma_f32_16x16x32_bf16 v[100:103], v[196:199], v[232:235], v[100:103]
  ds_read_b128 v[224:227], v6 offset:4096
  v_mfma_f32_16x16x32_bf16 v[148:151], v[196:199], v[236:239], v[148:151]
  ds_read_b64_tr_b16 v[172:173], v3
  v_mfma_f32_16x16x32_bf16 v[56:59], v[200:203], v[228:231], v[56:59]
  ds_read_b64_tr_b16 v[174:175], v3 offset:512
  v_mfma_f32_16x16x32_bf16 v[104:107], v[200:203], v[232:235], v[104:107]
  ds_read_b64_tr_b16 v[176:177], v4
  v_mfma_f32_16x16x32_bf16 v[152:155], v[200:203], v[236:239], v[152:155]
  ds_read_b64_tr_b16 v[178:179], v4 offset:512
  v_mfma_f32_16x16x32_bf16 v[60:63], v[204:207], v[228:231], v[60:63]
  ds_read_b64_tr_b16 v[180:181], v5
  v_mfma_f32_16x16x32_bf16 v[108:111], v[204:207], v[232:235], v[108:111]
  ds_read_b64_tr_b16 v[182:183], v5 offset:512
  v_mfma_f32_16x16x32_bf16 v[156:159], v[204:207], v[236:239], v[156:159]
  ds_read_b64_tr_b16 v[184:185], v2 offset:1024
  v_mfma_f32_16x16x32_bf16 v[64:67], v[208:211], v[228:231], v[64:67]
  ds_read_b64_tr_b16 v[186:187], v2 offset:1536
  v_mfma_f32_16x16x32_bf16 v[112:115], v[208:211], v[232:235], v[112:115]
  ds_read_b64_tr_b16 v[188:189], v3 offset:1024
  v_mfma_f32_16x16x32_bf16 v[160:163], v[208:211], v[236:239], v[160:163]
  ds_read_b64_tr_b16 v[190:191], v3 offset:1536
  v_mfma_f32_16x16x32_bf16 v[68:71], v[212:215], v[228:231], v[68:71]
  v_mfma_f32_16x16x32_bf16 v[116:119], v[212:215], v[232:235], v[116:119]
  v_mfma_f32_16x16x32_bf16 v[164:167], v[212:215], v[236:239], v[164:167]
  s_waitcnt lgkmcnt(12)
  v_mfma_f32_16x16x32_bf16 v[24:27], v[168:171], v[216:219], v[24:27]
  ds_read_b64_tr_b16 v[192:193], v4 offset:1024
  s_waitcnt lgkmcnt(12)
  v_mfma_f32_16x16x32_bf16 v[72:75], v[168:171], v[220:223], v[72:75]
  ds_read_b64_tr_b16 v[194:195], v4 offset:1536
  s_waitcnt lgkmcnt(12)
  v_mfma_f32_16x16x32_bf16 v[120:123], v[168:171], v[224:227], v[120:123]
  ds_read_b64_tr_b16 v[196:197], v5 offset:1024
  s_waitcnt lgkmcnt(11)
  v_mfma_f32_16x16x32_bf16 v[28:31], v[172:175], v[216:219], v[28:31]
  ds_read_b64_tr_b16 v[198:199], v5 offset:1536
  v_mfma_f32_16x16x32_bf16 v[76:79], v[172:175], v[220:223], v[76:79]
  ds_read_b64_tr_b16 v[200:201], v2 offset:2048
  v_mfma_f32_16x16x32_bf16 v[124:127], v[172:175], v[224:227], v[124:127]
  ds_read_b64_tr_b16 v[202:203], v2 offset:2560
  s_waitcnt lgkmcnt(12)
  v_mfma_f32_16x16x32_bf16 v[32:35], v[176:179], v[216:219], v[32:35]
  ds_read_b64_tr_b16 v[204:205], v3 offset:2048
  v_mfma_f32_16x16x32_bf16 v[80:83], v[176:179], v[220:223], v[80:83]
  ds_read_b64_tr_b16 v[206:207], v3 offset:2560
  v_mfma_f32_16x16x32_bf16 v[128:131], v[176:179], v[224:227], v[128:131]
  ds_read_b64_tr_b16 v[208:209], v4 offset:2048
  s_waitcnt lgkmcnt(13)
  v_mfma_f32_16x16x32_bf16 v[36:39], v[180:183], v[216:219], v[36:39]
  ds_read_b64_tr_b16 v[210:211], v4 offset:2560
  v_mfma_f32_16x16x32_bf16 v[84:87], v[180:183], v[220:223], v[84:87]
  ds_read_b64_tr_b16 v[212:213], v5 offset:2048
  v_mfma_f32_16x16x32_bf16 v[132:135], v[180:183], v[224:227], v[132:135]
  ds_read_b64_tr_b16 v[214:215], v5 offset:2560
  s_waitcnt lgkmcnt(14)
  v_mfma_f32_16x16x32_bf16 v[40:43], v[184:187], v[216:219], v[40:43]
  v_mfma_f32_16x16x32_bf16 v[88:91], v[184:187], v[220:223], v[88:91]
  v_mfma_f32_16x16x32_bf16 v[136:139], v[184:187], v[224:227], v[136:139]
  s_waitcnt lgkmcnt(12)
  v_mfma_f32_16x16x32_bf16 v[44:47], v[188:191], v[216:219], v[44:47]
  v_mfma_f32_16x16x32_bf16 v[92:95], v[188:191], v[220:223], v[92:95]
  v_mfma_f32_16x16x32_bf16 v[140:143], v[188:191], v[224:227], v[140:143]
  s_waitcnt lgkmcnt(10)
  v_mfma_f32_16x16x32_bf16 v[48:51], v[192:195], v[216:219], v[48:51]
  ds_read_b64_tr_b16 v[168:169], v2 offset:12288
  v_mfma_f32_16x16x32_bf16 v[96:99], v[192:195], v[220:223], v[96:99]
  ds_read_b64_tr_b16 v[170:171], v2 offset:12800
  v_mfma_f32_16x16x32_bf16 v[144:147], v[192:195], v[224:227], v[144:147]
  ds_read_b128 v[228:231], v7
  s_waitcnt lgkmcnt(11)
  v_mfma_f32_16x16x32_bf16 v[52:55], v[196:199], v[216:219], v[52:55]
  ds_read_b128 v[232:235], v7 offset:2048
  v_mfma_f32_16x16x32_bf16 v[100:103], v[196:199], v[220:223], v[100:103]
  ds_read_b128 v[236:239], v7 offset:4096
  v_mfma_f32_16x16x32_bf16 v[148:151], v[196:199], v[224:227], v[148:151]
  ds_read_b64_tr_b16 v[172:173], v3 offset:12288
  s_waitcnt lgkmcnt(12)
  v_mfma_f32_16x16x32_bf16 v[56:59], v[200:203], v[216:219], v[56:59]
  ds_read_b64_tr_b16 v[174:175], v3 offset:12800
  v_mfma_f32_16x16x32_bf16 v[104:107], v[200:203], v[220:223], v[104:107]
  ds_read_b64_tr_b16 v[176:177], v4 offset:12288
  v_mfma_f32_16x16x32_bf16 v[152:155], v[200:203], v[224:227], v[152:155]
  ds_read_b64_tr_b16 v[178:179], v4 offset:12800
  s_waitcnt lgkmcnt(13)
  v_mfma_f32_16x16x32_bf16 v[60:63], v[204:207], v[216:219], v[60:63]
  ds_read_b64_tr_b16 v[180:181], v5 offset:12288
  v_mfma_f32_16x16x32_bf16 v[108:111], v[204:207], v[220:223], v[108:111]
  ds_read_b64_tr_b16 v[182:183], v5 offset:12800
  v_mfma_f32_16x16x32_bf16 v[156:159], v[204:207], v[224:227], v[156:159]
  ds_read_b64_tr_b16 v[184:185], v2 offset:13312
  s_waitcnt lgkmcnt(14)
  v_mfma_f32_16x16x32_bf16 v[64:67], v[208:211], v[216:219], v[64:67]
  ds_read_b64_tr_b16 v[186:187], v2 offset:13824
  v_mfma_f32_16x16x32_bf16 v[112:115], v[208:211], v[220:223], v[112:115]
  ds_read_b64_tr_b16 v[188:189], v3 offset:13312
  v_mfma_f32_16x16x32_bf16 v[160:163], v[208:211], v[224:227], v[160:163]
  ds_read_b64_tr_b16 v[190:191], v3 offset:13824
  s_waitcnt lgkmcnt(15)
  v_mfma_f32_16x16x32_bf16 v[68:71], v[212:215], v[216:219], v[68:71]
  v_mfma_f32_16x16x32_bf16 v[116:119], v[212:215], v[220:223], v[116:119]
  v_mfma_f32_16x16x32_bf16 v[164:167], v[212:215], v[224:227], v[164:167]
  s_waitcnt lgkmcnt(12)
  v_mfma_f32_16x16x32_bf16 v[24:27], v[168:171], v[228:231], v[24:27]
  ds_read_b64_tr_b16 v[192:193], v4 offset:13312
  ds_read_b64_tr_b16 v[194:195], v4 offset:13824
  s_waitcnt lgkmcnt(13)
  v_mfma_f32_16x16x32_bf16 v[72:75], v[168:171], v[232:235], v[72:75]
  ds_read_b64_tr_b16 v[196:197], v5 offset:13312
  s_waitcnt lgkmcnt(13)
  v_mfma_f32_16x16x32_bf16 v[120:123], v[168:171], v[236:239], v[120:123]
  ds_read_b64_tr_b16 v[198:199], v5 offset:13824
  ds_read_b64_tr_b16 v[200:201], v2 offset:14336
  s_waitcnt lgkmcnt(13)
  v_mfma_f32_16x16x32_bf16 v[28:31], v[172:175], v[228:231], v[28:31]
  ds_read_b64_tr_b16 v[202:203], v2 offset:14848
  v_mfma_f32_16x16x32_bf16 v[76:79], v[172:175], v[232:235], v[76:79]
  ds_read_b64_tr_b16 v[204:205], v3 offset:14336
  ds_read_b64_tr_b16 v[206:207], v3 offset:14848
  v_mfma_f32_16x16x32_bf16 v[124:127], v[172:175], v[236:239], v[124:127]
  ds_read_b64_tr_b16 v[208:209], v4 offset:14336
  s_waitcnt lgkmcnt(15)
  v_mfma_f32_16x16x32_bf16 v[32:35], v[176:179], v[228:231], v[32:35]
  ds_read_b64_tr_b16 v[210:211], v4 offset:14848
  ds_read_b64_tr_b16 v[212:213], v5 offset:14336
  v_mfma_f32_16x16x32_bf16 v[80:83], v[176:179], v[232:235], v[80:83]
  ds_read_b64_tr_b16 v[214:215], v5 offset:14848
  v_mfma_f32_16x16x32_bf16 v[128:131], v[176:179], v[236:239], v[128:131]
  s_waitcnt lgkmcnt(15)
  v_mfma_f32_16x16x32_bf16 v[36:39], v[180:183], v[228:231], v[36:39]
  v_mfma_f32_16x16x32_bf16 v[84:87], v[180:183], v[232:235], v[84:87]
  v_add_u32 v2, 0xc000, v2
  v_mfma_f32_16x16x32_bf16 v[132:135], v[180:183], v[236:239], v[132:135]
  v_add_u32 v3, 0xc000, v3
  s_waitcnt lgkmcnt(14)
  v_mfma_f32_16x16x32_bf16 v[40:43], v[184:187], v[228:231], v[40:43]
  v_add_u32 v4, 0xc000, v4
  v_mfma_f32_16x16x32_bf16 v[88:91], v[184:187], v[232:235], v[88:91]
  v_add_u32 v5, 0xc000, v5
  v_mfma_f32_16x16x32_bf16 v[136:139], v[184:187], v[236:239], v[136:139]
  v_add_u32 v6, 0xc000, v6
  s_waitcnt lgkmcnt(12)
  v_mfma_f32_16x16x32_bf16 v[44:47], v[188:191], v[228:231], v[44:47]
  v_add_u32 v7, 0xc000, v7
  v_mfma_f32_16x16x32_bf16 v[92:95], v[188:191], v[232:235], v[92:95]
  v_mfma_f32_16x16x32_bf16 v[140:143], v[188:191], v[236:239], v[140:143]
  s_waitcnt lgkmcnt(0)
  s_barrier
  v_mfma_f32_16x16x32_bf16 v[48:51], v[192:195], v[228:231], v[48:51]
  ds_read_b64_tr_b16 v[168:169], v2
  v_mfma_f32_16x16x32_bf16 v[96:99], v[192:195], v[232:235], v[96:99]
  ds_read_b64_tr_b16 v[170:171], v2 offset:512
  v_mfma_f32_16x16x32_bf16 v[144:147], v[192:195], v[236:239], v[144:147]
  ds_read_b128 v[216:219], v6
  v_mfma_f32_16x16x32_bf16 v[52:55], v[196:199], v[228:231], v[52:55]
  ds_read_b128 v[220:223], v6 offset:2048
  v_mfma_f32_16x16x32_bf16 v[100:103], v[196:199], v[232:235], v[100:103]
  ds_read_b128 v[224:227], v6 offset:4096
  v_mfma_f32_16x16x32_bf16 v[148:151], v[196:199], v[236:239], v[148:151]
  ds_read_b64_tr_b16 v[172:173], v3
  v_mfma_f32_16x16x32_bf16 v[56:59], v[200:203], v[228:231], v[56:59]
  ds_read_b64_tr_b16 v[174:175], v3 offset:512
  v_mfma_f32_16x16x32_bf16 v[104:107], v[200:203], v[232:235], v[104:107]
  ds_read_b64_tr_b16 v[176:177], v4
  v_mfma_f32_16x16x32_bf16 v[152:155], v[200:203], v[236:239], v[152:155]
  ds_read_b64_tr_b16 v[178:179], v4 offset:512
  v_mfma_f32_16x16x32_bf16 v[60:63], v[204:207], v[228:231], v[60:63]
  ds_read_b64_tr_b16 v[180:181], v5
  v_mfma_f32_16x16x32_bf16 v[108:111], v[204:207], v[232:235], v[108:111]
  ds_read_b64_tr_b16 v[182:183], v5 offset:512
  v_mfma_f32_16x16x32_bf16 v[156:159], v[204:207], v[236:239], v[156:159]
  ds_read_b64_tr_b16 v[184:185], v2 offset:1024
  v_mfma_f32_16x16x32_bf16 v[64:67], v[208:211], v[228:231], v[64:67]
  ds_read_b64_tr_b16 v[186:187], v2 offset:1536
  v_mfma_f32_16x16x32_bf16 v[112:115], v[208:211], v[232:235], v[112:115]
  ds_read_b64_tr_b16 v[188:189], v3 offset:1024
  v_mfma_f32_16x16x32_bf16 v[160:163], v[208:211], v[236:239], v[160:163]
  ds_read_b64_tr_b16 v[190:191], v3 offset:1536
  v_mfma_f32_16x16x32_bf16 v[68:71], v[212:215], v[228:231], v[68:71]
  v_mfma_f32_16x16x32_bf16 v[116:119], v[212:215], v[232:235], v[116:119]
  v_mfma_f32_16x16x32_bf16 v[164:167], v[212:215], v[236:239], v[164:167]
  s_waitcnt lgkmcnt(12)
  v_mfma_f32_16x16x32_bf16 v[24:27], v[168:171], v[216:219], v[24:27]
  ds_read_b64_tr_b16 v[192:193], v4 offset:1024
  s_waitcnt lgkmcnt(12)
  v_mfma_f32_16x16x32_bf16 v[72:75], v[168:171], v[220:223], v[72:75]
  ds_read_b64_tr_b16 v[194:195], v4 offset:1536
  s_waitcnt lgkmcnt(12)
  v_mfma_f32_16x16x32_bf16 v[120:123], v[168:171], v[224:227], v[120:123]
  ds_read_b64_tr_b16 v[196:197], v5 offset:1024
  s_waitcnt lgkmcnt(11)
  v_mfma_f32_16x16x32_bf16 v[28:31], v[172:175], v[216:219], v[28:31]
  ds_read_b64_tr_b16 v[198:199], v5 offset:1536
  v_mfma_f32_16x16x32_bf16 v[76:79], v[172:175], v[220:223], v[76:79]
  ds_read_b64_tr_b16 v[200:201], v2 offset:2048
  v_mfma_f32_16x16x32_bf16 v[124:127], v[172:175], v[224:227], v[124:127]
  ds_read_b64_tr_b16 v[202:203], v2 offset:2560
  s_waitcnt lgkmcnt(12)
  v_mfma_f32_16x16x32_bf16 v[32:35], v[176:179], v[216:219], v[32:35]
  ds_read_b64_tr_b16 v[204:205], v3 offset:2048
  v_mfma_f32_16x16x32_bf16 v[80:83], v[176:179], v[220:223], v[80:83]
  ds_read_b64_tr_b16 v[206:207], v3 offset:2560
  v_mfma_f32_16x16x32_bf16 v[128:131], v[176:179], v[224:227], v[128:131]
  ds_read_b64_tr_b16 v[208:209], v4 offset:2048
  s_waitcnt lgkmcnt(13)
  v_mfma_f32_16x16x32_bf16 v[36:39], v[180:183], v[216:219], v[36:39]
  ds_read_b64_tr_b16 v[210:211], v4 offset:2560
  v_mfma_f32_16x16x32_bf16 v[84:87], v[180:183], v[220:223], v[84:87]
  ds_read_b64_tr_b16 v[212:213], v5 offset:2048
  v_mfma_f32_16x16x32_bf16 v[132:135], v[180:183], v[224:227], v[132:135]
  ds_read_b64_tr_b16 v[214:215], v5 offset:2560
  s_waitcnt lgkmcnt(14)
  v_mfma_f32_16x16x32_bf16 v[40:43], v[184:187], v[216:219], v[40:43]
  v_mfma_f32_16x16x32_bf16 v[88:91], v[184:187], v[220:223], v[88:91]
  v_mfma_f32_16x16x32_bf16 v[136:139], v[184:187], v[224:227], v[136:139]
  s_waitcnt lgkmcnt(12)
  v_mfma_f32_16x16x32_bf16 v[44:47], v[188:191], v[216:219], v[44:47]
  v_mfma_f32_16x16x32_bf16 v[92:95], v[188:191], v[220:223], v[92:95]
  v_mfma_f32_16x16x32_bf16 v[140:143], v[188:191], v[224:227], v[140:143]
  s_waitcnt lgkmcnt(10)
  v_mfma_f32_16x16x32_bf16 v[48:51], v[192:195], v[216:219], v[48:51]
  ds_read_b64_tr_b16 v[168:169], v2 offset:12288
  v_mfma_f32_16x16x32_bf16 v[96:99], v[192:195], v[220:223], v[96:99]
  ds_read_b64_tr_b16 v[170:171], v2 offset:12800
  v_mfma_f32_16x16x32_bf16 v[144:147], v[192:195], v[224:227], v[144:147]
  ds_read_b128 v[228:231], v7
  s_waitcnt lgkmcnt(11)
  v_mfma_f32_16x16x32_bf16 v[52:55], v[196:199], v[216:219], v[52:55]
  ds_read_b128 v[232:235], v7 offset:2048
  v_mfma_f32_16x16x32_bf16 v[100:103], v[196:199], v[220:223], v[100:103]
  ds_read_b128 v[236:239], v7 offset:4096
  v_mfma_f32_16x16x32_bf16 v[148:151], v[196:199], v[224:227], v[148:151]
  ds_read_b64_tr_b16 v[172:173], v3 offset:12288
  s_waitcnt lgkmcnt(12)
  v_mfma_f32_16x16x32_bf16 v[56:59], v[200:203], v[216:219], v[56:59]
  ds_read_b64_tr_b16 v[174:175], v3 offset:12800
  v_mfma_f32_16x16x32_bf16 v[104:107], v[200:203], v[220:223], v[104:107]
  ds_read_b64_tr_b16 v[176:177], v4 offset:12288
  v_mfma_f32_16x16x32_bf16 v[152:155], v[200:203], v[224:227], v[152:155]
  ds_read_b64_tr_b16 v[178:179], v4 offset:12800
  s_waitcnt lgkmcnt(13)
  v_mfma_f32_16x16x32_bf16 v[60:63], v[204:207], v[216:219], v[60:63]
  ds_read_b64_tr_b16 v[180:181], v5 offset:12288
  v_mfma_f32_16x16x32_bf16 v[108:111], v[204:207], v[220:223], v[108:111]
  ds_read_b64_tr_b16 v[182:183], v5 offset:12800
  v_mfma_f32_16x16x32_bf16 v[156:159], v[204:207], v[224:227], v[156:159]
  ds_read_b64_tr_b16 v[184:185], v2 offset:13312
  s_waitcnt lgkmcnt(14)
  v_mfma_f32_16x16x32_bf16 v[64:67], v[208:211], v[216:219], v[64:67]
  ds_read_b64_tr_b16 v[186:187], v2 offset:13824
  v_mfma_f32_16x16x32_bf16 v[112:115], v[208:211], v[220:223], v[112:115]
  ds_read_b64_tr_b16 v[188:189], v3 offset:13312
  v_mfma_f32_16x16x32_bf16 v[160:163], v[208:211], v[224:227], v[160:163]
  ds_read_b64_tr_b16 v[190:191], v3 offset:13824
  s_waitcnt lgkmcnt(15)
  v_mfma_f32_16x16x32_bf16 v[68:71], v[212:215], v[216:219], v[68:71]
  v_mfma_f32_16x16x32_bf16 v[116:119], v[212:215], v[220:223], v[116:119]
  v_mfma_f32_16x16x32_bf16 v[164:167], v[212:215], v[224:227], v[164:167]
  s_waitcnt lgkmcnt(12)
  v_mfma_f32_16x16x32_bf16 v[24:27], v[168:171], v[228:231], v[24:27]
  ds_read_b64_tr_b16 v[192:193], v4 offset:13312
  ds_read_b64_tr_b16 v[194:195], v4 offset:13824
  s_waitcnt lgkmcnt(13)
  v_mfma_f32_16x16x32_bf16 v[72:75], v[168:171], v[232:235], v[72:75]
  ds_read_b64_tr_b16 v[196:197], v5 offset:13312
  s_waitcnt lgkmcnt(13)
  v_mfma_f32_16x16x32_bf16 v[120:123], v[168:171], v[236:239], v[120:123]
  ds_read_b64_tr_b16 v[198:199], v5 offset:13824
  ds_read_b64_tr_b16 v[200:201], v2 offset:14336
  s_waitcnt lgkmcnt(13)
  v_mfma_f32_16x16x32_bf16 v[28:31], v[172:175], v[228:231], v[28:31]
  ds_read_b64_tr_b16 v[202:203], v2 offset:14848
  v_mfma_f32_16x16x32_bf16 v[76:79], v[172:175], v[232:235], v[76:79]
  ds_read_b64_tr_b16 v[204:205], v3 offset:14336
  ds_read_b64_tr_b16 v[206:207], v3 offset:14848
  v_mfma_f32_16x16x32_bf16 v[124:127], v[172:175], v[236:239], v[124:127]
  ds_read_b64_tr_b16 v[208:209], v4 offset:14336
  s_waitcnt lgkmcnt(15)
  v_mfma_f32_16x16x32_bf16 v[32:35], v[176:179], v[228:231], v[32:35]
  ds_read_b64_tr_b16 v[210:211], v4 offset:14848
  ds_read_b64_tr_b16 v[212:213], v5 offset:14336
  v_mfma_f32_16x16x32_bf16 v[80:83], v[176:179], v[232:235], v[80:83]
  ds_read_b64_tr_b16 v[214:215], v5 offset:14848
  v_mfma_f32_16x16x32_bf16 v[128:131], v[176:179], v[236:239], v[128:131]
  s_waitcnt lgkmcnt(15)
  v_mfma_f32_16x16x32_bf16 v[36:39], v[180:183], v[228:231], v[36:39]
  v_mfma_f32_16x16x32_bf16 v[84:87], v[180:183], v[232:235], v[84:87]
  v_add_u32 v2, 0xfffe8000, v2
  v_mfma_f32_16x16x32_bf16 v[132:135], v[180:183], v[236:239], v[132:135]
  v_add_u32 v3, 0xfffe8000, v3
  s_waitcnt lgkmcnt(14)
  v_mfma_f32_16x16x32_bf16 v[40:43], v[184:187], v[228:231], v[40:43]
  v_add_u32 v4, 0xfffe8000, v4
  v_mfma_f32_16x16x32_bf16 v[88:91], v[184:187], v[232:235], v[88:91]
  v_add_u32 v5, 0xfffe8000, v5
  v_mfma_f32_16x16x32_bf16 v[136:139], v[184:187], v[236:239], v[136:139]
  v_add_u32 v6, 0xfffe8000, v6
  s_waitcnt lgkmcnt(12)
  v_mfma_f32_16x16x32_bf16 v[44:47], v[188:191], v[228:231], v[44:47]
  v_add_u32 v7, 0xfffe8000, v7
  v_mfma_f32_16x16x32_bf16 v[92:95], v[188:191], v[232:235], v[92:95]
  v_mfma_f32_16x16x32_bf16 v[140:143], v[188:191], v[236:239], v[140:143]
  s_waitcnt lgkmcnt(0)
  s_barrier
  v_mfma_f32_16x16x32_bf16 v[48:51], v[192:195], v[228:231], v[48:51]
  ds_read_b64_tr_b16 v[168:169], v2
  v_mfma_f32_16x16x32_bf16 v[96:99], v[192:195], v[232:235], v[96:99]
  ds_read_b64_tr_b16 v[170:171], v2 offset:512
  v_mfma_f32_16x16x32_bf16 v[144:147], v[192:195], v[236:239], v[144:147]
  ds_read_b128 v[216:219], v6
  v_mfma_f32_16x16x32_bf16 v[52:55], v[196:199], v[228:231], v[52:55]
  ds_read_b128 v[220:223], v6 offset:2048
  v_mfma_f32_16x16x32_bf16 v[100:103], v[196:199], v[232:235], v[100:103]
  ds_read_b128 v[224:227], v6 offset:4096
  v_mfma_f32_16x16x32_bf16 v[148:151], v[196:199], v[236:239], v[148:151]
  ds_read_b64_tr_b16 v[172:173], v3
  v_mfma_f32_16x16x32_bf16 v[56:59], v[200:203], v[228:231], v[56:59]
  ds_read_b64_tr_b16 v[174:175], v3 offset:512
  v_mfma_f32_16x16x32_bf16 v[104:107], v[200:203], v[232:235], v[104:107]
  ds_read_b64_tr_b16 v[176:177], v4
  v_mfma_f32_16x16x32_bf16 v[152:155], v[200:203], v[236:239], v[152:155]
  ds_read_b64_tr_b16 v[178:179], v4 offset:512
  v_mfma_f32_16x16x32_bf16 v[60:63], v[204:207], v[228:231], v[60:63]
  ds_read_b64_tr_b16 v[180:181], v5
  v_mfma_f32_16x16x32_bf16 v[108:111], v[204:207], v[232:235], v[108:111]
  ds_read_b64_tr_b16 v[182:183], v5 offset:512
  v_mfma_f32_16x16x32_bf16 v[156:159], v[204:207], v[236:239], v[156:159]
  ds_read_b64_tr_b16 v[184:185], v2 offset:1024
  v_mfma_f32_16x16x32_bf16 v[64:67], v[208:211], v[228:231], v[64:67]
  ds_read_b64_tr_b16 v[186:187], v2 offset:1536
  v_mfma_f32_16x16x32_bf16 v[112:115], v[208:211], v[232:235], v[112:115]
  ds_read_b64_tr_b16 v[188:189], v3 offset:1024
  v_mfma_f32_16x16x32_bf16 v[160:163], v[208:211], v[236:239], v[160:163]
  ds_read_b64_tr_b16 v[190:191], v3 offset:1536
  v_mfma_f32_16x16x32_bf16 v[68:71], v[212:215], v[228:231], v[68:71]
  v_mfma_f32_16x16x32_bf16 v[116:119], v[212:215], v[232:235], v[116:119]
  v_mfma_f32_16x16x32_bf16 v[164:167], v[212:215], v[236:239], v[164:167]
  s_waitcnt lgkmcnt(12)
  v_mfma_f32_16x16x32_bf16 v[24:27], v[168:171], v[216:219], v[24:27]
  ds_read_b64_tr_b16 v[192:193], v4 offset:1024
  s_waitcnt lgkmcnt(12)
  v_mfma_f32_16x16x32_bf16 v[72:75], v[168:171], v[220:223], v[72:75]
  ds_read_b64_tr_b16 v[194:195], v4 offset:1536
  s_waitcnt lgkmcnt(12)
  v_mfma_f32_16x16x32_bf16 v[120:123], v[168:171], v[224:227], v[120:123]
  ds_read_b64_tr_b16 v[196:197], v5 offset:1024
  s_waitcnt lgkmcnt(11)
  v_mfma_f32_16x16x32_bf16 v[28:31], v[172:175], v[216:219], v[28:31]
  ds_read_b64_tr_b16 v[198:199], v5 offset:1536
  v_mfma_f32_16x16x32_bf16 v[76:79], v[172:175], v[220:223], v[76:79]
  ds_read_b64_tr_b16 v[200:201], v2 offset:2048
  v_mfma_f32_16x16x32_bf16 v[124:127], v[172:175], v[224:227], v[124:127]
  ds_read_b64_tr_b16 v[202:203], v2 offset:2560
  s_waitcnt lgkmcnt(12)
  v_mfma_f32_16x16x32_bf16 v[32:35], v[176:179], v[216:219], v[32:35]
  ds_read_b64_tr_b16 v[204:205], v3 offset:2048
  v_mfma_f32_16x16x32_bf16 v[80:83], v[176:179], v[220:223], v[80:83]
  ds_read_b64_tr_b16 v[206:207], v3 offset:2560
  v_mfma_f32_16x16x32_bf16 v[128:131], v[176:179], v[224:227], v[128:131]
  ds_read_b64_tr_b16 v[208:209], v4 offset:2048
  s_waitcnt lgkmcnt(13)
  v_mfma_f32_16x16x32_bf16 v[36:39], v[180:183], v[216:219], v[36:39]
  ds_read_b64_tr_b16 v[210:211], v4 offset:2560
  v_mfma_f32_16x16x32_bf16 v[84:87], v[180:183], v[220:223], v[84:87]
  ds_read_b64_tr_b16 v[212:213], v5 offset:2048
  v_mfma_f32_16x16x32_bf16 v[132:135], v[180:183], v[224:227], v[132:135]
  ds_read_b64_tr_b16 v[214:215], v5 offset:2560
  s_waitcnt lgkmcnt(14)
  v_mfma_f32_16x16x32_bf16 v[40:43], v[184:187], v[216:219], v[40:43]
  v_mfma_f32_16x16x32_bf16 v[88:91], v[184:187], v[220:223], v[88:91]
  v_mfma_f32_16x16x32_bf16 v[136:139], v[184:187], v[224:227], v[136:139]
  s_waitcnt lgkmcnt(12)
  v_mfma_f32_16x16x32_bf16 v[44:47], v[188:191], v[216:219], v[44:47]
  v_mfma_f32_16x16x32_bf16 v[92:95], v[188:191], v[220:223], v[92:95]
  v_mfma_f32_16x16x32_bf16 v[140:143], v[188:191], v[224:227], v[140:143]
  s_waitcnt lgkmcnt(10)
  v_mfma_f32_16x16x32_bf16 v[48:51], v[192:195], v[216:219], v[48:51]
  ds_read_b64_tr_b16 v[168:169], v2 offset:12288
  v_mfma_f32_16x16x32_bf16 v[96:99], v[192:195], v[220:223], v[96:99]
  ds_read_b64_tr_b16 v[170:171], v2 offset:12800
  v_mfma_f32_16x16x32_bf16 v[144:147], v[192:195], v[224:227], v[144:147]
  ds_read_b128 v[228:231], v7
  s_waitcnt lgkmcnt(11)
  v_mfma_f32_16x16x32_bf16 v[52:55], v[196:199], v[216:219], v[52:55]
  ds_read_b128 v[232:235], v7 offset:2048
  v_mfma_f32_16x16x32_bf16 v[100:103], v[196:199], v[220:223], v[100:103]
  ds_read_b128 v[236:239], v7 offset:4096
  v_mfma_f32_16x16x32_bf16 v[148:151], v[196:199], v[224:227], v[148:151]
  ds_read_b64_tr_b16 v[172:173], v3 offset:12288
  s_waitcnt lgkmcnt(12)
  v_mfma_f32_16x16x32_bf16 v[56:59], v[200:203], v[216:219], v[56:59]
  ds_read_b64_tr_b16 v[174:175], v3 offset:12800
  v_mfma_f32_16x16x32_bf16 v[104:107], v[200:203], v[220:223], v[104:107]
  ds_read_b64_tr_b16 v[176:177], v4 offset:12288
  v_mfma_f32_16x16x32_bf16 v[152:155], v[200:203], v[224:227], v[152:155]
  ds_read_b64_tr_b16 v[178:179], v4 offset:12800
  s_waitcnt lgkmcnt(13)
  v_mfma_f32_16x16x32_bf16 v[60:63], v[204:207], v[216:219], v[60:63]
  ds_read_b64_tr_b16 v[180:181], v5 offset:12288
  v_mfma_f32_16x16x32_bf16 v[108:111], v[204:207], v[220:223], v[108:111]
  ds_read_b64_tr_b16 v[182:183], v5 offset:12800
  v_mfma_f32_16x16x32_bf16 v[156:159], v[204:207], v[224:227], v[156:159]
  ds_read_b64_tr_b16 v[184:185], v2 offset:13312
  s_waitcnt lgkmcnt(14)
  v_mfma_f32_16x16x32_bf16 v[64:67], v[208:211], v[216:219], v[64:67]
  ds_read_b64_tr_b16 v[186:187], v2 offset:13824
  v_mfma_f32_16x16x32_bf16 v[112:115], v[208:211], v[220:223], v[112:115]
  ds_read_b64_tr_b16 v[188:189], v3 offset:13312
  v_mfma_f32_16x16x32_bf16 v[160:163], v[208:211], v[224:227], v[160:163]
  ds_read_b64_tr_b16 v[190:191], v3 offset:13824
  s_waitcnt lgkmcnt(15)
  v_mfma_f32_16x16x32_bf16 v[68:71], v[212:215], v[216:219], v[68:71]
  v_mfma_f32_16x16x32_bf16 v[116:119], v[212:215], v[220:223], v[116:119]
  v_mfma_f32_16x16x32_bf16 v[164:167], v[212:215], v[224:227], v[164:167]
  s_waitcnt lgkmcnt(12)
  v_mfma_f32_16x16x32_bf16 v[24:27], v[168:171], v[228:231], v[24:27]
  ds_read_b64_tr_b16 v[192:193], v4 offset:13312
  ds_read_b64_tr_b16 v[194:195], v4 offset:13824
  s_waitcnt lgkmcnt(13)
  v_mfma_f32_16x16x32_bf16 v[72:75], v[168:171], v[232:235], v[72:75]
  ds_read_b64_tr_b16 v[196:197], v5 offset:13312
  s_waitcnt lgkmcnt(13)
  v_mfma_f32_16x16x32_bf16 v[120:123], v[168:171], v[236:239], v[120:123]
  ds_read_b64_tr_b16 v[198:199], v5 offset:13824
  ds_read_b64_tr_b16 v[200:201], v2 offset:14336
  s_waitcnt lgkmcnt(13)
  v_mfma_f32_16x16x32_bf16 v[28:31], v[172:175], v[228:231], v[28:31]
  ds_read_b64_tr_b16 v[202:203], v2 offset:14848
  v_mfma_f32_16x16x32_bf16 v[76:79], v[172:175], v[232:235], v[76:79]
  ds_read_b64_tr_b16 v[204:205], v3 offset:14336
  ds_read_b64_tr_b16 v[206:207], v3 offset:14848
  v_mfma_f32_16x16x32_bf16 v[124:127], v[172:175], v[236:239], v[124:127]
  ds_read_b64_tr_b16 v[208:209], v4 offset:14336
  s_waitcnt lgkmcnt(15)
  v_mfma_f32_16x16x32_bf16 v[32:35], v[176:179], v[228:231], v[32:35]
  ds_read_b64_tr_b16 v[210:211], v4 offset:14848
  ds_read_b64_tr_b16 v[212:213], v5 offset:14336
  v_mfma_f32_16x16x32_bf16 v[80:83], v[176:179], v[232:235], v[80:83]
  ds_read_b64_tr_b16 v[214:215], v5 offset:14848
  v_mfma_f32_16x16x32_bf16 v[128:131], v[176:179], v[236:239], v[128:131]
  s_waitcnt lgkmcnt(15)
  v_mfma_f32_16x16x32_bf16 v[36:39], v[180:183], v[228:231], v[36:39]
  v_mfma_f32_16x16x32_bf16 v[84:87], v[180:183], v[232:235], v[84:87]
  v_add_u32 v2, 0xc000, v2
  v_mfma_f32_16x16x32_bf16 v[132:135], v[180:183], v[236:239], v[132:135]
  v_add_u32 v3, 0xc000, v3
  s_waitcnt lgkmcnt(14)
  v_mfma_f32_16x16x32_bf16 v[40:43], v[184:187], v[228:231], v[40:43]
  v_add_u32 v4, 0xc000, v4
  v_mfma_f32_16x16x32_bf16 v[88:91], v[184:187], v[232:235], v[88:91]
  v_add_u32 v5, 0xc000, v5
  v_mfma_f32_16x16x32_bf16 v[136:139], v[184:187], v[236:239], v[136:139]
  v_add_u32 v6, 0xc000, v6
  s_waitcnt lgkmcnt(12)
  v_mfma_f32_16x16x32_bf16 v[44:47], v[188:191], v[228:231], v[44:47]
  v_add_u32 v7, 0xc000, v7
  v_mfma_f32_16x16x32_bf16 v[92:95], v[188:191], v[232:235], v[92:95]
  v_mfma_f32_16x16x32_bf16 v[140:143], v[188:191], v[236:239], v[140:143]
  s_waitcnt lgkmcnt(0)
  s_barrier
  v_mfma_f32_16x16x32_bf16 v[48:51], v[192:195], v[228:231], v[48:51]
  ds_read_b64_tr_b16 v[168:169], v2
  v_mfma_f32_16x16x32_bf16 v[96:99], v[192:195], v[232:235], v[96:99]
  ds_read_b64_tr_b16 v[170:171], v2 offset:512
  v_mfma_f32_16x16x32_bf16 v[144:147], v[192:195], v[236:239], v[144:147]
  ds_read_b128 v[216:219], v6
  v_mfma_f32_16x16x32_bf16 v[52:55], v[196:199], v[228:231], v[52:55]
  ds_read_b128 v[220:223], v6 offset:2048
  v_mfma_f32_16x16x32_bf16 v[100:103], v[196:199], v[232:235], v[100:103]
  ds_read_b128 v[224:227], v6 offset:4096
  v_mfma_f32_16x16x32_bf16 v[148:151], v[196:199], v[236:239], v[148:151]
  ds_read_b64_tr_b16 v[172:173], v3
  v_mfma_f32_16x16x32_bf16 v[56:59], v[200:203], v[228:231], v[56:59]
  ds_read_b64_tr_b16 v[174:175], v3 offset:512
  v_mfma_f32_16x16x32_bf16 v[104:107], v[200:203], v[232:235], v[104:107]
  ds_read_b64_tr_b16 v[176:177], v4
  v_mfma_f32_16x16x32_bf16 v[152:155], v[200:203], v[236:239], v[152:155]
  ds_read_b64_tr_b16 v[178:179], v4 offset:512
  v_mfma_f32_16x16x32_bf16 v[60:63], v[204:207], v[228:231], v[60:63]
  ds_read_b64_tr_b16 v[180:181], v5
  v_mfma_f32_16x16x32_bf16 v[108:111], v[204:207], v[232:235], v[108:111]
  ds_read_b64_tr_b16 v[182:183], v5 offset:512
  v_mfma_f32_16x16x32_bf16 v[156:159], v[204:207], v[236:239], v[156:159]
  ds_read_b64_tr_b16 v[184:185], v2 offset:1024
  v_mfma_f32_16x16x32_bf16 v[64:67], v[208:211], v[228:231], v[64:67]
  ds_read_b64_tr_b16 v[186:187], v2 offset:1536
  v_mfma_f32_16x16x32_bf16 v[112:115], v[208:211], v[232:235], v[112:115]
  ds_read_b64_tr_b16 v[188:189], v3 offset:1024
  v_mfma_f32_16x16x32_bf16 v[160:163], v[208:211], v[236:239], v[160:163]
  ds_read_b64_tr_b16 v[190:191], v3 offset:1536
  v_mfma_f32_16x16x32_bf16 v[68:71], v[212:215], v[228:231], v[68:71]
  v_mfma_f32_16x16x32_bf16 v[116:119], v[212:215], v[232:235], v[116:119]
  v_mfma_f32_16x16x32_bf16 v[164:167], v[212:215], v[236:239], v[164:167]
  s_waitcnt lgkmcnt(12)
  v_mfma_f32_16x16x32_bf16 v[24:27], v[168:171], v[216:219], v[24:27]
  ds_read_b64_tr_b16 v[192:193], v4 offset:1024
  s_waitcnt lgkmcnt(12)
  v_mfma_f32_16x16x32_bf16 v[72:75], v[168:171], v[220:223], v[72:75]
  ds_read_b64_tr_b16 v[194:195], v4 offset:1536
  s_waitcnt lgkmcnt(12)
  v_mfma_f32_16x16x32_bf16 v[120:123], v[168:171], v[224:227], v[120:123]
  ds_read_b64_tr_b16 v[196:197], v5 offset:1024
  s_waitcnt lgkmcnt(11)
  v_mfma_f32_16x16x32_bf16 v[28:31], v[172:175], v[216:219], v[28:31]
  ds_read_b64_tr_b16 v[198:199], v5 offset:1536
  v_mfma_f32_16x16x32_bf16 v[76:79], v[172:175], v[220:223], v[76:79]
  ds_read_b64_tr_b16 v[200:201], v2 offset:2048
  v_mfma_f32_16x16x32_bf16 v[124:127], v[172:175], v[224:227], v[124:127]
  ds_read_b64_tr_b16 v[202:203], v2 offset:2560
  s_waitcnt lgkmcnt(12)
  v_mfma_f32_16x16x32_bf16 v[32:35], v[176:179], v[216:219], v[32:35]
  ds_read_b64_tr_b16 v[204:205], v3 offset:2048
  v_mfma_f32_16x16x32_bf16 v[80:83], v[176:179], v[220:223], v[80:83]
  ds_read_b64_tr_b16 v[206:207], v3 offset:2560
  v_mfma_f32_16x16x32_bf16 v[128:131], v[176:179], v[224:227], v[128:131]
  ds_read_b64_tr_b16 v[208:209], v4 offset:2048
  s_waitcnt lgkmcnt(13)
  v_mfma_f32_16x16x32_bf16 v[36:39], v[180:183], v[216:219], v[36:39]
  ds_read_b64_tr_b16 v[210:211], v4 offset:2560
  v_mfma_f32_16x16x32_bf16 v[84:87], v[180:183], v[220:223], v[84:87]
  ds_read_b64_tr_b16 v[212:213], v5 offset:2048
  v_mfma_f32_16x16x32_bf16 v[132:135], v[180:183], v[224:227], v[132:135]
  ds_read_b64_tr_b16 v[214:215], v5 offset:2560
  s_waitcnt lgkmcnt(14)
  v_mfma_f32_16x16x32_bf16 v[40:43], v[184:187], v[216:219], v[40:43]
  v_mfma_f32_16x16x32_bf16 v[88:91], v[184:187], v[220:223], v[88:91]
  v_mfma_f32_16x16x32_bf16 v[136:139], v[184:187], v[224:227], v[136:139]
  s_waitcnt lgkmcnt(12)
  v_mfma_f32_16x16x32_bf16 v[44:47], v[188:191], v[216:219], v[44:47]
  v_mfma_f32_16x16x32_bf16 v[92:95], v[188:191], v[220:223], v[92:95]
  v_mfma_f32_16x16x32_bf16 v[140:143], v[188:191], v[224:227], v[140:143]
  s_waitcnt lgkmcnt(10)
  v_mfma_f32_16x16x32_bf16 v[48:51], v[192:195], v[216:219], v[48:51]
  ds_read_b64_tr_b16 v[168:169], v2 offset:12288
  v_mfma_f32_16x16x32_bf16 v[96:99], v[192:195], v[220:223], v[96:99]
  ds_read_b64_tr_b16 v[170:171], v2 offset:12800
  v_mfma_f32_16x16x32_bf16 v[144:147], v[192:195], v[224:227], v[144:147]
  ds_read_b128 v[228:231], v7
  s_waitcnt lgkmcnt(11)
  v_mfma_f32_16x16x32_bf16 v[52:55], v[196:199], v[216:219], v[52:55]
  ds_read_b128 v[232:235], v7 offset:2048
  v_mfma_f32_16x16x32_bf16 v[100:103], v[196:199], v[220:223], v[100:103]
  ds_read_b128 v[236:239], v7 offset:4096
  v_mfma_f32_16x16x32_bf16 v[148:151], v[196:199], v[224:227], v[148:151]
  ds_read_b64_tr_b16 v[172:173], v3 offset:12288
  s_waitcnt lgkmcnt(12)
  v_mfma_f32_16x16x32_bf16 v[56:59], v[200:203], v[216:219], v[56:59]
  ds_read_b64_tr_b16 v[174:175], v3 offset:12800
  v_mfma_f32_16x16x32_bf16 v[104:107], v[200:203], v[220:223], v[104:107]
  ds_read_b64_tr_b16 v[176:177], v4 offset:12288
  v_mfma_f32_16x16x32_bf16 v[152:155], v[200:203], v[224:227], v[152:155]
  ds_read_b64_tr_b16 v[178:179], v4 offset:12800
  s_waitcnt lgkmcnt(13)
  v_mfma_f32_16x16x32_bf16 v[60:63], v[204:207], v[216:219], v[60:63]
  ds_read_b64_tr_b16 v[180:181], v5 offset:12288
  v_mfma_f32_16x16x32_bf16 v[108:111], v[204:207], v[220:223], v[108:111]
  ds_read_b64_tr_b16 v[182:183], v5 offset:12800
  v_mfma_f32_16x16x32_bf16 v[156:159], v[204:207], v[224:227], v[156:159]
  ds_read_b64_tr_b16 v[184:185], v2 offset:13312
  s_waitcnt lgkmcnt(14)
  v_mfma_f32_16x16x32_bf16 v[64:67], v[208:211], v[216:219], v[64:67]
  ds_read_b64_tr_b16 v[186:187], v2 offset:13824
  v_mfma_f32_16x16x32_bf16 v[112:115], v[208:211], v[220:223], v[112:115]
  ds_read_b64_tr_b16 v[188:189], v3 offset:13312
  v_mfma_f32_16x16x32_bf16 v[160:163], v[208:211], v[224:227], v[160:163]
  ds_read_b64_tr_b16 v[190:191], v3 offset:13824
  s_waitcnt lgkmcnt(15)
  v_mfma_f32_16x16x32_bf16 v[68:71], v[212:215], v[216:219], v[68:71]
  v_mfma_f32_16x16x32_bf16 v[116:119], v[212:215], v[220:223], v[116:119]
  v_mfma_f32_16x16x32_bf16 v[164:167], v[212:215], v[224:227], v[164:167]
  s_waitcnt lgkmcnt(12)
  v_mfma_f32_16x16x32_bf16 v[24:27], v[168:171], v[228:231], v[24:27]
  ds_read_b64_tr_b16 v[192:193], v4 offset:13312
  ds_read_b64_tr_b16 v[194:195], v4 offset:13824
  s_waitcnt lgkmcnt(13)
  v_mfma_f32_16x16x32_bf16 v[72:75], v[168:171], v[232:235], v[72:75]
  ds_read_b64_tr_b16 v[196:197], v5 offset:13312
  s_waitcnt lgkmcnt(13)
  v_mfma_f32_16x16x32_bf16 v[120:123], v[168:171], v[236:239], v[120:123]
  ds_read_b64_tr_b16 v[198:199], v5 offset:13824
  ds_read_b64_tr_b16 v[200:201], v2 offset:14336
  s_waitcnt lgkmcnt(13)
  v_mfma_f32_16x16x32_bf16 v[28:31], v[172:175], v[228:231], v[28:31]
  ds_read_b64_tr_b16 v[202:203], v2 offset:14848
  v_mfma_f32_16x16x32_bf16 v[76:79], v[172:175], v[232:235], v[76:79]
  ds_read_b64_tr_b16 v[204:205], v3 offset:14336
  ds_read_b64_tr_b16 v[206:207], v3 offset:14848
  v_mfma_f32_16x16x32_bf16 v[124:127], v[172:175], v[236:239], v[124:127]
  ds_read_b64_tr_b16 v[208:209], v4 offset:14336
  s_waitcnt lgkmcnt(15)
  v_mfma_f32_16x16x32_bf16 v[32:35], v[176:179], v[228:231], v[32:35]
  ds_read_b64_tr_b16 v[210:211], v4 offset:14848
  ds_read_b64_tr_b16 v[212:213], v5 offset:14336
  v_mfma_f32_16x16x32_bf16 v[80:83], v[176:179], v[232:235], v[80:83]
  ds_read_b64_tr_b16 v[214:215], v5 offset:14848
  v_mfma_f32_16x16x32_bf16 v[128:131], v[176:179], v[236:239], v[128:131]
  s_waitcnt lgkmcnt(15)
  v_mfma_f32_16x16x32_bf16 v[36:39], v[180:183], v[228:231], v[36:39]
  v_mfma_f32_16x16x32_bf16 v[84:87], v[180:183], v[232:235], v[84:87]
  v_add_u32 v2, 0xc000, v2
  v_mfma_f32_16x16x32_bf16 v[132:135], v[180:183], v[236:239], v[132:135]
  v_add_u32 v3, 0xc000, v3
  s_waitcnt lgkmcnt(14)
  v_mfma_f32_16x16x32_bf16 v[40:43], v[184:187], v[228:231], v[40:43]
  v_add_u32 v4, 0xc000, v4
  v_mfma_f32_16x16x32_bf16 v[88:91], v[184:187], v[232:235], v[88:91]
  v_add_u32 v5, 0xc000, v5
  v_mfma_f32_16x16x32_bf16 v[136:139], v[184:187], v[236:239], v[136:139]
  v_add_u32 v6, 0xc000, v6
  s_waitcnt lgkmcnt(12)
  v_mfma_f32_16x16x32_bf16 v[44:47], v[188:191], v[228:231], v[44:47]
  v_add_u32 v7, 0xc000, v7
  v_mfma_f32_16x16x32_bf16 v[92:95], v[188:191], v[232:235], v[92:95]
  v_mfma_f32_16x16x32_bf16 v[140:143], v[188:191], v[236:239], v[140:143]
  s_waitcnt lgkmcnt(0)
  s_barrier
  v_mfma_f32_16x16x32_bf16 v[48:51], v[192:195], v[228:231], v[48:51]
  ds_read_b64_tr_b16 v[168:169], v2
  v_mfma_f32_16x16x32_bf16 v[96:99], v[192:195], v[232:235], v[96:99]
  ds_read_b64_tr_b16 v[170:171], v2 offset:512
  v_mfma_f32_16x16x32_bf16 v[144:147], v[192:195], v[236:239], v[144:147]
  ds_read_b128 v[216:219], v6
  v_mfma_f32_16x16x32_bf16 v[52:55], v[196:199], v[228:231], v[52:55]
  ds_read_b128 v[220:223], v6 offset:2048
  v_mfma_f32_16x16x32_bf16 v[100:103], v[196:199], v[232:235], v[100:103]
  ds_read_b128 v[224:227], v6 offset:4096
  v_mfma_f32_16x16x32_bf16 v[148:151], v[196:199], v[236:239], v[148:151]
  ds_read_b64_tr_b16 v[172:173], v3
  v_mfma_f32_16x16x32_bf16 v[56:59], v[200:203], v[228:231], v[56:59]
  ds_read_b64_tr_b16 v[174:175], v3 offset:512
  v_mfma_f32_16x16x32_bf16 v[104:107], v[200:203], v[232:235], v[104:107]
  ds_read_b64_tr_b16 v[176:177], v4
  v_mfma_f32_16x16x32_bf16 v[152:155], v[200:203], v[236:239], v[152:155]
  ds_read_b64_tr_b16 v[178:179], v4 offset:512
  v_mfma_f32_16x16x32_bf16 v[60:63], v[204:207], v[228:231], v[60:63]
  ds_read_b64_tr_b16 v[180:181], v5
  v_mfma_f32_16x16x32_bf16 v[108:111], v[204:207], v[232:235], v[108:111]
  ds_read_b64_tr_b16 v[182:183], v5 offset:512
  v_mfma_f32_16x16x32_bf16 v[156:159], v[204:207], v[236:239], v[156:159]
  ds_read_b64_tr_b16 v[184:185], v2 offset:1024
  v_mfma_f32_16x16x32_bf16 v[64:67], v[208:211], v[228:231], v[64:67]
  ds_read_b64_tr_b16 v[186:187], v2 offset:1536
  v_mfma_f32_16x16x32_bf16 v[112:115], v[208:211], v[232:235], v[112:115]
  ds_read_b64_tr_b16 v[188:189], v3 offset:1024
  v_mfma_f32_16x16x32_bf16 v[160:163], v[208:211], v[236:239], v[160:163]
  ds_read_b64_tr_b16 v[190:191], v3 offset:1536
  v_mfma_f32_16x16x32_bf16 v[68:71], v[212:215], v[228:231], v[68:71]
  v_mfma_f32_16x16x32_bf16 v[116:119], v[212:215], v[232:235], v[116:119]
  v_mfma_f32_16x16x32_bf16 v[164:167], v[212:215], v[236:239], v[164:167]
  s_waitcnt lgkmcnt(12)
  v_mfma_f32_16x16x32_bf16 v[24:27], v[168:171], v[216:219], v[24:27]
  ds_read_b64_tr_b16 v[192:193], v4 offset:1024
  s_waitcnt lgkmcnt(12)
  v_mfma_f32_16x16x32_bf16 v[72:75], v[168:171], v[220:223], v[72:75]
  ds_read_b64_tr_b16 v[194:195], v4 offset:1536
  s_waitcnt lgkmcnt(12)
  v_mfma_f32_16x16x32_bf16 v[120:123], v[168:171], v[224:227], v[120:123]
  ds_read_b64_tr_b16 v[196:197], v5 offset:1024
  s_waitcnt lgkmcnt(11)
  v_mfma_f32_16x16x32_bf16 v[28:31], v[172:175], v[216:219], v[28:31]
  ds_read_b64_tr_b16 v[198:199], v5 offset:1536
  v_mfma_f32_16x16x32_bf16 v[76:79], v[172:175], v[220:223], v[76:79]
  ds_read_b64_tr_b16 v[200:201], v2 offset:2048
  v_mfma_f32_16x16x32_bf16 v[124:127], v[172:175], v[224:227], v[124:127]
  ds_read_b64_tr_b16 v[202:203], v2 offset:2560
  s_waitcnt lgkmcnt(12)
  v_mfma_f32_16x16x32_bf16 v[32:35], v[176:179], v[216:219], v[32:35]
  ds_read_b64_tr_b16 v[204:205], v3 offset:2048
  v_mfma_f32_16x16x32_bf16 v[80:83], v[176:179], v[220:223], v[80:83]
  ds_read_b64_tr_b16 v[206:207], v3 offset:2560
  v_mfma_f32_16x16x32_bf16 v[128:131], v[176:179], v[224:227], v[128:131]
  ds_read_b64_tr_b16 v[208:209], v4 offset:2048
  s_waitcnt lgkmcnt(13)
  v_mfma_f32_16x16x32_bf16 v[36:39], v[180:183], v[216:219], v[36:39]
  ds_read_b64_tr_b16 v[210:211], v4 offset:2560
  v_mfma_f32_16x16x32_bf16 v[84:87], v[180:183], v[220:223], v[84:87]
  ds_read_b64_tr_b16 v[212:213], v5 offset:2048
  v_mfma_f32_16x16x32_bf16 v[132:135], v[180:183], v[224:227], v[132:135]
  ds_read_b64_tr_b16 v[214:215], v5 offset:2560
  s_waitcnt lgkmcnt(14)
  v_mfma_f32_16x16x32_bf16 v[40:43], v[184:187], v[216:219], v[40:43]
  v_mfma_f32_16x16x32_bf16 v[88:91], v[184:187], v[220:223], v[88:91]
  v_mfma_f32_16x16x32_bf16 v[136:139], v[184:187], v[224:227], v[136:139]
  s_waitcnt lgkmcnt(12)
  v_mfma_f32_16x16x32_bf16 v[44:47], v[188:191], v[216:219], v[44:47]
  v_mfma_f32_16x16x32_bf16 v[92:95], v[188:191], v[220:223], v[92:95]
  v_mfma_f32_16x16x32_bf16 v[140:143], v[188:191], v[224:227], v[140:143]
  s_waitcnt lgkmcnt(10)
  v_mfma_f32_16x16x32_bf16 v[48:51], v[192:195], v[216:219], v[48:51]
  ds_read_b64_tr_b16 v[168:169], v2 offset:12288
  v_mfma_f32_16x16x32_bf16 v[96:99], v[192:195], v[220:223], v[96:99]
  ds_read_b64_tr_b16 v[170:171], v2 offset:12800
  v_mfma_f32_16x16x32_bf16 v[144:147], v[192:195], v[224:227], v[144:147]
  ds_read_b128 v[228:231], v7
  s_waitcnt lgkmcnt(11)
  v_mfma_f32_16x16x32_bf16 v[52:55], v[196:199], v[216:219], v[52:55]
  ds_read_b128 v[232:235], v7 offset:2048
  v_mfma_f32_16x16x32_bf16 v[100:103], v[196:199], v[220:223], v[100:103]
  ds_read_b128 v[236:239], v7 offset:4096
  v_mfma_f32_16x16x32_bf16 v[148:151], v[196:199], v[224:227], v[148:151]
  ds_read_b64_tr_b16 v[172:173], v3 offset:12288
  s_waitcnt lgkmcnt(12)
  v_mfma_f32_16x16x32_bf16 v[56:59], v[200:203], v[216:219], v[56:59]
  ds_read_b64_tr_b16 v[174:175], v3 offset:12800
  v_mfma_f32_16x16x32_bf16 v[104:107], v[200:203], v[220:223], v[104:107]
  ds_read_b64_tr_b16 v[176:177], v4 offset:12288
  v_mfma_f32_16x16x32_bf16 v[152:155], v[200:203], v[224:227], v[152:155]
  ds_read_b64_tr_b16 v[178:179], v4 offset:12800
  s_waitcnt lgkmcnt(13)
  v_mfma_f32_16x16x32_bf16 v[60:63], v[204:207], v[216:219], v[60:63]
  ds_read_b64_tr_b16 v[180:181], v5 offset:12288
  v_mfma_f32_16x16x32_bf16 v[108:111], v[204:207], v[220:223], v[108:111]
  ds_read_b64_tr_b16 v[182:183], v5 offset:12800
  v_mfma_f32_16x16x32_bf16 v[156:159], v[204:207], v[224:227], v[156:159]
  ds_read_b64_tr_b16 v[184:185], v2 offset:13312
  s_waitcnt lgkmcnt(14)
  v_mfma_f32_16x16x32_bf16 v[64:67], v[208:211], v[216:219], v[64:67]
  ds_read_b64_tr_b16 v[186:187], v2 offset:13824
  v_mfma_f32_16x16x32_bf16 v[112:115], v[208:211], v[220:223], v[112:115]
  ds_read_b64_tr_b16 v[188:189], v3 offset:13312
  v_mfma_f32_16x16x32_bf16 v[160:163], v[208:211], v[224:227], v[160:163]
  ds_read_b64_tr_b16 v[190:191], v3 offset:13824
  s_waitcnt lgkmcnt(15)
  v_mfma_f32_16x16x32_bf16 v[68:71], v[212:215], v[216:219], v[68:71]
  v_mfma_f32_16x16x32_bf16 v[116:119], v[212:215], v[220:223], v[116:119]
  v_mfma_f32_16x16x32_bf16 v[164:167], v[212:215], v[224:227], v[164:167]
  s_waitcnt lgkmcnt(12)
  v_mfma_f32_16x16x32_bf16 v[24:27], v[168:171], v[228:231], v[24:27]
  ds_read_b64_tr_b16 v[192:193], v4 offset:13312
  ds_read_b64_tr_b16 v[194:195], v4 offset:13824
  s_waitcnt lgkmcnt(13)
  v_mfma_f32_16x16x32_bf16 v[72:75], v[168:171], v[232:235], v[72:75]
  ds_read_b64_tr_b16 v[196:197], v5 offset:13312
  s_waitcnt lgkmcnt(13)
  v_mfma_f32_16x16x32_bf16 v[120:123], v[168:171], v[236:239], v[120:123]
  ds_read_b64_tr_b16 v[198:199], v5 offset:13824
  ds_read_b64_tr_b16 v[200:201], v2 offset:14336
  s_waitcnt lgkmcnt(13)
  v_mfma_f32_16x16x32_bf16 v[28:31], v[172:175], v[228:231], v[28:31]
  ds_read_b64_tr_b16 v[202:203], v2 offset:14848
  v_mfma_f32_16x16x32_bf16 v[76:79], v[172:175], v[232:235], v[76:79]
  ds_read_b64_tr_b16 v[204:205], v3 offset:14336
  ds_read_b64_tr_b16 v[206:207], v3 offset:14848
  v_mfma_f32_16x16x32_bf16 v[124:127], v[172:175], v[236:239], v[124:127]
  ds_read_b64_tr_b16 v[208:209], v4 offset:14336
  s_waitcnt lgkmcnt(15)
  v_mfma_f32_16x16x32_bf16 v[32:35], v[176:179], v[228:231], v[32:35]
  ds_read_b64_tr_b16 v[210:211], v4 offset:14848
  ds_read_b64_tr_b16 v[212:213], v5 offset:14336
  v_mfma_f32_16x16x32_bf16 v[80:83], v[176:179], v[232:235], v[80:83]
  ds_read_b64_tr_b16 v[214:215], v5 offset:14848
  v_mfma_f32_16x16x32_bf16 v[128:131], v[176:179], v[236:239], v[128:131]
  s_waitcnt lgkmcnt(15)
  v_mfma_f32_16x16x32_bf16 v[36:39], v[180:183], v[228:231], v[36:39]
  v_mfma_f32_16x16x32_bf16 v[84:87], v[180:183], v[232:235], v[84:87]
  v_add_u32 v2, 0xfffe8000, v2
  v_mfma_f32_16x16x32_bf16 v[132:135], v[180:183], v[236:239], v[132:135]
  v_add_u32 v3, 0xfffe8000, v3
  s_waitcnt lgkmcnt(14)
  v_mfma_f32_16x16x32_bf16 v[40:43], v[184:187], v[228:231], v[40:43]
  v_add_u32 v4, 0xfffe8000, v4
  v_mfma_f32_16x16x32_bf16 v[88:91], v[184:187], v[232:235], v[88:91]
  v_add_u32 v5, 0xfffe8000, v5
  v_mfma_f32_16x16x32_bf16 v[136:139], v[184:187], v[236:239], v[136:139]
  v_add_u32 v6, 0xfffe8000, v6
  s_waitcnt lgkmcnt(12)
  v_mfma_f32_16x16x32_bf16 v[44:47], v[188:191], v[228:231], v[44:47]
  v_add_u32 v7, 0xfffe8000, v7
  v_mfma_f32_16x16x32_bf16 v[92:95], v[188:191], v[232:235], v[92:95]
  v_mfma_f32_16x16x32_bf16 v[140:143], v[188:191], v[236:239], v[140:143]
  s_waitcnt lgkmcnt(0)
  s_barrier
  v_mfma_f32_16x16x32_bf16 v[48:51], v[192:195], v[228:231], v[48:51]
  ds_read_b64_tr_b16 v[168:169], v2
  v_mfma_f32_16x16x32_bf16 v[96:99], v[192:195], v[232:235], v[96:99]
  ds_read_b64_tr_b16 v[170:171], v2 offset:512
  v_mfma_f32_16x16x32_bf16 v[144:147], v[192:195], v[236:239], v[144:147]
  ds_read_b128 v[216:219], v6
  v_mfma_f32_16x16x32_bf16 v[52:55], v[196:199], v[228:231], v[52:55]
  ds_read_b128 v[220:223], v6 offset:2048
  v_mfma_f32_16x16x32_bf16 v[100:103], v[196:199], v[232:235], v[100:103]
  ds_read_b128 v[224:227], v6 offset:4096
  v_mfma_f32_16x16x32_bf16 v[148:151], v[196:199], v[236:239], v[148:151]
  ds_read_b64_tr_b16 v[172:173], v3
  v_mfma_f32_16x16x32_bf16 v[56:59], v[200:203], v[228:231], v[56:59]
  ds_read_b64_tr_b16 v[174:175], v3 offset:512
  v_mfma_f32_16x16x32_bf16 v[104:107], v[200:203], v[232:235], v[104:107]
  ds_read_b64_tr_b16 v[176:177], v4
  v_mfma_f32_16x16x32_bf16 v[152:155], v[200:203], v[236:239], v[152:155]
  ds_read_b64_tr_b16 v[178:179], v4 offset:512
  v_mfma_f32_16x16x32_bf16 v[60:63], v[204:207], v[228:231], v[60:63]
  ds_read_b64_tr_b16 v[180:181], v5
  v_mfma_f32_16x16x32_bf16 v[108:111], v[204:207], v[232:235], v[108:111]
  ds_read_b64_tr_b16 v[182:183], v5 offset:512
  v_mfma_f32_16x16x32_bf16 v[156:159], v[204:207], v[236:239], v[156:159]
  ds_read_b64_tr_b16 v[184:185], v2 offset:1024
  v_mfma_f32_16x16x32_bf16 v[64:67], v[208:211], v[228:231], v[64:67]
  ds_read_b64_tr_b16 v[186:187], v2 offset:1536
  v_mfma_f32_16x16x32_bf16 v[112:115], v[208:211], v[232:235], v[112:115]
  ds_read_b64_tr_b16 v[188:189], v3 offset:1024
  v_mfma_f32_16x16x32_bf16 v[160:163], v[208:211], v[236:239], v[160:163]
  ds_read_b64_tr_b16 v[190:191], v3 offset:1536
  v_mfma_f32_16x16x32_bf16 v[68:71], v[212:215], v[228:231], v[68:71]
  v_mfma_f32_16x16x32_bf16 v[116:119], v[212:215], v[232:235], v[116:119]
  v_mfma_f32_16x16x32_bf16 v[164:167], v[212:215], v[236:239], v[164:167]
  s_waitcnt lgkmcnt(12)
  v_mfma_f32_16x16x32_bf16 v[24:27], v[168:171], v[216:219], v[24:27]
  ds_read_b64_tr_b16 v[192:193], v4 offset:1024
  s_waitcnt lgkmcnt(12)
  v_mfma_f32_16x16x32_bf16 v[72:75], v[168:171], v[220:223], v[72:75]
  ds_read_b64_tr_b16 v[194:195], v4 offset:1536
  s_waitcnt lgkmcnt(12)
  v_mfma_f32_16x16x32_bf16 v[120:123], v[168:171], v[224:227], v[120:123]
  ds_read_b64_tr_b16 v[196:197], v5 offset:1024
  s_waitcnt lgkmcnt(11)
  v_mfma_f32_16x16x32_bf16 v[28:31], v[172:175], v[216:219], v[28:31]
  ds_read_b64_tr_b16 v[198:199], v5 offset:1536
  v_mfma_f32_16x16x32_bf16 v[76:79], v[172:175], v[220:223], v[76:79]
  ds_read_b64_tr_b16 v[200:201], v2 offset:2048
  v_mfma_f32_16x16x32_bf16 v[124:127], v[172:175], v[224:227], v[124:127]
  ds_read_b64_tr_b16 v[202:203], v2 offset:2560
  s_waitcnt lgkmcnt(12)
  v_mfma_f32_16x16x32_bf16 v[32:35], v[176:179], v[216:219], v[32:35]
  ds_read_b64_tr_b16 v[204:205], v3 offset:2048
  v_mfma_f32_16x16x32_bf16 v[80:83], v[176:179], v[220:223], v[80:83]
  ds_read_b64_tr_b16 v[206:207], v3 offset:2560
  v_mfma_f32_16x16x32_bf16 v[128:131], v[176:179], v[224:227], v[128:131]
  ds_read_b64_tr_b16 v[208:209], v4 offset:2048
  s_waitcnt lgkmcnt(13)
  v_mfma_f32_16x16x32_bf16 v[36:39], v[180:183], v[216:219], v[36:39]
  ds_read_b64_tr_b16 v[210:211], v4 offset:2560
  v_mfma_f32_16x16x32_bf16 v[84:87], v[180:183], v[220:223], v[84:87]
  ds_read_b64_tr_b16 v[212:213], v5 offset:2048
  v_mfma_f32_16x16x32_bf16 v[132:135], v[180:183], v[224:227], v[132:135]
  ds_read_b64_tr_b16 v[214:215], v5 offset:2560
  s_waitcnt lgkmcnt(14)
  v_mfma_f32_16x16x32_bf16 v[40:43], v[184:187], v[216:219], v[40:43]
  v_mfma_f32_16x16x32_bf16 v[88:91], v[184:187], v[220:223], v[88:91]
  v_mfma_f32_16x16x32_bf16 v[136:139], v[184:187], v[224:227], v[136:139]
  s_waitcnt lgkmcnt(12)
  v_mfma_f32_16x16x32_bf16 v[44:47], v[188:191], v[216:219], v[44:47]
  v_mfma_f32_16x16x32_bf16 v[92:95], v[188:191], v[220:223], v[92:95]
  v_mfma_f32_16x16x32_bf16 v[140:143], v[188:191], v[224:227], v[140:143]
  s_waitcnt lgkmcnt(10)
  v_mfma_f32_16x16x32_bf16 v[48:51], v[192:195], v[216:219], v[48:51]
  ds_read_b64_tr_b16 v[168:169], v2 offset:12288
  v_mfma_f32_16x16x32_bf16 v[96:99], v[192:195], v[220:223], v[96:99]
  ds_read_b64_tr_b16 v[170:171], v2 offset:12800
  v_mfma_f32_16x16x32_bf16 v[144:147], v[192:195], v[224:227], v[144:147]
  ds_read_b128 v[228:231], v7
  s_waitcnt lgkmcnt(11)
  v_mfma_f32_16x16x32_bf16 v[52:55], v[196:199], v[216:219], v[52:55]
  ds_read_b128 v[232:235], v7 offset:2048
  v_mfma_f32_16x16x32_bf16 v[100:103], v[196:199], v[220:223], v[100:103]
  ds_read_b128 v[236:239], v7 offset:4096
  v_mfma_f32_16x16x32_bf16 v[148:151], v[196:199], v[224:227], v[148:151]
  ds_read_b64_tr_b16 v[172:173], v3 offset:12288
  s_waitcnt lgkmcnt(12)
  v_mfma_f32_16x16x32_bf16 v[56:59], v[200:203], v[216:219], v[56:59]
  ds_read_b64_tr_b16 v[174:175], v3 offset:12800
  v_mfma_f32_16x16x32_bf16 v[104:107], v[200:203], v[220:223], v[104:107]
  ds_read_b64_tr_b16 v[176:177], v4 offset:12288
  v_mfma_f32_16x16x32_bf16 v[152:155], v[200:203], v[224:227], v[152:155]
  ds_read_b64_tr_b16 v[178:179], v4 offset:12800
  s_waitcnt lgkmcnt(13)
  v_mfma_f32_16x16x32_bf16 v[60:63], v[204:207], v[216:219], v[60:63]
  ds_read_b64_tr_b16 v[180:181], v5 offset:12288
  v_mfma_f32_16x16x32_bf16 v[108:111], v[204:207], v[220:223], v[108:111]
  ds_read_b64_tr_b16 v[182:183], v5 offset:12800
  v_mfma_f32_16x16x32_bf16 v[156:159], v[204:207], v[224:227], v[156:159]
  ds_read_b64_tr_b16 v[184:185], v2 offset:13312
  s_waitcnt lgkmcnt(14)
  v_mfma_f32_16x16x32_bf16 v[64:67], v[208:211], v[216:219], v[64:67]
  ds_read_b64_tr_b16 v[186:187], v2 offset:13824
  v_mfma_f32_16x16x32_bf16 v[112:115], v[208:211], v[220:223], v[112:115]
  ds_read_b64_tr_b16 v[188:189], v3 offset:13312
  v_mfma_f32_16x16x32_bf16 v[160:163], v[208:211], v[224:227], v[160:163]
  ds_read_b64_tr_b16 v[190:191], v3 offset:13824
  s_waitcnt lgkmcnt(15)
  v_mfma_f32_16x16x32_bf16 v[68:71], v[212:215], v[216:219], v[68:71]
  v_mfma_f32_16x16x32_bf16 v[116:119], v[212:215], v[220:223], v[116:119]
  v_mfma_f32_16x16x32_bf16 v[164:167], v[212:215], v[224:227], v[164:167]
  s_waitcnt lgkmcnt(12)
  v_mfma_f32_16x16x32_bf16 v[24:27], v[168:171], v[228:231], v[24:27]
  ds_read_b64_tr_b16 v[192:193], v4 offset:13312
  ds_read_b64_tr_b16 v[194:195], v4 offset:13824
  s_waitcnt lgkmcnt(13)
  v_mfma_f32_16x16x32_bf16 v[72:75], v[168:171], v[232:235], v[72:75]
  ds_read_b64_tr_b16 v[196:197], v5 offset:13312
  s_waitcnt lgkmcnt(13)
  v_mfma_f32_16x16x32_bf16 v[120:123], v[168:171], v[236:239], v[120:123]
  ds_read_b64_tr_b16 v[198:199], v5 offset:13824
  ds_read_b64_tr_b16 v[200:201], v2 offset:14336
  s_waitcnt lgkmcnt(13)
  v_mfma_f32_16x16x32_bf16 v[28:31], v[172:175], v[228:231], v[28:31]
  ds_read_b64_tr_b16 v[202:203], v2 offset:14848
  v_mfma_f32_16x16x32_bf16 v[76:79], v[172:175], v[232:235], v[76:79]
  ds_read_b64_tr_b16 v[204:205], v3 offset:14336
  ds_read_b64_tr_b16 v[206:207], v3 offset:14848
  v_mfma_f32_16x16x32_bf16 v[124:127], v[172:175], v[236:239], v[124:127]
  ds_read_b64_tr_b16 v[208:209], v4 offset:14336
  s_waitcnt lgkmcnt(15)
  v_mfma_f32_16x16x32_bf16 v[32:35], v[176:179], v[228:231], v[32:35]
  ds_read_b64_tr_b16 v[210:211], v4 offset:14848
  ds_read_b64_tr_b16 v[212:213], v5 offset:14336
  v_mfma_f32_16x16x32_bf16 v[80:83], v[176:179], v[232:235], v[80:83]
  ds_read_b64_tr_b16 v[214:215], v5 offset:14848
  v_mfma_f32_16x16x32_bf16 v[128:131], v[176:179], v[236:239], v[128:131]
  s_waitcnt lgkmcnt(15)
  v_mfma_f32_16x16x32_bf16 v[36:39], v[180:183], v[228:231], v[36:39]
  v_mfma_f32_16x16x32_bf16 v[84:87], v[180:183], v[232:235], v[84:87]
  v_add_u32 v2, 0xc000, v2
  v_mfma_f32_16x16x32_bf16 v[132:135], v[180:183], v[236:239], v[132:135]
  v_add_u32 v3, 0xc000, v3
  s_waitcnt lgkmcnt(14)
  v_mfma_f32_16x16x32_bf16 v[40:43], v[184:187], v[228:231], v[40:43]
  v_add_u32 v4, 0xc000, v4
  v_mfma_f32_16x16x32_bf16 v[88:91], v[184:187], v[232:235], v[88:91]
  v_add_u32 v5, 0xc000, v5
  v_mfma_f32_16x16x32_bf16 v[136:139], v[184:187], v[236:239], v[136:139]
  v_add_u32 v6, 0xc000, v6
  s_waitcnt lgkmcnt(12)
  v_mfma_f32_16x16x32_bf16 v[44:47], v[188:191], v[228:231], v[44:47]
  v_add_u32 v7, 0xc000, v7
  v_mfma_f32_16x16x32_bf16 v[92:95], v[188:191], v[232:235], v[92:95]
  v_mfma_f32_16x16x32_bf16 v[140:143], v[188:191], v[236:239], v[140:143]
  s_waitcnt lgkmcnt(0)
  s_barrier
  v_mfma_f32_16x16x32_bf16 v[48:51], v[192:195], v[228:231], v[48:51]
  ds_read_b64_tr_b16 v[168:169], v2
  v_mfma_f32_16x16x32_bf16 v[96:99], v[192:195], v[232:235], v[96:99]
  ds_read_b64_tr_b16 v[170:171], v2 offset:512
  v_mfma_f32_16x16x32_bf16 v[144:147], v[192:195], v[236:239], v[144:147]
  ds_read_b128 v[216:219], v6
  v_mfma_f32_16x16x32_bf16 v[52:55], v[196:199], v[228:231], v[52:55]
  ds_read_b128 v[220:223], v6 offset:2048
  v_mfma_f32_16x16x32_bf16 v[100:103], v[196:199], v[232:235], v[100:103]
  ds_read_b128 v[224:227], v6 offset:4096
  v_mfma_f32_16x16x32_bf16 v[148:151], v[196:199], v[236:239], v[148:151]
  ds_read_b64_tr_b16 v[172:173], v3
  v_mfma_f32_16x16x32_bf16 v[56:59], v[200:203], v[228:231], v[56:59]
  ds_read_b64_tr_b16 v[174:175], v3 offset:512
  v_mfma_f32_16x16x32_bf16 v[104:107], v[200:203], v[232:235], v[104:107]
  ds_read_b64_tr_b16 v[176:177], v4
  v_mfma_f32_16x16x32_bf16 v[152:155], v[200:203], v[236:239], v[152:155]
  ds_read_b64_tr_b16 v[178:179], v4 offset:512
  v_mfma_f32_16x16x32_bf16 v[60:63], v[204:207], v[228:231], v[60:63]
  ds_read_b64_tr_b16 v[180:181], v5
  v_mfma_f32_16x16x32_bf16 v[108:111], v[204:207], v[232:235], v[108:111]
  ds_read_b64_tr_b16 v[182:183], v5 offset:512
  v_mfma_f32_16x16x32_bf16 v[156:159], v[204:207], v[236:239], v[156:159]
  ds_read_b64_tr_b16 v[184:185], v2 offset:1024
  v_mfma_f32_16x16x32_bf16 v[64:67], v[208:211], v[228:231], v[64:67]
  ds_read_b64_tr_b16 v[186:187], v2 offset:1536
  v_mfma_f32_16x16x32_bf16 v[112:115], v[208:211], v[232:235], v[112:115]
  ds_read_b64_tr_b16 v[188:189], v3 offset:1024
  v_mfma_f32_16x16x32_bf16 v[160:163], v[208:211], v[236:239], v[160:163]
  ds_read_b64_tr_b16 v[190:191], v3 offset:1536
  v_mfma_f32_16x16x32_bf16 v[68:71], v[212:215], v[228:231], v[68:71]
  v_mfma_f32_16x16x32_bf16 v[116:119], v[212:215], v[232:235], v[116:119]
  v_mfma_f32_16x16x32_bf16 v[164:167], v[212:215], v[236:239], v[164:167]
  s_waitcnt lgkmcnt(12)
  v_mfma_f32_16x16x32_bf16 v[24:27], v[168:171], v[216:219], v[24:27]
  ds_read_b64_tr_b16 v[192:193], v4 offset:1024
  s_waitcnt lgkmcnt(12)
  v_mfma_f32_16x16x32_bf16 v[72:75], v[168:171], v[220:223], v[72:75]
  ds_read_b64_tr_b16 v[194:195], v4 offset:1536
  s_waitcnt lgkmcnt(12)
  v_mfma_f32_16x16x32_bf16 v[120:123], v[168:171], v[224:227], v[120:123]
  ds_read_b64_tr_b16 v[196:197], v5 offset:1024
  s_waitcnt lgkmcnt(11)
  v_mfma_f32_16x16x32_bf16 v[28:31], v[172:175], v[216:219], v[28:31]
  ds_read_b64_tr_b16 v[198:199], v5 offset:1536
  v_mfma_f32_16x16x32_bf16 v[76:79], v[172:175], v[220:223], v[76:79]
  ds_read_b64_tr_b16 v[200:201], v2 offset:2048
  v_mfma_f32_16x16x32_bf16 v[124:127], v[172:175], v[224:227], v[124:127]
  ds_read_b64_tr_b16 v[202:203], v2 offset:2560
  s_waitcnt lgkmcnt(12)
  v_mfma_f32_16x16x32_bf16 v[32:35], v[176:179], v[216:219], v[32:35]
  ds_read_b64_tr_b16 v[204:205], v3 offset:2048
  v_mfma_f32_16x16x32_bf16 v[80:83], v[176:179], v[220:223], v[80:83]
  ds_read_b64_tr_b16 v[206:207], v3 offset:2560
  v_mfma_f32_16x16x32_bf16 v[128:131], v[176:179], v[224:227], v[128:131]
  ds_read_b64_tr_b16 v[208:209], v4 offset:2048
  s_waitcnt lgkmcnt(13)
  v_mfma_f32_16x16x32_bf16 v[36:39], v[180:183], v[216:219], v[36:39]
  ds_read_b64_tr_b16 v[210:211], v4 offset:2560
  v_mfma_f32_16x16x32_bf16 v[84:87], v[180:183], v[220:223], v[84:87]
  ds_read_b64_tr_b16 v[212:213], v5 offset:2048
  v_mfma_f32_16x16x32_bf16 v[132:135], v[180:183], v[224:227], v[132:135]
  ds_read_b64_tr_b16 v[214:215], v5 offset:2560
  s_waitcnt lgkmcnt(14)
  v_mfma_f32_16x16x32_bf16 v[40:43], v[184:187], v[216:219], v[40:43]
  v_mfma_f32_16x16x32_bf16 v[88:91], v[184:187], v[220:223], v[88:91]
  v_mfma_f32_16x16x32_bf16 v[136:139], v[184:187], v[224:227], v[136:139]
  s_waitcnt lgkmcnt(12)
  v_mfma_f32_16x16x32_bf16 v[44:47], v[188:191], v[216:219], v[44:47]
  v_mfma_f32_16x16x32_bf16 v[92:95], v[188:191], v[220:223], v[92:95]
  v_mfma_f32_16x16x32_bf16 v[140:143], v[188:191], v[224:227], v[140:143]
  s_waitcnt lgkmcnt(10)
  v_mfma_f32_16x16x32_bf16 v[48:51], v[192:195], v[216:219], v[48:51]
  ds_read_b64_tr_b16 v[168:169], v2 offset:12288
  v_mfma_f32_16x16x32_bf16 v[96:99], v[192:195], v[220:223], v[96:99]
  ds_read_b64_tr_b16 v[170:171], v2 offset:12800
  v_mfma_f32_16x16x32_bf16 v[144:147], v[192:195], v[224:227], v[144:147]
  ds_read_b128 v[228:231], v7
  s_waitcnt lgkmcnt(11)
  v_mfma_f32_16x16x32_bf16 v[52:55], v[196:199], v[216:219], v[52:55]
  ds_read_b128 v[232:235], v7 offset:2048
  v_mfma_f32_16x16x32_bf16 v[100:103], v[196:199], v[220:223], v[100:103]
  ds_read_b128 v[236:239], v7 offset:4096
  v_mfma_f32_16x16x32_bf16 v[148:151], v[196:199], v[224:227], v[148:151]
  ds_read_b64_tr_b16 v[172:173], v3 offset:12288
  s_waitcnt lgkmcnt(12)
  v_mfma_f32_16x16x32_bf16 v[56:59], v[200:203], v[216:219], v[56:59]
  ds_read_b64_tr_b16 v[174:175], v3 offset:12800
  v_mfma_f32_16x16x32_bf16 v[104:107], v[200:203], v[220:223], v[104:107]
  ds_read_b64_tr_b16 v[176:177], v4 offset:12288
  v_mfma_f32_16x16x32_bf16 v[152:155], v[200:203], v[224:227], v[152:155]
  ds_read_b64_tr_b16 v[178:179], v4 offset:12800
  s_waitcnt lgkmcnt(13)
  v_mfma_f32_16x16x32_bf16 v[60:63], v[204:207], v[216:219], v[60:63]
  ds_read_b64_tr_b16 v[180:181], v5 offset:12288
  v_mfma_f32_16x16x32_bf16 v[108:111], v[204:207], v[220:223], v[108:111]
  ds_read_b64_tr_b16 v[182:183], v5 offset:12800
  v_mfma_f32_16x16x32_bf16 v[156:159], v[204:207], v[224:227], v[156:159]
  ds_read_b64_tr_b16 v[184:185], v2 offset:13312
  s_waitcnt lgkmcnt(14)
  v_mfma_f32_16x16x32_bf16 v[64:67], v[208:211], v[216:219], v[64:67]
  ds_read_b64_tr_b16 v[186:187], v2 offset:13824
  v_mfma_f32_16x16x32_bf16 v[112:115], v[208:211], v[220:223], v[112:115]
  ds_read_b64_tr_b16 v[188:189], v3 offset:13312
  v_mfma_f32_16x16x32_bf16 v[160:163], v[208:211], v[224:227], v[160:163]
  ds_read_b64_tr_b16 v[190:191], v3 offset:13824
  s_waitcnt lgkmcnt(15)
  v_mfma_f32_16x16x32_bf16 v[68:71], v[212:215], v[216:219], v[68:71]
  v_mfma_f32_16x16x32_bf16 v[116:119], v[212:215], v[220:223], v[116:119]
  v_mfma_f32_16x16x32_bf16 v[164:167], v[212:215], v[224:227], v[164:167]
  s_waitcnt lgkmcnt(12)
  v_mfma_f32_16x16x32_bf16 v[24:27], v[168:171], v[228:231], v[24:27]
  ds_read_b64_tr_b16 v[192:193], v4 offset:13312
  ds_read_b64_tr_b16 v[194:195], v4 offset:13824
  s_waitcnt lgkmcnt(13)
  v_mfma_f32_16x16x32_bf16 v[72:75], v[168:171], v[232:235], v[72:75]
  ds_read_b64_tr_b16 v[196:197], v5 offset:13312
  s_waitcnt lgkmcnt(13)
  v_mfma_f32_16x16x32_bf16 v[120:123], v[168:171], v[236:239], v[120:123]
  ds_read_b64_tr_b16 v[198:199], v5 offset:13824
  ds_read_b64_tr_b16 v[200:201], v2 offset:14336
  s_waitcnt lgkmcnt(13)
  v_mfma_f32_16x16x32_bf16 v[28:31], v[172:175], v[228:231], v[28:31]
  ds_read_b64_tr_b16 v[202:203], v2 offset:14848
  v_mfma_f32_16x16x32_bf16 v[76:79], v[172:175], v[232:235], v[76:79]
  ds_read_b64_tr_b16 v[204:205], v3 offset:14336
  ds_read_b64_tr_b16 v[206:207], v3 offset:14848
  v_mfma_f32_16x16x32_bf16 v[124:127], v[172:175], v[236:239], v[124:127]
  ds_read_b64_tr_b16 v[208:209], v4 offset:14336
  s_waitcnt lgkmcnt(15)
  v_mfma_f32_16x16x32_bf16 v[32:35], v[176:179], v[228:231], v[32:35]
  ds_read_b64_tr_b16 v[210:211], v4 offset:14848
  ds_read_b64_tr_b16 v[212:213], v5 offset:14336
  v_mfma_f32_16x16x32_bf16 v[80:83], v[176:179], v[232:235], v[80:83]
  ds_read_b64_tr_b16 v[214:215], v5 offset:14848
  v_mfma_f32_16x16x32_bf16 v[128:131], v[176:179], v[236:239], v[128:131]
  s_waitcnt lgkmcnt(15)
  v_mfma_f32_16x16x32_bf16 v[36:39], v[180:183], v[228:231], v[36:39]
  v_mfma_f32_16x16x32_bf16 v[84:87], v[180:183], v[232:235], v[84:87]
  v_add_u32 v2, 0xc000, v2
  v_mfma_f32_16x16x32_bf16 v[132:135], v[180:183], v[236:239], v[132:135]
  v_add_u32 v3, 0xc000, v3
  s_waitcnt lgkmcnt(14)
  v_mfma_f32_16x16x32_bf16 v[40:43], v[184:187], v[228:231], v[40:43]
  v_add_u32 v4, 0xc000, v4
  v_mfma_f32_16x16x32_bf16 v[88:91], v[184:187], v[232:235], v[88:91]
  v_add_u32 v5, 0xc000, v5
  v_mfma_f32_16x16x32_bf16 v[136:139], v[184:187], v[236:239], v[136:139]
  v_add_u32 v6, 0xc000, v6
  s_waitcnt lgkmcnt(12)
  v_mfma_f32_16x16x32_bf16 v[44:47], v[188:191], v[228:231], v[44:47]
  v_add_u32 v7, 0xc000, v7
  v_mfma_f32_16x16x32_bf16 v[92:95], v[188:191], v[232:235], v[92:95]
  v_mfma_f32_16x16x32_bf16 v[140:143], v[188:191], v[236:239], v[140:143]
  s_waitcnt lgkmcnt(0)
  s_barrier
  v_mfma_f32_16x16x32_bf16 v[48:51], v[192:195], v[228:231], v[48:51]
  ds_read_b64_tr_b16 v[168:169], v2
  v_mfma_f32_16x16x32_bf16 v[96:99], v[192:195], v[232:235], v[96:99]
  ds_read_b64_tr_b16 v[170:171], v2 offset:512
  v_mfma_f32_16x16x32_bf16 v[144:147], v[192:195], v[236:239], v[144:147]
  ds_read_b128 v[216:219], v6
  v_mfma_f32_16x16x32_bf16 v[52:55], v[196:199], v[228:231], v[52:55]
  ds_read_b128 v[220:223], v6 offset:2048
  v_mfma_f32_16x16x32_bf16 v[100:103], v[196:199], v[232:235], v[100:103]
  ds_read_b128 v[224:227], v6 offset:4096
  v_mfma_f32_16x16x32_bf16 v[148:151], v[196:199], v[236:239], v[148:151]
  ds_read_b64_tr_b16 v[172:173], v3
  v_mfma_f32_16x16x32_bf16 v[56:59], v[200:203], v[228:231], v[56:59]
  ds_read_b64_tr_b16 v[174:175], v3 offset:512
  v_mfma_f32_16x16x32_bf16 v[104:107], v[200:203], v[232:235], v[104:107]
  ds_read_b64_tr_b16 v[176:177], v4
  v_mfma_f32_16x16x32_bf16 v[152:155], v[200:203], v[236:239], v[152:155]
  ds_read_b64_tr_b16 v[178:179], v4 offset:512
  v_mfma_f32_16x16x32_bf16 v[60:63], v[204:207], v[228:231], v[60:63]
  ds_read_b64_tr_b16 v[180:181], v5
  v_mfma_f32_16x16x32_bf16 v[108:111], v[204:207], v[232:235], v[108:111]
  ds_read_b64_tr_b16 v[182:183], v5 offset:512
  v_mfma_f32_16x16x32_bf16 v[156:159], v[204:207], v[236:239], v[156:159]
  ds_read_b64_tr_b16 v[184:185], v2 offset:1024
  v_mfma_f32_16x16x32_bf16 v[64:67], v[208:211], v[228:231], v[64:67]
  ds_read_b64_tr_b16 v[186:187], v2 offset:1536
  v_mfma_f32_16x16x32_bf16 v[112:115], v[208:211], v[232:235], v[112:115]
  ds_read_b64_tr_b16 v[188:189], v3 offset:1024
  v_mfma_f32_16x16x32_bf16 v[160:163], v[208:211], v[236:239], v[160:163]
  ds_read_b64_tr_b16 v[190:191], v3 offset:1536
  v_mfma_f32_16x16x32_bf16 v[68:71], v[212:215], v[228:231], v[68:71]
  v_mfma_f32_16x16x32_bf16 v[116:119], v[212:215], v[232:235], v[116:119]
  v_mfma_f32_16x16x32_bf16 v[164:167], v[212:215], v[236:239], v[164:167]
  s_waitcnt lgkmcnt(12)
  v_mfma_f32_16x16x32_bf16 v[24:27], v[168:171], v[216:219], v[24:27]
  ds_read_b64_tr_b16 v[192:193], v4 offset:1024
  s_waitcnt lgkmcnt(12)
  v_mfma_f32_16x16x32_bf16 v[72:75], v[168:171], v[220:223], v[72:75]
  ds_read_b64_tr_b16 v[194:195], v4 offset:1536
  s_waitcnt lgkmcnt(12)
  v_mfma_f32_16x16x32_bf16 v[120:123], v[168:171], v[224:227], v[120:123]
  ds_read_b64_tr_b16 v[196:197], v5 offset:1024
  s_waitcnt lgkmcnt(11)
  v_mfma_f32_16x16x32_bf16 v[28:31], v[172:175], v[216:219], v[28:31]
  ds_read_b64_tr_b16 v[198:199], v5 offset:1536
  v_mfma_f32_16x16x32_bf16 v[76:79], v[172:175], v[220:223], v[76:79]
  ds_read_b64_tr_b16 v[200:201], v2 offset:2048
  v_mfma_f32_16x16x32_bf16 v[124:127], v[172:175], v[224:227], v[124:127]
  ds_read_b64_tr_b16 v[202:203], v2 offset:2560
  s_waitcnt lgkmcnt(12)
  v_mfma_f32_16x16x32_bf16 v[32:35], v[176:179], v[216:219], v[32:35]
  ds_read_b64_tr_b16 v[204:205], v3 offset:2048
  v_mfma_f32_16x16x32_bf16 v[80:83], v[176:179], v[220:223], v[80:83]
  ds_read_b64_tr_b16 v[206:207], v3 offset:2560
  v_mfma_f32_16x16x32_bf16 v[128:131], v[176:179], v[224:227], v[128:131]
  ds_read_b64_tr_b16 v[208:209], v4 offset:2048
  s_waitcnt lgkmcnt(13)
  v_mfma_f32_16x16x32_bf16 v[36:39], v[180:183], v[216:219], v[36:39]
  ds_read_b64_tr_b16 v[210:211], v4 offset:2560
  v_mfma_f32_16x16x32_bf16 v[84:87], v[180:183], v[220:223], v[84:87]
  ds_read_b64_tr_b16 v[212:213], v5 offset:2048
  v_mfma_f32_16x16x32_bf16 v[132:135], v[180:183], v[224:227], v[132:135]
  ds_read_b64_tr_b16 v[214:215], v5 offset:2560
  s_waitcnt lgkmcnt(14)
  v_mfma_f32_16x16x32_bf16 v[40:43], v[184:187], v[216:219], v[40:43]
  v_mfma_f32_16x16x32_bf16 v[88:91], v[184:187], v[220:223], v[88:91]
  v_mfma_f32_16x16x32_bf16 v[136:139], v[184:187], v[224:227], v[136:139]
  s_waitcnt lgkmcnt(12)
  v_mfma_f32_16x16x32_bf16 v[44:47], v[188:191], v[216:219], v[44:47]
  v_mfma_f32_16x16x32_bf16 v[92:95], v[188:191], v[220:223], v[92:95]
  v_mfma_f32_16x16x32_bf16 v[140:143], v[188:191], v[224:227], v[140:143]
  s_waitcnt lgkmcnt(10)
  v_mfma_f32_16x16x32_bf16 v[48:51], v[192:195], v[216:219], v[48:51]
  ds_read_b64_tr_b16 v[168:169], v2 offset:12288
  v_mfma_f32_16x16x32_bf16 v[96:99], v[192:195], v[220:223], v[96:99]
  ds_read_b64_tr_b16 v[170:171], v2 offset:12800
  v_mfma_f32_16x16x32_bf16 v[144:147], v[192:195], v[224:227], v[144:147]
  ds_read_b128 v[228:231], v7
  s_waitcnt lgkmcnt(11)
  v_mfma_f32_16x16x32_bf16 v[52:55], v[196:199], v[216:219], v[52:55]
  ds_read_b128 v[232:235], v7 offset:2048
  v_mfma_f32_16x16x32_bf16 v[100:103], v[196:199], v[220:223], v[100:103]
  ds_read_b128 v[236:239], v7 offset:4096
  v_mfma_f32_16x16x32_bf16 v[148:151], v[196:199], v[224:227], v[148:151]
  ds_read_b64_tr_b16 v[172:173], v3 offset:12288
  s_waitcnt lgkmcnt(12)
  v_mfma_f32_16x16x32_bf16 v[56:59], v[200:203], v[216:219], v[56:59]
  ds_read_b64_tr_b16 v[174:175], v3 offset:12800
  v_mfma_f32_16x16x32_bf16 v[104:107], v[200:203], v[220:223], v[104:107]
  ds_read_b64_tr_b16 v[176:177], v4 offset:12288
  v_mfma_f32_16x16x32_bf16 v[152:155], v[200:203], v[224:227], v[152:155]
  ds_read_b64_tr_b16 v[178:179], v4 offset:12800
  s_waitcnt lgkmcnt(13)
  v_mfma_f32_16x16x32_bf16 v[60:63], v[204:207], v[216:219], v[60:63]
  ds_read_b64_tr_b16 v[180:181], v5 offset:12288
  v_mfma_f32_16x16x32_bf16 v[108:111], v[204:207], v[220:223], v[108:111]
  ds_read_b64_tr_b16 v[182:183], v5 offset:12800
  v_mfma_f32_16x16x32_bf16 v[156:159], v[204:207], v[224:227], v[156:159]
  ds_read_b64_tr_b16 v[184:185], v2 offset:13312
  s_waitcnt lgkmcnt(14)
  v_mfma_f32_16x16x32_bf16 v[64:67], v[208:211], v[216:219], v[64:67]
  ds_read_b64_tr_b16 v[186:187], v2 offset:13824
  v_mfma_f32_16x16x32_bf16 v[112:115], v[208:211], v[220:223], v[112:115]
  ds_read_b64_tr_b16 v[188:189], v3 offset:13312
  v_mfma_f32_16x16x32_bf16 v[160:163], v[208:211], v[224:227], v[160:163]
  ds_read_b64_tr_b16 v[190:191], v3 offset:13824
  s_waitcnt lgkmcnt(15)
  v_mfma_f32_16x16x32_bf16 v[68:71], v[212:215], v[216:219], v[68:71]
  v_mfma_f32_16x16x32_bf16 v[116:119], v[212:215], v[220:223], v[116:119]
  v_mfma_f32_16x16x32_bf16 v[164:167], v[212:215], v[224:227], v[164:167]
  s_waitcnt lgkmcnt(12)
  v_mfma_f32_16x16x32_bf16 v[24:27], v[168:171], v[228:231], v[24:27]
  ds_read_b64_tr_b16 v[192:193], v4 offset:13312
  ds_read_b64_tr_b16 v[194:195], v4 offset:13824
  s_waitcnt lgkmcnt(13)
  v_mfma_f32_16x16x32_bf16 v[72:75], v[168:171], v[232:235], v[72:75]
  ds_read_b64_tr_b16 v[196:197], v5 offset:13312
  s_waitcnt lgkmcnt(13)
  v_mfma_f32_16x16x32_bf16 v[120:123], v[168:171], v[236:239], v[120:123]
  ds_read_b64_tr_b16 v[198:199], v5 offset:13824
  ds_read_b64_tr_b16 v[200:201], v2 offset:14336
  s_waitcnt lgkmcnt(13)
  v_mfma_f32_16x16x32_bf16 v[28:31], v[172:175], v[228:231], v[28:31]
  ds_read_b64_tr_b16 v[202:203], v2 offset:14848
  v_mfma_f32_16x16x32_bf16 v[76:79], v[172:175], v[232:235], v[76:79]
  ds_read_b64_tr_b16 v[204:205], v3 offset:14336
  ds_read_b64_tr_b16 v[206:207], v3 offset:14848
  v_mfma_f32_16x16x32_bf16 v[124:127], v[172:175], v[236:239], v[124:127]
  ds_read_b64_tr_b16 v[208:209], v4 offset:14336
  s_waitcnt lgkmcnt(15)
  v_mfma_f32_16x16x32_bf16 v[32:35], v[176:179], v[228:231], v[32:35]
  ds_read_b64_tr_b16 v[210:211], v4 offset:14848
  ds_read_b64_tr_b16 v[212:213], v5 offset:14336
  v_mfma_f32_16x16x32_bf16 v[80:83], v[176:179], v[232:235], v[80:83]
  ds_read_b64_tr_b16 v[214:215], v5 offset:14848
  v_mfma_f32_16x16x32_bf16 v[128:131], v[176:179], v[236:239], v[128:131]
  s_waitcnt lgkmcnt(15)
  v_mfma_f32_16x16x32_bf16 v[36:39], v[180:183], v[228:231], v[36:39]
  v_mfma_f32_16x16x32_bf16 v[84:87], v[180:183], v[232:235], v[84:87]
  v_add_u32 v2, 0xfffe8000, v2
  v_mfma_f32_16x16x32_bf16 v[132:135], v[180:183], v[236:239], v[132:135]
  v_add_u32 v3, 0xfffe8000, v3
  s_waitcnt lgkmcnt(14)
  v_mfma_f32_16x16x32_bf16 v[40:43], v[184:187], v[228:231], v[40:43]
  v_add_u32 v4, 0xfffe8000, v4
  v_mfma_f32_16x16x32_bf16 v[88:91], v[184:187], v[232:235], v[88:91]
  v_add_u32 v5, 0xfffe8000, v5
  v_mfma_f32_16x16x32_bf16 v[136:139], v[184:187], v[236:239], v[136:139]
  v_add_u32 v6, 0xfffe8000, v6
  s_waitcnt lgkmcnt(12)
  v_mfma_f32_16x16x32_bf16 v[44:47], v[188:191], v[228:231], v[44:47]
  v_add_u32 v7, 0xfffe8000, v7
  v_mfma_f32_16x16x32_bf16 v[92:95], v[188:191], v[232:235], v[92:95]
  v_mfma_f32_16x16x32_bf16 v[140:143], v[188:191], v[236:239], v[140:143]
  s_waitcnt lgkmcnt(0)
  s_barrier
  v_mfma_f32_16x16x32_bf16 v[48:51], v[192:195], v[228:231], v[48:51]
  ds_read_b64_tr_b16 v[168:169], v2
  v_mfma_f32_16x16x32_bf16 v[96:99], v[192:195], v[232:235], v[96:99]
  ds_read_b64_tr_b16 v[170:171], v2 offset:512
  v_mfma_f32_16x16x32_bf16 v[144:147], v[192:195], v[236:239], v[144:147]
  ds_read_b128 v[216:219], v6
  v_mfma_f32_16x16x32_bf16 v[52:55], v[196:199], v[228:231], v[52:55]
  ds_read_b128 v[220:223], v6 offset:2048
  v_mfma_f32_16x16x32_bf16 v[100:103], v[196:199], v[232:235], v[100:103]
  ds_read_b128 v[224:227], v6 offset:4096
  v_mfma_f32_16x16x32_bf16 v[148:151], v[196:199], v[236:239], v[148:151]
  ds_read_b64_tr_b16 v[172:173], v3
  v_mfma_f32_16x16x32_bf16 v[56:59], v[200:203], v[228:231], v[56:59]
  ds_read_b64_tr_b16 v[174:175], v3 offset:512
  v_mfma_f32_16x16x32_bf16 v[104:107], v[200:203], v[232:235], v[104:107]
  ds_read_b64_tr_b16 v[176:177], v4
  v_mfma_f32_16x16x32_bf16 v[152:155], v[200:203], v[236:239], v[152:155]
  ds_read_b64_tr_b16 v[178:179], v4 offset:512
  v_mfma_f32_16x16x32_bf16 v[60:63], v[204:207], v[228:231], v[60:63]
  ds_read_b64_tr_b16 v[180:181], v5
  v_mfma_f32_16x16x32_bf16 v[108:111], v[204:207], v[232:235], v[108:111]
  ds_read_b64_tr_b16 v[182:183], v5 offset:512
  v_mfma_f32_16x16x32_bf16 v[156:159], v[204:207], v[236:239], v[156:159]
  ds_read_b64_tr_b16 v[184:185], v2 offset:1024
  v_mfma_f32_16x16x32_bf16 v[64:67], v[208:211], v[228:231], v[64:67]
  ds_read_b64_tr_b16 v[186:187], v2 offset:1536
  v_mfma_f32_16x16x32_bf16 v[112:115], v[208:211], v[232:235], v[112:115]
  ds_read_b64_tr_b16 v[188:189], v3 offset:1024
  v_mfma_f32_16x16x32_bf16 v[160:163], v[208:211], v[236:239], v[160:163]
  ds_read_b64_tr_b16 v[190:191], v3 offset:1536
  v_mfma_f32_16x16x32_bf16 v[68:71], v[212:215], v[228:231], v[68:71]
  v_mfma_f32_16x16x32_bf16 v[116:119], v[212:215], v[232:235], v[116:119]
  v_mfma_f32_16x16x32_bf16 v[164:167], v[212:215], v[236:239], v[164:167]
  s_waitcnt lgkmcnt(12)
  v_mfma_f32_16x16x32_bf16 v[24:27], v[168:171], v[216:219], v[24:27]
  ds_read_b64_tr_b16 v[192:193], v4 offset:1024
  s_waitcnt lgkmcnt(12)
  v_mfma_f32_16x16x32_bf16 v[72:75], v[168:171], v[220:223], v[72:75]
  ds_read_b64_tr_b16 v[194:195], v4 offset:1536
  s_waitcnt lgkmcnt(12)
  v_mfma_f32_16x16x32_bf16 v[120:123], v[168:171], v[224:227], v[120:123]
  ds_read_b64_tr_b16 v[196:197], v5 offset:1024
  s_waitcnt lgkmcnt(11)
  v_mfma_f32_16x16x32_bf16 v[28:31], v[172:175], v[216:219], v[28:31]
  ds_read_b64_tr_b16 v[198:199], v5 offset:1536
  v_mfma_f32_16x16x32_bf16 v[76:79], v[172:175], v[220:223], v[76:79]
  ds_read_b64_tr_b16 v[200:201], v2 offset:2048
  v_mfma_f32_16x16x32_bf16 v[124:127], v[172:175], v[224:227], v[124:127]
  ds_read_b64_tr_b16 v[202:203], v2 offset:2560
  s_waitcnt lgkmcnt(12)
  v_mfma_f32_16x16x32_bf16 v[32:35], v[176:179], v[216:219], v[32:35]
  ds_read_b64_tr_b16 v[204:205], v3 offset:2048
  v_mfma_f32_16x16x32_bf16 v[80:83], v[176:179], v[220:223], v[80:83]
  ds_read_b64_tr_b16 v[206:207], v3 offset:2560
  v_mfma_f32_16x16x32_bf16 v[128:131], v[176:179], v[224:227], v[128:131]
  ds_read_b64_tr_b16 v[208:209], v4 offset:2048
  s_waitcnt lgkmcnt(13)
  v_mfma_f32_16x16x32_bf16 v[36:39], v[180:183], v[216:219], v[36:39]
  ds_read_b64_tr_b16 v[210:211], v4 offset:2560
  v_mfma_f32_16x16x32_bf16 v[84:87], v[180:183], v[220:223], v[84:87]
  ds_read_b64_tr_b16 v[212:213], v5 offset:2048
  v_mfma_f32_16x16x32_bf16 v[132:135], v[180:183], v[224:227], v[132:135]
  ds_read_b64_tr_b16 v[214:215], v5 offset:2560
  s_waitcnt lgkmcnt(14)
  v_mfma_f32_16x16x32_bf16 v[40:43], v[184:187], v[216:219], v[40:43]
  v_mfma_f32_16x16x32_bf16 v[88:91], v[184:187], v[220:223], v[88:91]
  v_mfma_f32_16x16x32_bf16 v[136:139], v[184:187], v[224:227], v[136:139]
  s_waitcnt lgkmcnt(12)
  v_mfma_f32_16x16x32_bf16 v[44:47], v[188:191], v[216:219], v[44:47]
  v_mfma_f32_16x16x32_bf16 v[92:95], v[188:191], v[220:223], v[92:95]
  v_mfma_f32_16x16x32_bf16 v[140:143], v[188:191], v[224:227], v[140:143]
  s_waitcnt lgkmcnt(10)
  v_mfma_f32_16x16x32_bf16 v[48:51], v[192:195], v[216:219], v[48:51]
  ds_read_b64_tr_b16 v[168:169], v2 offset:12288
  v_mfma_f32_16x16x32_bf16 v[96:99], v[192:195], v[220:223], v[96:99]
  ds_read_b64_tr_b16 v[170:171], v2 offset:12800
  v_mfma_f32_16x16x32_bf16 v[144:147], v[192:195], v[224:227], v[144:147]
  ds_read_b128 v[228:231], v7
  s_waitcnt lgkmcnt(11)
  v_mfma_f32_16x16x32_bf16 v[52:55], v[196:199], v[216:219], v[52:55]
  ds_read_b128 v[232:235], v7 offset:2048
  v_mfma_f32_16x16x32_bf16 v[100:103], v[196:199], v[220:223], v[100:103]
  ds_read_b128 v[236:239], v7 offset:4096
  v_mfma_f32_16x16x32_bf16 v[148:151], v[196:199], v[224:227], v[148:151]
  ds_read_b64_tr_b16 v[172:173], v3 offset:12288
  s_waitcnt lgkmcnt(12)
  v_mfma_f32_16x16x32_bf16 v[56:59], v[200:203], v[216:219], v[56:59]
  ds_read_b64_tr_b16 v[174:175], v3 offset:12800
  v_mfma_f32_16x16x32_bf16 v[104:107], v[200:203], v[220:223], v[104:107]
  ds_read_b64_tr_b16 v[176:177], v4 offset:12288
  v_mfma_f32_16x16x32_bf16 v[152:155], v[200:203], v[224:227], v[152:155]
  ds_read_b64_tr_b16 v[178:179], v4 offset:12800
  s_waitcnt lgkmcnt(13)
  v_mfma_f32_16x16x32_bf16 v[60:63], v[204:207], v[216:219], v[60:63]
  ds_read_b64_tr_b16 v[180:181], v5 offset:12288
  v_mfma_f32_16x16x32_bf16 v[108:111], v[204:207], v[220:223], v[108:111]
  ds_read_b64_tr_b16 v[182:183], v5 offset:12800
  v_mfma_f32_16x16x32_bf16 v[156:159], v[204:207], v[224:227], v[156:159]
  ds_read_b64_tr_b16 v[184:185], v2 offset:13312
  s_waitcnt lgkmcnt(14)
  v_mfma_f32_16x16x32_bf16 v[64:67], v[208:211], v[216:219], v[64:67]
  ds_read_b64_tr_b16 v[186:187], v2 offset:13824
  v_mfma_f32_16x16x32_bf16 v[112:115], v[208:211], v[220:223], v[112:115]
  ds_read_b64_tr_b16 v[188:189], v3 offset:13312
  v_mfma_f32_16x16x32_bf16 v[160:163], v[208:211], v[224:227], v[160:163]
  ds_read_b64_tr_b16 v[190:191], v3 offset:13824
  s_waitcnt lgkmcnt(15)
  v_mfma_f32_16x16x32_bf16 v[68:71], v[212:215], v[216:219], v[68:71]
  v_mfma_f32_16x16x32_bf16 v[116:119], v[212:215], v[220:223], v[116:119]
  v_mfma_f32_16x16x32_bf16 v[164:167], v[212:215], v[224:227], v[164:167]
  s_waitcnt lgkmcnt(12)
  v_mfma_f32_16x16x32_bf16 v[24:27], v[168:171], v[228:231], v[24:27]
  ds_read_b64_tr_b16 v[192:193], v4 offset:13312
  ds_read_b64_tr_b16 v[194:195], v4 offset:13824
  s_waitcnt lgkmcnt(13)
  v_mfma_f32_16x16x32_bf16 v[72:75], v[168:171], v[232:235], v[72:75]
  ds_read_b64_tr_b16 v[196:197], v5 offset:13312
  s_waitcnt lgkmcnt(13)
  v_mfma_f32_16x16x32_bf16 v[120:123], v[168:171], v[236:239], v[120:123]
  ds_read_b64_tr_b16 v[198:199], v5 offset:13824
  ds_read_b64_tr_b16 v[200:201], v2 offset:14336
  s_waitcnt lgkmcnt(13)
  v_mfma_f32_16x16x32_bf16 v[28:31], v[172:175], v[228:231], v[28:31]
  ds_read_b64_tr_b16 v[202:203], v2 offset:14848
  v_mfma_f32_16x16x32_bf16 v[76:79], v[172:175], v[232:235], v[76:79]
  ds_read_b64_tr_b16 v[204:205], v3 offset:14336
  ds_read_b64_tr_b16 v[206:207], v3 offset:14848
  v_mfma_f32_16x16x32_bf16 v[124:127], v[172:175], v[236:239], v[124:127]
  ds_read_b64_tr_b16 v[208:209], v4 offset:14336
  s_waitcnt lgkmcnt(15)
  v_mfma_f32_16x16x32_bf16 v[32:35], v[176:179], v[228:231], v[32:35]
  ds_read_b64_tr_b16 v[210:211], v4 offset:14848
  ds_read_b64_tr_b16 v[212:213], v5 offset:14336
  v_mfma_f32_16x16x32_bf16 v[80:83], v[176:179], v[232:235], v[80:83]
  ds_read_b64_tr_b16 v[214:215], v5 offset:14848
  v_mfma_f32_16x16x32_bf16 v[128:131], v[176:179], v[236:239], v[128:131]
  s_waitcnt lgkmcnt(15)
  v_mfma_f32_16x16x32_bf16 v[36:39], v[180:183], v[228:231], v[36:39]
  v_mfma_f32_16x16x32_bf16 v[84:87], v[180:183], v[232:235], v[84:87]
  v_mfma_f32_16x16x32_bf16 v[132:135], v[180:183], v[236:239], v[132:135]
  s_waitcnt lgkmcnt(14)
  v_mfma_f32_16x16x32_bf16 v[40:43], v[184:187], v[228:231], v[40:43]
  v_mfma_f32_16x16x32_bf16 v[88:91], v[184:187], v[232:235], v[88:91]
  v_mfma_f32_16x16x32_bf16 v[136:139], v[184:187], v[236:239], v[136:139]
  s_waitcnt lgkmcnt(12)
  v_mfma_f32_16x16x32_bf16 v[44:47], v[188:191], v[228:231], v[44:47]
  v_mfma_f32_16x16x32_bf16 v[92:95], v[188:191], v[232:235], v[92:95]
  v_mfma_f32_16x16x32_bf16 v[140:143], v[188:191], v[236:239], v[140:143]
  s_waitcnt lgkmcnt(0)
  s_barrier
  v_mfma_f32_16x16x32_bf16 v[48:51], v[192:195], v[228:231], v[48:51]
  ds_read_b64 v[168:169], v8
  ds_read_b64 v[170:171], v9
  v_mfma_f32_16x16x32_bf16 v[96:99], v[192:195], v[232:235], v[96:99]
  ds_read_b64 v[172:173], v8 offset:2048
  v_mfma_f32_16x16x32_bf16 v[144:147], v[192:195], v[236:239], v[144:147]
  ds_read_b64 v[174:175], v9 offset:2048
  ds_read_b64 v[176:177], v8 offset:4096
  v_mfma_f32_16x16x32_bf16 v[52:55], v[196:199], v[228:231], v[52:55]
  ds_read_b64 v[178:179], v9 offset:4096
  v_mfma_f32_16x16x32_bf16 v[100:103], v[196:199], v[232:235], v[100:103]
  ds_read_b64 v[180:181], v10
  ds_read_b64 v[182:183], v11
  v_mfma_f32_16x16x32_bf16 v[148:151], v[196:199], v[236:239], v[148:151]
  ds_read_b64 v[184:185], v10 offset:2048
  v_mfma_f32_16x16x32_bf16 v[56:59], v[200:203], v[228:231], v[56:59]
  ds_read_b64 v[186:187], v11 offset:2048
  ds_read_b64 v[188:189], v10 offset:4096
  v_mfma_f32_16x16x32_bf16 v[104:107], v[200:203], v[232:235], v[104:107]
  ds_read_b64 v[190:191], v11 offset:4096
  v_mfma_f32_16x16x32_bf16 v[152:155], v[200:203], v[236:239], v[152:155]
  ds_read_b64 v[216:217], v8 offset:24576
  ds_read_b64 v[218:219], v9 offset:24576
  v_mfma_f32_16x16x32_bf16 v[60:63], v[204:207], v[228:231], v[60:63]
  ds_read_b64 v[220:221], v8 offset:26624
  v_mfma_f32_16x16x32_bf16 v[108:111], v[204:207], v[232:235], v[108:111]
  ds_read_b64 v[222:223], v9 offset:26624
  ds_read_b64 v[224:225], v8 offset:28672
  v_mfma_f32_16x16x32_bf16 v[156:159], v[204:207], v[236:239], v[156:159]
  ds_read_b64 v[226:227], v9 offset:28672
  v_mfma_f32_16x16x32_bf16 v[64:67], v[208:211], v[228:231], v[64:67]
  v_mfma_f32_16x16x32_bf16 v[112:115], v[208:211], v[232:235], v[112:115]
  ds_read_b64 v[192:193], v10 offset:24576
  ds_read_b64 v[194:195], v11 offset:24576
  v_mfma_f32_16x16x32_bf16 v[160:163], v[208:211], v[236:239], v[160:163]
  ds_read_b64 v[196:197], v10 offset:26624
  ds_read_b64 v[198:199], v11 offset:26624
  v_mfma_f32_16x16x32_bf16 v[68:71], v[212:215], v[228:231], v[68:71]
  ds_read_b64 v[200:201], v10 offset:28672
  ds_read_b64 v[202:203], v11 offset:28672
  v_mfma_f32_16x16x32_bf16 v[116:119], v[212:215], v[232:235], v[116:119]
  ds_read_b64 v[204:205], v8 offset:49152
  ds_read_b64 v[206:207], v9 offset:49152
  v_mfma_f32_16x16x32_bf16 v[164:167], v[212:215], v[236:239], v[164:167]
  ds_read_b64 v[208:209], v8 offset:51200
  ds_read_b64 v[210:211], v9 offset:51200
  ds_read_b64 v[212:213], v8 offset:53248
  ds_read_b64 v[214:215], v9 offset:53248
  ds_read_b64 v[228:229], v10 offset:49152
  ds_read_b64 v[230:231], v11 offset:49152
  ds_read_b64 v[232:233], v10 offset:51200
  ds_read_b64 v[234:235], v11 offset:51200
  ds_read_b64 v[236:237], v10 offset:53248
  ds_read_b64 v[238:239], v11 offset:53248
  v_cvt_pk_bf16_f32 v24, v24, v25
  v_cvt_pk_bf16_f32 v25, v26, v27
  v_cvt_pk_bf16_f32 v26, v28, v29
  v_cvt_pk_bf16_f32 v27, v30, v31
  v_cvt_pk_bf16_f32 v32, v32, v33
  v_cvt_pk_bf16_f32 v33, v34, v35
  v_cvt_pk_bf16_f32 v34, v36, v37
  v_cvt_pk_bf16_f32 v35, v38, v39
  v_cvt_pk_bf16_f32 v40, v40, v41
  v_cvt_pk_bf16_f32 v41, v42, v43
  v_cvt_pk_bf16_f32 v42, v44, v45
  v_cvt_pk_bf16_f32 v43, v46, v47
  s_waitcnt lgkmcnt(15)
  v_mfma_f32_16x16x32_bf16 v[28:31], v[168:171], v[24:27], 0
  v_cvt_pk_bf16_f32 v48, v48, v49
  v_cvt_pk_bf16_f32 v49, v50, v51
  v_mfma_f32_16x16x32_bf16 v[36:39], v[172:175], v[24:27], 0
  v_cvt_pk_bf16_f32 v50, v52, v53
  v_cvt_pk_bf16_f32 v51, v54, v55
  v_mfma_f32_16x16x32_bf16 v[44:47], v[176:179], v[24:27], 0
  v_cvt_pk_bf16_f32 v56, v56, v57
  v_cvt_pk_bf16_f32 v57, v58, v59
  v_mfma_f32_16x16x32_bf16 v[28:31], v[180:183], v[32:35], v[28:31]
  v_cvt_pk_bf16_f32 v58, v60, v61
  v_cvt_pk_bf16_f32 v59, v62, v63
  v_mfma_f32_16x16x32_bf16 v[36:39], v[184:187], v[32:35], v[36:39]
  v_cvt_pk_bf16_f32 v64, v64, v65
  v_cvt_pk_bf16_f32 v65, v66, v67
  v_mfma_f32_16x16x32_bf16 v[44:47], v[188:191], v[32:35], v[44:47]
  v_cvt_pk_bf16_f32 v66, v68, v69
  v_cvt_pk_bf16_f32 v67, v70, v71
  v_mfma_f32_16x16x32_bf16 v[28:31], v[216:219], v[40:43], v[28:31]
  v_cvt_pk_bf16_f32 v72, v72, v73
  v_cvt_pk_bf16_f32 v73, v74, v75
  v_mfma_f32_16x16x32_bf16 v[36:39], v[220:223], v[40:43], v[36:39]
  v_cvt_pk_bf16_f32 v74, v76, v77
  v_cvt_pk_bf16_f32 v75, v78, v79
  v_mfma_f32_16x16x32_bf16 v[44:47], v[224:227], v[40:43], v[44:47]
  v_cvt_pk_bf16_f32 v80, v80, v81
  v_cvt_pk_bf16_f32 v81, v82, v83
  v_mfma_f32_16x16x32_bf16 v[28:31], v[192:195], v[48:51], v[28:31]
  v_cvt_pk_bf16_f32 v82, v84, v85
  v_cvt_pk_bf16_f32 v83, v86, v87
  s_waitcnt lgkmcnt(14)
  v_mfma_f32_16x16x32_bf16 v[36:39], v[196:199], v[48:51], v[36:39]
  v_cvt_pk_bf16_f32 v88, v88, v89
  v_cvt_pk_bf16_f32 v89, v90, v91
  s_waitcnt lgkmcnt(12)
  v_mfma_f32_16x16x32_bf16 v[44:47], v[200:203], v[48:51], v[44:47]
  v_cvt_pk_bf16_f32 v90, v92, v93
  v_cvt_pk_bf16_f32 v91, v94, v95
  s_waitcnt lgkmcnt(10)
  v_mfma_f32_16x16x32_bf16 v[28:31], v[204:207], v[56:59], v[28:31]
  v_cvt_pk_bf16_f32 v96, v96, v97
  v_cvt_pk_bf16_f32 v97, v98, v99
  s_waitcnt lgkmcnt(8)
  v_mfma_f32_16x16x32_bf16 v[36:39], v[208:211], v[56:59], v[36:39]
  v_cvt_pk_bf16_f32 v98, v100, v101
  v_cvt_pk_bf16_f32 v99, v102, v103
  s_waitcnt lgkmcnt(6)
  v_mfma_f32_16x16x32_bf16 v[44:47], v[212:215], v[56:59], v[44:47]
  v_cvt_pk_bf16_f32 v104, v104, v105
  v_cvt_pk_bf16_f32 v105, v106, v107
  s_waitcnt lgkmcnt(4)
  v_mfma_f32_16x16x32_bf16 v[28:31], v[228:231], v[64:67], v[28:31]
  v_cvt_pk_bf16_f32 v106, v108, v109
  v_cvt_pk_bf16_f32 v107, v110, v111
  s_waitcnt lgkmcnt(2)
  v_mfma_f32_16x16x32_bf16 v[36:39], v[232:235], v[64:67], v[36:39]
  v_cvt_pk_bf16_f32 v112, v112, v113
  v_cvt_pk_bf16_f32 v113, v114, v115
  s_waitcnt lgkmcnt(0)
  v_mfma_f32_16x16x32_bf16 v[44:47], v[236:239], v[64:67], v[44:47]
  v_cvt_pk_bf16_f32 v114, v116, v117
  v_cvt_pk_bf16_f32 v115, v118, v119
  s_waitcnt lgkmcnt(0)
  s_barrier
  v_mfma_f32_16x16x32_bf16 v[76:79], v[168:171], v[72:75], 0
  v_cvt_pk_bf16_f32 v120, v120, v121
  v_cvt_pk_bf16_f32 v121, v122, v123
  v_cvt_pk_bf16_f32 v122, v124, v125
  v_mfma_f32_16x16x32_bf16 v[84:87], v[172:175], v[72:75], 0
  v_cvt_pk_bf16_f32 v123, v126, v127
  v_cvt_pk_bf16_f32 v128, v128, v129
  v_cvt_pk_bf16_f32 v129, v130, v131
  v_mfma_f32_16x16x32_bf16 v[92:95], v[176:179], v[72:75], 0
  v_cvt_pk_bf16_f32 v130, v132, v133
  v_cvt_pk_bf16_f32 v131, v134, v135
  v_cvt_pk_bf16_f32 v136, v136, v137
  v_mfma_f32_16x16x32_bf16 v[76:79], v[180:183], v[80:83], v[76:79]
  v_cvt_pk_bf16_f32 v137, v138, v139
  v_cvt_pk_bf16_f32 v138, v140, v141
  v_cvt_pk_bf16_f32 v139, v142, v143
  v_mfma_f32_16x16x32_bf16 v[84:87], v[184:187], v[80:83], v[84:87]
  v_cvt_pk_bf16_f32 v144, v144, v145
  v_cvt_pk_bf16_f32 v145, v146, v147
  v_cvt_pk_bf16_f32 v146, v148, v149
  v_mfma_f32_16x16x32_bf16 v[92:95], v[188:191], v[80:83], v[92:95]
  v_cvt_pk_bf16_f32 v147, v150, v151
  v_cvt_pk_bf16_f32 v152, v152, v153
  v_cvt_pk_bf16_f32 v153, v154, v155
  v_mfma_f32_16x16x32_bf16 v[76:79], v[216:219], v[88:91], v[76:79]
  v_cvt_pk_bf16_f32 v154, v156, v157
  v_cvt_pk_bf16_f32 v155, v158, v159
  v_cvt_pk_bf16_f32 v160, v160, v161
  v_mfma_f32_16x16x32_bf16 v[84:87], v[220:223], v[88:91], v[84:87]
  v_cvt_pk_bf16_f32 v161, v162, v163
  v_cvt_pk_bf16_f32 v162, v164, v165
  v_cvt_pk_bf16_f32 v163, v166, v167
  v_mfma_f32_16x16x32_bf16 v[92:95], v[224:227], v[88:91], v[92:95]
  v_max3_f32 v14, v28, v29, v30
  v_max3_f32 v14, v14, v31, v36
  v_max3_f32 v14, v14, v37, v38
  v_mfma_f32_16x16x32_bf16 v[76:79], v[192:195], v[96:99], v[76:79]
  v_max3_f32 v14, v14, v39, v44
  v_max3_f32 v14, v14, v45, v46
  v_max_f32 v14, v14, v47
  v_mfma_f32_16x16x32_bf16 v[84:87], v[196:199], v[96:99], v[84:87]
  v_mov_b32 v17, v14
  s_nop 1
  v_permlane32_swap_b32 v14, v17
  v_max_f32 v14, v14, v17
  v_mfma_f32_16x16x32_bf16 v[92:95], v[200:203], v[96:99], v[92:95]
  v_mov_b32 v17, v14
  s_nop 1
  v_permlane16_swap_b32 v14, v17
  v_max_f32 v14, v14, v17
  v_mfma_f32_16x16x32_bf16 v[76:79], v[204:207], v[104:107], v[76:79]
  v_mul_f32 v14, s57, v14
  v_fma_f32 v28, v28, s57, -v14
  v_fma_f32 v29, v29, s57, -v14
  v_mfma_f32_16x16x32_bf16 v[84:87], v[208:211], v[104:107], v[84:87]
  v_fma_f32 v30, v30, s57, -v14
  v_fma_f32 v31, v31, s57, -v14
  v_fma_f32 v36, v36, s57, -v14
  v_mfma_f32_16x16x32_bf16 v[92:95], v[212:215], v[104:107], v[92:95]
  v_fma_f32 v37, v37, s57, -v14
  v_fma_f32 v38, v38, s57, -v14
  v_fma_f32 v39, v39, s57, -v14
  v_mfma_f32_16x16x32_bf16 v[76:79], v[228:231], v[112:115], v[76:79]
  v_fma_f32 v44, v44, s57, -v14
  v_fma_f32 v45, v45, s57, -v14
  v_fma_f32 v46, v46, s57, -v14
  v_mfma_f32_16x16x32_bf16 v[84:87], v[232:235], v[112:115], v[84:87]
  v_fma_f32 v47, v47, s57, -v14
  v_exp_f32 v28, v28
  v_exp_f32 v29, v29
  v_mfma_f32_16x16x32_bf16 v[92:95], v[236:239], v[112:115], v[92:95]
  v_exp_f32 v30, v30
  v_exp_f32 v31, v31
  v_exp_f32 v36, v36
  v_mfma_f32_16x16x32_bf16 v[124:127], v[168:171], v[120:123], 0
  v_exp_f32 v37, v37
  v_exp_f32 v38, v38
  v_exp_f32 v39, v39
  v_exp_f32 v44, v44
  v_mfma_f32_16x16x32_bf16 v[132:135], v[172:175], v[120:123], 0
  v_exp_f32 v45, v45
  v_exp_f32 v46, v46
  v_exp_f32 v47, v47
  v_add_f32 v15, v28, v29
  v_mfma_f32_16x16x32_bf16 v[140:143], v[176:179], v[120:123], 0
  v_add_f32 v16, v30, v31
  v_add_f32 v15, v15, v36
  v_add_f32 v16, v16, v37
  v_add_f32 v15, v15, v38
  v_mfma_f32_16x16x32_bf16 v[124:127], v[180:183], v[128:131], v[124:127]
  v_add_f32 v16, v16, v39
  v_add_f32 v15, v15, v44
  v_add_f32 v16, v16, v45
  v_add_f32 v15, v15, v46
  v_mfma_f32_16x16x32_bf16 v[132:135], v[184:187], v[128:131], v[132:135]
  v_add_f32 v16, v16, v47
  v_add_f32 v15, v15, v16
  v_mov_b32 v18, v15
  s_nop 1
  v_permlane32_swap_b32 v15, v18
  v_mfma_f32_16x16x32_bf16 v[140:143], v[188:191], v[128:131], v[140:143]
  v_add_f32 v15, v15, v18
  v_mov_b32 v18, v15
  s_nop 1
  v_permlane16_swap_b32 v15, v18
  v_add_f32 v15, v15, v18
  v_mfma_f32_16x16x32_bf16 v[124:127], v[216:219], v[136:139], v[124:127]
  v_rcp_f32 v15, v15
  s_nop 0
  v_mul_f32 v28, v28, v15
  v_mul_f32 v29, v29, v15
  v_mul_f32 v30, v30, v15
  v_mfma_f32_16x16x32_bf16 v[132:135], v[220:223], v[136:139], v[132:135]
  v_mul_f32 v31, v31, v15
  v_mul_f32 v36, v36, v15
  v_mul_f32 v37, v37, v15
  v_mul_f32 v38, v38, v15
  v_mfma_f32_16x16x32_bf16 v[140:143], v[224:227], v[136:139], v[140:143]
  v_mul_f32 v39, v39, v15
  v_mul_f32 v44, v44, v15
  v_mul_f32 v45, v45, v15
  v_mul_f32 v46, v46, v15
  v_mfma_f32_16x16x32_bf16 v[124:127], v[192:195], v[144:147], v[124:127]
  v_mul_f32 v47, v47, v15
  v_cvt_pk_bf16_f32 v52, v28, v29
  v_cvt_pk_bf16_f32 v53, v30, v31
  v_cvt_pk_bf16_f32 v54, v36, v37
  v_mfma_f32_16x16x32_bf16 v[132:135], v[196:199], v[144:147], v[132:135]
  v_cvt_pk_bf16_f32 v55, v38, v39
  v_cvt_pk_bf16_f32 v60, v44, v45
  v_cvt_pk_bf16_f32 v61, v46, v47
  buffer_store_dwordx4 v[52:55], v12, s[48:51], s64 offen sc1
  v_mfma_f32_16x16x32_bf16 v[140:143], v[200:203], v[144:147], v[140:143]
  v_max3_f32 v14, v76, v77, v78
  v_max3_f32 v14, v14, v79, v84
  v_max3_f32 v14, v14, v85, v86
  v_max3_f32 v14, v14, v87, v92
  v_mfma_f32_16x16x32_bf16 v[124:127], v[204:207], v[152:155], v[124:127]
  v_max3_f32 v14, v14, v93, v94
  v_max_f32 v14, v14, v95
  v_mov_b32 v17, v14
  v_mfma_f32_16x16x32_bf16 v[132:135], v[208:211], v[152:155], v[132:135]
  s_nop 0
  v_permlane32_swap_b32 v14, v17
  v_max_f32 v14, v14, v17
  v_mov_b32 v17, v14
  v_mfma_f32_16x16x32_bf16 v[140:143], v[212:215], v[152:155], v[140:143]
  s_nop 0
  v_permlane16_swap_b32 v14, v17
  v_max_f32 v14, v14, v17
  v_mul_f32 v14, s57, v14
  v_mfma_f32_16x16x32_bf16 v[124:127], v[228:231], v[160:163], v[124:127]
  v_fma_f32 v76, v76, s57, -v14
  v_fma_f32 v77, v77, s57, -v14
  v_fma_f32 v78, v78, s57, -v14
  v_mfma_f32_16x16x32_bf16 v[132:135], v[232:235], v[160:163], v[132:135]
  v_fma_f32 v79, v79, s57, -v14
  v_fma_f32 v84, v84, s57, -v14
  v_fma_f32 v85, v85, s57, -v14
  v_mfma_f32_16x16x32_bf16 v[140:143], v[236:239], v[160:163], v[140:143]
  v_fma_f32 v86, v86, s57, -v14
  v_fma_f32 v87, v87, s57, -v14
  v_fma_f32 v92, v92, s57, -v14
  v_fma_f32 v93, v93, s57, -v14
  v_fma_f32 v94, v94, s57, -v14
  v_fma_f32 v95, v95, s57, -v14
  v_exp_f32 v76, v76
  v_exp_f32 v77, v77
  v_exp_f32 v78, v78
  v_exp_f32 v79, v79
  v_exp_f32 v84, v84
  v_exp_f32 v85, v85
  v_exp_f32 v86, v86
  v_exp_f32 v87, v87
  v_exp_f32 v92, v92
  v_exp_f32 v93, v93
  v_exp_f32 v94, v94
  v_exp_f32 v95, v95
  v_add_f32 v15, v76, v77
  v_add_f32 v16, v78, v79
  v_add_f32 v15, v15, v84
  v_add_f32 v16, v16, v85
  v_add_f32 v15, v15, v86
  v_add_f32 v16, v16, v87
  v_add_f32 v15, v15, v92
  v_add_f32 v16, v16, v93
  v_add_f32 v15, v15, v94
  v_add_f32 v16, v16, v95
  v_add_f32 v15, v15, v16
  v_mov_b32 v18, v15
  s_nop 1
  v_permlane32_swap_b32 v15, v18
  v_add_f32 v15, v15, v18
  v_mov_b32 v18, v15
  s_nop 1
  v_permlane16_swap_b32 v15, v18
  v_add_f32 v15, v15, v18
  v_rcp_f32 v15, v15
  s_nop 0
  v_mul_f32 v76, v76, v15
  v_mul_f32 v77, v77, v15
  v_mul_f32 v78, v78, v15
  v_mul_f32 v79, v79, v15
  v_mul_f32 v84, v84, v15
  v_mul_f32 v85, v85, v15
  v_mul_f32 v86, v86, v15
  v_mul_f32 v87, v87, v15
  v_mul_f32 v92, v92, v15
  v_mul_f32 v93, v93, v15
  v_mul_f32 v94, v94, v15
  v_mul_f32 v95, v95, v15
  v_cvt_pk_bf16_f32 v100, v76, v77
  v_cvt_pk_bf16_f32 v101, v78, v79
  v_cvt_pk_bf16_f32 v102, v84, v85
  v_cvt_pk_bf16_f32 v103, v86, v87
  v_cvt_pk_bf16_f32 v62, v92, v93
  v_cvt_pk_bf16_f32 v63, v94, v95
  buffer_store_dwordx4 v[100:103], v12, s[48:51], s64 offen offset:1024 sc1
  buffer_store_dwordx4 v[60:63], v12, s[48:51], s64 offen offset:3072 sc1
  v_max3_f32 v14, v124, v125, v126
  v_max3_f32 v14, v14, v127, v132
  v_max3_f32 v14, v14, v133, v134
  v_max3_f32 v14, v14, v135, v140
  v_max3_f32 v14, v14, v141, v142
  v_max_f32 v14, v14, v143
  v_mov_b32 v17, v14
  s_nop 1
  v_permlane32_swap_b32 v14, v17
  v_max_f32 v14, v14, v17
  v_mov_b32 v17, v14
  s_nop 1
  v_permlane16_swap_b32 v14, v17
  v_max_f32 v14, v14, v17
  v_mul_f32 v14, s57, v14
  v_fma_f32 v124, v124, s57, -v14
  v_fma_f32 v125, v125, s57, -v14
  v_fma_f32 v126, v126, s57, -v14
  v_fma_f32 v127, v127, s57, -v14
  v_fma_f32 v132, v132, s57, -v14
  v_fma_f32 v133, v133, s57, -v14
  v_fma_f32 v134, v134, s57, -v14
  v_fma_f32 v135, v135, s57, -v14
  v_fma_f32 v140, v140, s57, -v14
  v_fma_f32 v141, v141, s57, -v14
  v_fma_f32 v142, v142, s57, -v14
  v_fma_f32 v143, v143, s57, -v14
  v_exp_f32 v124, v124
  v_exp_f32 v125, v125
  v_exp_f32 v126, v126
  v_exp_f32 v127, v127
  v_exp_f32 v132, v132
  v_exp_f32 v133, v133
  v_exp_f32 v134, v134
  v_exp_f32 v135, v135
  v_exp_f32 v140, v140
  v_exp_f32 v141, v141
  v_exp_f32 v142, v142
  v_exp_f32 v143, v143
  v_add_f32 v15, v124, v125
  v_add_f32 v16, v126, v127
  v_add_f32 v15, v15, v132
  v_add_f32 v16, v16, v133
  v_add_f32 v15, v15, v134
  v_add_f32 v16, v16, v135
  v_add_f32 v15, v15, v140
  v_add_f32 v16, v16, v141
  v_add_f32 v15, v15, v142
  v_add_f32 v16, v16, v143
  v_add_f32 v15, v15, v16
  v_mov_b32 v18, v15
  s_nop 1
  v_permlane32_swap_b32 v15, v18
  v_add_f32 v15, v15, v18
  v_mov_b32 v18, v15
  s_nop 1
  v_permlane16_swap_b32 v15, v18
  v_add_f32 v15, v15, v18
  v_rcp_f32 v15, v15
  s_nop 0
  v_mul_f32 v124, v124, v15
  v_mul_f32 v125, v125, v15
  v_mul_f32 v126, v126, v15
  v_mul_f32 v127, v127, v15
  v_mul_f32 v132, v132, v15
  v_mul_f32 v133, v133, v15
  v_mul_f32 v134, v134, v15
  v_mul_f32 v135, v135, v15
  v_mul_f32 v140, v140, v15
  v_mul_f32 v141, v141, v15
  v_mul_f32 v142, v142, v15
  v_mul_f32 v143, v143, v15
  v_cvt_pk_bf16_f32 v148, v124, v125
  v_cvt_pk_bf16_f32 v149, v126, v127
  v_cvt_pk_bf16_f32 v150, v132, v133
  v_cvt_pk_bf16_f32 v151, v134, v135
  v_cvt_pk_bf16_f32 v108, v140, v141
  v_cvt_pk_bf16_f32 v109, v142, v143
  buffer_store_dwordx4 v[148:151], v12, s[48:51], s64 offen offset:2048 sc1
  buffer_store_dwordx2 v[108:109], v13, s[48:51], s58 offen sc1
  v_mov_b32 v2, v240
  v_mov_b32 v3, v241
  v_mov_b32 v6, v242
  v_mov_b32 v7, v243
  v_mov_b32 v8, v244
  v_mov_b32 v9, v245
  v_mov_b32 v10, v246
  v_mov_b32 v11, v247
  v_mov_b32 v20, v248
  v_mov_b32 v21, v249
  v_mov_b32 v22, v250
  v_mov_b32 v13, v251
  s_barrier
  ds_read_b64 v[168:169], v20
  ds_read_b64 v[170:171], v21
  ds_read_b64 v[172:173], v20 offset:2048
  ds_read_b64 v[174:175], v21 offset:2048
  ds_read_b64 v[176:177], v20 offset:4096
  ds_read_b64 v[178:179], v21 offset:4096
  ds_read_b64_tr_b16 v[192:193], v2
  ds_read_b64_tr_b16 v[194:195], v2 offset:10240
  ds_read_b64_tr_b16 v[196:197], v3
  ds_read_b64_tr_b16 v[198:199], v3 offset:10240
  ds_read_b64_tr_b16 v[200:201], v2 offset:1024
  ds_read_b64_tr_b16 v[202:203], v2 offset:11264
  ds_read_b64_tr_b16 v[204:205], v3 offset:1024
  ds_read_b64_tr_b16 v[206:207], v3 offset:11264
  ds_read_b64_tr_b16 v[208:209], v2 offset:2048
  ds_read_b64_tr_b16 v[210:211], v2 offset:12288
  s_waitcnt lgkmcnt(8)
  v_mfma_f32_16x16x32_bf16 v[24:27], v[168:171], v[192:195], 0
  ds_read_b64_tr_b16 v[212:213], v3 offset:2048
  v_mfma_f32_16x16x32_bf16 v[64:67], v[172:175], v[192:195], 0
  ds_read_b64_tr_b16 v[214:215], v3 offset:12288
  v_mfma_f32_16x16x32_bf16 v[104:107], v[176:179], v[192:195], 0
  ds_read_b64_tr_b16 v[216:217], v2 offset:3072
  s_waitcnt lgkmcnt(9)
  v_mfma_f32_16x16x32_bf16 v[28:31], v[168:171], v[196:199], 0
  ds_read_b64_tr_b16 v[218:219], v2 offset:13312
  v_mfma_f32_16x16x32_bf16 v[68:71], v[172:175], v[196:199], 0
  ds_read_b64_tr_b16 v[220:221], v3 offset:3072
  v_mfma_f32_16x16x32_bf16 v[108:111], v[176:179], v[196:199], 0
  ds_read_b64_tr_b16 v[222:223], v3 offset:13312
  s_waitcnt lgkmcnt(10)
  v_mfma_f32_16x16x32_bf16 v[32:35], v[168:171], v[200:203], 0
  ds_read_b64_tr_b16 v[224:225], v2 offset:4096
  v_mfma_f32_16x16x32_bf16 v[72:75], v[172:175], v[200:203], 0
  ds_read_b64_tr_b16 v[226:227], v2 offset:14336
  v_mfma_f32_16x16x32_bf16 v[112:115], v[176:179], v[200:203], 0
  ds_read_b64_tr_b16 v[228:229], v3 offset:4096
  s_waitcnt lgkmcnt(11)
  v_mfma_f32_16x16x32_bf16 v[36:39], v[168:171], v[204:207], 0
  ds_read_b64_tr_b16 v[230:231], v3 offset:14336
  v_mfma_f32_16x16x32_bf16 v[76:79], v[172:175], v[204:207], 0
  v_mfma_f32_16x16x32_bf16 v[116:119], v[176:179], v[204:207], 0
  s_waitcnt lgkmcnt(10)
  v_mfma_f32_16x16x32_bf16 v[40:43], v[168:171], v[208:211], 0
  v_mfma_f32_16x16x32_bf16 v[80:83], v[172:175], v[208:211], 0
  v_mfma_f32_16x16x32_bf16 v[120:123], v[176:179], v[208:211], 0
  v_mov_b32 v14, 0
  v_mov_b32 v15, 1
  s_waitcnt vmcnt(0)
  s_mov_b64 exec, 1
  buffer_store_dword v15, v14, s[52:55], s59 offen sc1
  s_mov_b64 exec, -1
  s_waitcnt lgkmcnt(0)
  s_barrier
  v_mfma_f32_16x16x32_bf16 v[44:47], v[168:171], v[212:215], 0
  ds_read_b64 v[180:181], v22
  ds_read_b64 v[182:183], v13
  v_mfma_f32_16x16x32_bf16 v[84:87], v[172:175], v[212:215], 0
  ds_read_b64 v[184:185], v22 offset:2048
  v_mfma_f32_16x16x32_bf16 v[124:127], v[176:179], v[212:215], 0
  ds_read_b64 v[186:187], v13 offset:2048
  v_mfma_f32_16x16x32_bf16 v[48:51], v[168:171], v[216:219], 0
  ds_read_b64 v[188:189], v22 offset:4096
  v_mfma_f32_16x16x32_bf16 v[88:91], v[172:175], v[216:219], 0
  ds_read_b64 v[190:191], v13 offset:4096
  v_mfma_f32_16x16x32_bf16 v[128:131], v[176:179], v[216:219], 0
  v_add_u32 v2, 0xfffe2000, v2
  v_add_u32 v3, 0xfffe2000, v3
  ds_read_b64_tr_b16 v[192:193], v2
  v_mfma_f32_16x16x32_bf16 v[52:55], v[168:171], v[220:223], 0
  ds_read_b64_tr_b16 v[194:195], v2 offset:10240
  v_mfma_f32_16x16x32_bf16 v[92:95], v[172:175], v[220:223], 0
  ds_read_b64_tr_b16 v[196:197], v3
  v_mfma_f32_16x16x32_bf16 v[132:135], v[176:179], v[220:223], 0
  ds_read_b64_tr_b16 v[198:199], v3 offset:10240
  v_mfma_f32_16x16x32_bf16 v[56:59], v[168:171], v[224:227], 0
  ds_read_b64_tr_b16 v[200:201], v2 offset:1024
  v_mfma_f32_16x16x32_bf16 v[96:99], v[172:175], v[224:227], 0
  ds_read_b64_tr_b16 v[202:203], v2 offset:11264
  ds_read_b64_tr_b16 v[204:205], v3 offset:1024
  v_mfma_f32_16x16x32_bf16 v[136:139], v[176:179], v[224:227], 0
  ds_read_b64_tr_b16 v[206:207], v3 offset:11264
  v_mfma_f32_16x16x32_bf16 v[60:63], v[168:171], v[228:231], 0
  ds_read_b64_tr_b16 v[208:209], v2 offset:2048
  v_mfma_f32_16x16x32_bf16 v[100:103], v[172:175], v[228:231], 0
  ds_read_b64_tr_b16 v[210:211], v2 offset:12288
  v_mfma_f32_16x16x32_bf16 v[140:143], v[176:179], v[228:231], 0
  s_waitcnt lgkmcnt(8)
  v_mfma_f32_16x16x32_bf16 v[24:27], v[180:183], v[192:195], v[24:27]
  ds_read_b64_tr_b16 v[212:213], v3 offset:2048
  v_mfma_f32_16x16x32_bf16 v[64:67], v[184:187], v[192:195], v[64:67]
  ds_read_b64_tr_b16 v[214:215], v3 offset:12288
  v_mfma_f32_16x16x32_bf16 v[104:107], v[188:191], v[192:195], v[104:107]
  ds_read_b64_tr_b16 v[216:217], v2 offset:3072
  s_waitcnt lgkmcnt(9)
  v_mfma_f32_16x16x32_bf16 v[28:31], v[180:183], v[196:199], v[28:31]
  ds_read_b64_tr_b16 v[218:219], v2 offset:13312
  v_mfma_f32_16x16x32_bf16 v[68:71], v[184:187], v[196:199], v[68:71]
  ds_read_b64_tr_b16 v[220:221], v3 offset:3072
  v_mfma_f32_16x16x32_bf16 v[108:111], v[188:191], v[196:199], v[108:111]
  ds_read_b64_tr_b16 v[222:223], v3 offset:13312
  s_waitcnt lgkmcnt(10)
  v_mfma_f32_16x16x32_bf16 v[32:35], v[180:183], v[200:203], v[32:35]
  ds_read_b64_tr_b16 v[224:225], v2 offset:4096
  v_mfma_f32_16x16x32_bf16 v[72:75], v[184:187], v[200:203], v[72:75]
  ds_read_b64_tr_b16 v[226:227], v2 offset:14336
  v_mfma_f32_16x16x32_bf16 v[112:115], v[188:191], v[200:203], v[112:115]
  ds_read_b64_tr_b16 v[228:229], v3 offset:4096
  s_waitcnt lgkmcnt(11)
  v_mfma_f32_16x16x32_bf16 v[36:39], v[180:183], v[204:207], v[36:39]
  ds_read_b64_tr_b16 v[230:231], v3 offset:14336
  v_mfma_f32_16x16x32_bf16 v[76:79], v[184:187], v[204:207], v[76:79]
  v_mfma_f32_16x16x32_bf16 v[116:119], v[188:191], v[204:207], v[116:119]
  s_waitcnt lgkmcnt(10)
  v_mfma_f32_16x16x32_bf16 v[40:43], v[180:183], v[208:211], v[40:43]
  v_mfma_f32_16x16x32_bf16 v[80:83], v[184:187], v[208:211], v[80:83]
  v_mfma_f32_16x16x32_bf16 v[120:123], v[188:191], v[208:211], v[120:123]
  s_waitcnt lgkmcnt(0)
  s_barrier
  v_mfma_f32_16x16x32_bf16 v[44:47], v[180:183], v[212:215], v[44:47]
  v_add_u32 v20, 0xfffe0000, v20
  v_add_u32 v21, 0xfffe0000, v21
  v_add_u32 v22, 0xfffe0000, v22
  v_add_u32 v13, 0xfffe0000, v13
  ds_read_b64 v[168:169], v20
  ds_read_b64 v[170:171], v21
  v_mfma_f32_16x16x32_bf16 v[84:87], v[184:187], v[212:215], v[84:87]
  ds_read_b64 v[172:173], v20 offset:2048
  v_mfma_f32_16x16x32_bf16 v[124:127], v[188:191], v[212:215], v[124:127]
  ds_read_b64 v[174:175], v21 offset:2048
  v_mfma_f32_16x16x32_bf16 v[48:51], v[180:183], v[216:219], v[48:51]
  ds_read_b64 v[176:177], v20 offset:4096
  v_mfma_f32_16x16x32_bf16 v[88:91], v[184:187], v[216:219], v[88:91]
  ds_read_b64 v[178:179], v21 offset:4096
  v_mfma_f32_16x16x32_bf16 v[128:131], v[188:191], v[216:219], v[128:131]
  v_add_u32 v2, 0x8000, v2
  v_add_u32 v3, 0x8000, v3
  ds_read_b64_tr_b16 v[192:193], v2
  v_mfma_f32_16x16x32_bf16 v[52:55], v[180:183], v[220:223], v[52:55]
  ds_read_b64_tr_b16 v[194:195], v2 offset:10240
  v_mfma_f32_16x16x32_bf16 v[92:95], v[184:187], v[220:223], v[92:95]
  ds_read_b64_tr_b16 v[196:197], v3
  v_mfma_f32_16x16x32_bf16 v[132:135], v[188:191], v[220:223], v[132:135]
  ds_read_b64_tr_b16 v[198:199], v3 offset:10240
  v_mfma_f32_16x16x32_bf16 v[56:59], v[180:183], v[224:227], v[56:59]
  ds_read_b64_tr_b16 v[200:201], v2 offset:1024
  v_mfma_f32_16x16x32_bf16 v[96:99], v[184:187], v[224:227], v[96:99]
  ds_read_b64_tr_b16 v[202:203], v2 offset:11264
  ds_read_b64_tr_b16 v[204:205], v3 offset:1024
  v_mfma_f32_16x16x32_bf16 v[136:139], v[188:191], v[224:227], v[136:139]
  ds_read_b64_tr_b16 v[206:207], v3 offset:11264
  v_mfma_f32_16x16x32_bf16 v[60:63], v[180:183], v[228:231], v[60:63]
  ds_read_b64_tr_b16 v[208:209], v2 offset:2048
  v_mfma_f32_16x16x32_bf16 v[100:103], v[184:187], v[228:231], v[100:103]
  ds_read_b64_tr_b16 v[210:211], v2 offset:12288
  v_mfma_f32_16x16x32_bf16 v[140:143], v[188:191], v[228:231], v[140:143]
  s_waitcnt lgkmcnt(8)
  v_mfma_f32_16x16x32_bf16 v[24:27], v[168:171], v[192:195], v[24:27]
  ds_read_b64_tr_b16 v[212:213], v3 offset:2048
  v_mfma_f32_16x16x32_bf16 v[64:67], v[172:175], v[192:195], v[64:67]
  ds_read_b64_tr_b16 v[214:215], v3 offset:12288
  v_mfma_f32_16x16x32_bf16 v[104:107], v[176:179], v[192:195], v[104:107]
  ds_read_b64_tr_b16 v[216:217], v2 offset:3072
  s_waitcnt lgkmcnt(9)
  v_mfma_f32_16x16x32_bf16 v[28:31], v[168:171], v[196:199], v[28:31]
  ds_read_b64_tr_b16 v[218:219], v2 offset:13312
  v_mfma_f32_16x16x32_bf16 v[68:71], v[172:175], v[196:199], v[68:71]
  ds_read_b64_tr_b16 v[220:221], v3 offset:3072
  v_mfma_f32_16x16x32_bf16 v[108:111], v[176:179], v[196:199], v[108:111]
  ds_read_b64_tr_b16 v[222:223], v3 offset:13312
  s_waitcnt lgkmcnt(10)
  v_mfma_f32_16x16x32_bf16 v[32:35], v[168:171], v[200:203], v[32:35]
  ds_read_b64_tr_b16 v[224:225], v2 offset:4096
  v_mfma_f32_16x16x32_bf16 v[72:75], v[172:175], v[200:203], v[72:75]
  ds_read_b64_tr_b16 v[226:227], v2 offset:14336
  v_mfma_f32_16x16x32_bf16 v[112:115], v[176:179], v[200:203], v[112:115]
  ds_read_b64_tr_b16 v[228:229], v3 offset:4096
  s_waitcnt lgkmcnt(11)
  v_mfma_f32_16x16x32_bf16 v[36:39], v[168:171], v[204:207], v[36:39]
  ds_read_b64_tr_b16 v[230:231], v3 offset:14336
  v_mfma_f32_16x16x32_bf16 v[76:79], v[172:175], v[204:207], v[76:79]
  v_mfma_f32_16x16x32_bf16 v[116:119], v[176:179], v[204:207], v[116:119]
  s_waitcnt lgkmcnt(10)
  v_mfma_f32_16x16x32_bf16 v[40:43], v[168:171], v[208:211], v[40:43]
  v_mfma_f32_16x16x32_bf16 v[80:83], v[172:175], v[208:211], v[80:83]
  v_mfma_f32_16x16x32_bf16 v[120:123], v[176:179], v[208:211], v[120:123]
  s_waitcnt lgkmcnt(0)
  s_barrier
  v_mfma_f32_16x16x32_bf16 v[44:47], v[168:171], v[212:215], v[44:47]
  ds_read_b64 v[180:181], v22
  ds_read_b64 v[182:183], v13
  v_mfma_f32_16x16x32_bf16 v[84:87], v[172:175], v[212:215], v[84:87]
  ds_read_b64 v[184:185], v22 offset:2048
  v_mfma_f32_16x16x32_bf16 v[124:127], v[176:179], v[212:215], v[124:127]
  ds_read_b64 v[186:187], v13 offset:2048
  v_mfma_f32_16x16x32_bf16 v[48:51], v[168:171], v[216:219], v[48:51]
  ds_read_b64 v[188:189], v22 offset:4096
  v_mfma_f32_16x16x32_bf16 v[88:91], v[172:175], v[216:219], v[88:91]
  ds_read_b64 v[190:191], v13 offset:4096
  v_mfma_f32_16x16x32_bf16 v[128:131], v[176:179], v[216:219], v[128:131]
  v_add_u32 v2, 0x5000, v2
  v_add_u32 v3, 0x5000, v3
  ds_read_b64_tr_b16 v[192:193], v2
  v_mfma_f32_16x16x32_bf16 v[52:55], v[168:171], v[220:223], v[52:55]
  ds_read_b64_tr_b16 v[194:195], v2 offset:10240
  v_mfma_f32_16x16x32_bf16 v[92:95], v[172:175], v[220:223], v[92:95]
  ds_read_b64_tr_b16 v[196:197], v3
  v_mfma_f32_16x16x32_bf16 v[132:135], v[176:179], v[220:223], v[132:135]
  ds_read_b64_tr_b16 v[198:199], v3 offset:10240
  v_mfma_f32_16x16x32_bf16 v[56:59], v[168:171], v[224:227], v[56:59]
  ds_read_b64_tr_b16 v[200:201], v2 offset:1024
  v_mfma_f32_16x16x32_bf16 v[96:99], v[172:175], v[224:227], v[96:99]
  ds_read_b64_tr_b16 v[202:203], v2 offset:11264
  ds_read_b64_tr_b16 v[204:205], v3 offset:1024
  v_mfma_f32_16x16x32_bf16 v[136:139], v[176:179], v[224:227], v[136:139]
  ds_read_b64_tr_b16 v[206:207], v3 offset:11264
  v_mfma_f32_16x16x32_bf16 v[60:63], v[168:171], v[228:231], v[60:63]
  ds_read_b64_tr_b16 v[208:209], v2 offset:2048
  v_mfma_f32_16x16x32_bf16 v[100:103], v[172:175], v[228:231], v[100:103]
  ds_read_b64_tr_b16 v[210:211], v2 offset:12288
  v_mfma_f32_16x16x32_bf16 v[140:143], v[176:179], v[228:231], v[140:143]
  s_waitcnt lgkmcnt(8)
  v_mfma_f32_16x16x32_bf16 v[24:27], v[180:183], v[192:195], v[24:27]
  ds_read_b64_tr_b16 v[212:213], v3 offset:2048
  v_mfma_f32_16x16x32_bf16 v[64:67], v[184:187], v[192:195], v[64:67]
  ds_read_b64_tr_b16 v[214:215], v3 offset:12288
  v_mfma_f32_16x16x32_bf16 v[104:107], v[188:191], v[192:195], v[104:107]
  ds_read_b64_tr_b16 v[216:217], v2 offset:3072
  s_waitcnt lgkmcnt(9)
  v_mfma_f32_16x16x32_bf16 v[28:31], v[180:183], v[196:199], v[28:31]
  ds_read_b64_tr_b16 v[218:219], v2 offset:13312
  v_mfma_f32_16x16x32_bf16 v[68:71], v[184:187], v[196:199], v[68:71]
  ds_read_b64_tr_b16 v[220:221], v3 offset:3072
  v_mfma_f32_16x16x32_bf16 v[108:111], v[188:191], v[196:199], v[108:111]
  ds_read_b64_tr_b16 v[222:223], v3 offset:13312
  s_waitcnt lgkmcnt(10)
  v_mfma_f32_16x16x32_bf16 v[32:35], v[180:183], v[200:203], v[32:35]
  ds_read_b64_tr_b16 v[224:225], v2 offset:4096
  v_mfma_f32_16x16x32_bf16 v[72:75], v[184:187], v[200:203], v[72:75]
  ds_read_b64_tr_b16 v[226:227], v2 offset:14336
  v_mfma_f32_16x16x32_bf16 v[112:115], v[188:191], v[200:203], v[112:115]
  ds_read_b64_tr_b16 v[228:229], v3 offset:4096
  s_waitcnt lgkmcnt(11)
  v_mfma_f32_16x16x32_bf16 v[36:39], v[180:183], v[204:207], v[36:39]
  ds_read_b64_tr_b16 v[230:231], v3 offset:14336
  v_mfma_f32_16x16x32_bf16 v[76:79], v[184:187], v[204:207], v[76:79]
  v_mfma_f32_16x16x32_bf16 v[116:119], v[188:191], v[204:207], v[116:119]
  s_waitcnt lgkmcnt(10)
  v_mfma_f32_16x16x32_bf16 v[40:43], v[180:183], v[208:211], v[40:43]
  v_mfma_f32_16x16x32_bf16 v[80:83], v[184:187], v[208:211], v[80:83]
  v_mfma_f32_16x16x32_bf16 v[120:123], v[188:191], v[208:211], v[120:123]
  s_waitcnt lgkmcnt(0)
  s_barrier
  v_mfma_f32_16x16x32_bf16 v[44:47], v[180:183], v[212:215], v[44:47]
  v_add_u32 v20, 0x12000, v20
  v_add_u32 v21, 0x12000, v21
  v_add_u32 v22, 0x12000, v22
  v_add_u32 v13, 0x12000, v13
  ds_read_b64 v[168:169], v20
  ds_read_b64 v[170:171], v21
  v_mfma_f32_16x16x32_bf16 v[84:87], v[184:187], v[212:215], v[84:87]
  ds_read_b64 v[172:173], v20 offset:2048
  v_mfma_f32_16x16x32_bf16 v[124:127], v[188:191], v[212:215], v[124:127]
  ds_read_b64 v[174:175], v21 offset:2048
  v_mfma_f32_16x16x32_bf16 v[48:51], v[180:183], v[216:219], v[48:51]
  ds_read_b64 v[176:177], v20 offset:4096
  v_mfma_f32_16x16x32_bf16 v[88:91], v[184:187], v[216:219], v[88:91]
  ds_read_b64 v[178:179], v21 offset:4096
  v_mfma_f32_16x16x32_bf16 v[128:131], v[188:191], v[216:219], v[128:131]
  v_add_u32 v2, 0x5000, v2
  v_add_u32 v3, 0x5000, v3
  ds_read_b64_tr_b16 v[192:193], v2
  v_mfma_f32_16x16x32_bf16 v[52:55], v[180:183], v[220:223], v[52:55]
  ds_read_b64_tr_b16 v[194:195], v2 offset:10240
  v_mfma_f32_16x16x32_bf16 v[92:95], v[184:187], v[220:223], v[92:95]
  ds_read_b64_tr_b16 v[196:197], v3
  v_mfma_f32_16x16x32_bf16 v[132:135], v[188:191], v[220:223], v[132:135]
  ds_read_b64_tr_b16 v[198:199], v3 offset:10240
  v_mfma_f32_16x16x32_bf16 v[56:59], v[180:183], v[224:227], v[56:59]
  ds_read_b64_tr_b16 v[200:201], v2 offset:1024
  v_mfma_f32_16x16x32_bf16 v[96:99], v[184:187], v[224:227], v[96:99]
  ds_read_b64_tr_b16 v[202:203], v2 offset:11264
  ds_read_b64_tr_b16 v[204:205], v3 offset:1024
  v_mfma_f32_16x16x32_bf16 v[136:139], v[188:191], v[224:227], v[136:139]
  ds_read_b64_tr_b16 v[206:207], v3 offset:11264
  v_mfma_f32_16x16x32_bf16 v[60:63], v[180:183], v[228:231], v[60:63]
  ds_read_b64_tr_b16 v[208:209], v2 offset:2048
  v_mfma_f32_16x16x32_bf16 v[100:103], v[184:187], v[228:231], v[100:103]
  ds_read_b64_tr_b16 v[210:211], v2 offset:12288
  v_mfma_f32_16x16x32_bf16 v[140:143], v[188:191], v[228:231], v[140:143]
  s_waitcnt lgkmcnt(8)
  v_mfma_f32_16x16x32_bf16 v[24:27], v[168:171], v[192:195], v[24:27]
  ds_read_b64_tr_b16 v[212:213], v3 offset:2048
  v_mfma_f32_16x16x32_bf16 v[64:67], v[172:175], v[192:195], v[64:67]
  ds_read_b64_tr_b16 v[214:215], v3 offset:12288
  v_mfma_f32_16x16x32_bf16 v[104:107], v[176:179], v[192:195], v[104:107]
  ds_read_b64_tr_b16 v[216:217], v2 offset:3072
  s_waitcnt lgkmcnt(9)
  v_mfma_f32_16x16x32_bf16 v[28:31], v[168:171], v[196:199], v[28:31]
  ds_read_b64_tr_b16 v[218:219], v2 offset:13312
  v_mfma_f32_16x16x32_bf16 v[68:71], v[172:175], v[196:199], v[68:71]
  ds_read_b64_tr_b16 v[220:221], v3 offset:3072
  v_mfma_f32_16x16x32_bf16 v[108:111], v[176:179], v[196:199], v[108:111]
  ds_read_b64_tr_b16 v[222:223], v3 offset:13312
  s_waitcnt lgkmcnt(10)
  v_mfma_f32_16x16x32_bf16 v[32:35], v[168:171], v[200:203], v[32:35]
  ds_read_b64_tr_b16 v[224:225], v2 offset:4096
  v_mfma_f32_16x16x32_bf16 v[72:75], v[172:175], v[200:203], v[72:75]
  ds_read_b64_tr_b16 v[226:227], v2 offset:14336
  v_mfma_f32_16x16x32_bf16 v[112:115], v[176:179], v[200:203], v[112:115]
  ds_read_b64_tr_b16 v[228:229], v3 offset:4096
  s_waitcnt lgkmcnt(11)
  v_mfma_f32_16x16x32_bf16 v[36:39], v[168:171], v[204:207], v[36:39]
  ds_read_b64_tr_b16 v[230:231], v3 offset:14336
  v_mfma_f32_16x16x32_bf16 v[76:79], v[172:175], v[204:207], v[76:79]
  v_mfma_f32_16x16x32_bf16 v[116:119], v[176:179], v[204:207], v[116:119]
  s_waitcnt lgkmcnt(10)
  v_mfma_f32_16x16x32_bf16 v[40:43], v[168:171], v[208:211], v[40:43]
  v_mfma_f32_16x16x32_bf16 v[80:83], v[172:175], v[208:211], v[80:83]
  v_mfma_f32_16x16x32_bf16 v[120:123], v[176:179], v[208:211], v[120:123]
  s_waitcnt lgkmcnt(0)
  s_barrier
  v_mfma_f32_16x16x32_bf16 v[44:47], v[168:171], v[212:215], v[44:47]
  ds_read_b64 v[180:181], v22
  ds_read_b64 v[182:183], v13
  v_mfma_f32_16x16x32_bf16 v[84:87], v[172:175], v[212:215], v[84:87]
  ds_read_b64 v[184:185], v22 offset:2048
  v_mfma_f32_16x16x32_bf16 v[124:127], v[176:179], v[212:215], v[124:127]
  ds_read_b64 v[186:187], v13 offset:2048
  v_mfma_f32_16x16x32_bf16 v[48:51], v[168:171], v[216:219], v[48:51]
  ds_read_b64 v[188:189], v22 offset:4096
  v_mfma_f32_16x16x32_bf16 v[88:91], v[172:175], v[216:219], v[88:91]
  ds_read_b64 v[190:191], v13 offset:4096
  v_mfma_f32_16x16x32_bf16 v[128:131], v[176:179], v[216:219], v[128:131]
  v_add_u32 v2, 0xc000, v2
  v_add_u32 v3, 0xc000, v3
  ds_read_b64_tr_b16 v[192:193], v2
  v_mfma_f32_16x16x32_bf16 v[52:55], v[168:171], v[220:223], v[52:55]
  ds_read_b64_tr_b16 v[194:195], v2 offset:10240
  v_mfma_f32_16x16x32_bf16 v[92:95], v[172:175], v[220:223], v[92:95]
  ds_read_b64_tr_b16 v[196:197], v3
  v_mfma_f32_16x16x32_bf16 v[132:135], v[176:179], v[220:223], v[132:135]
  ds_read_b64_tr_b16 v[198:199], v3 offset:10240
  v_mfma_f32_16x16x32_bf16 v[56:59], v[168:171], v[224:227], v[56:59]
  ds_read_b64_tr_b16 v[200:201], v2 offset:1024
  v_mfma_f32_16x16x32_bf16 v[96:99], v[172:175], v[224:227], v[96:99]
  ds_read_b64_tr_b16 v[202:203], v2 offset:11264
  ds_read_b64_tr_b16 v[204:205], v3 offset:1024
  v_mfma_f32_16x16x32_bf16 v[136:139], v[176:179], v[224:227], v[136:139]
  ds_read_b64_tr_b16 v[206:207], v3 offset:11264
  v_mfma_f32_16x16x32_bf16 v[60:63], v[168:171], v[228:231], v[60:63]
  ds_read_b64_tr_b16 v[208:209], v2 offset:2048
  v_mfma_f32_16x16x32_bf16 v[100:103], v[172:175], v[228:231], v[100:103]
  ds_read_b64_tr_b16 v[210:211], v2 offset:12288
  v_mfma_f32_16x16x32_bf16 v[140:143], v[176:179], v[228:231], v[140:143]
  s_waitcnt lgkmcnt(8)
  v_mfma_f32_16x16x32_bf16 v[24:27], v[180:183], v[192:195], v[24:27]
  ds_read_b64_tr_b16 v[212:213], v3 offset:2048
  v_mfma_f32_16x16x32_bf16 v[64:67], v[184:187], v[192:195], v[64:67]
  ds_read_b64_tr_b16 v[214:215], v3 offset:12288
  v_mfma_f32_16x16x32_bf16 v[104:107], v[188:191], v[192:195], v[104:107]
  ds_read_b64_tr_b16 v[216:217], v2 offset:3072
  s_waitcnt lgkmcnt(9)
  v_mfma_f32_16x16x32_bf16 v[28:31], v[180:183], v[196:199], v[28:31]
  ds_read_b64_tr_b16 v[218:219], v2 offset:13312
  v_mfma_f32_16x16x32_bf16 v[68:71], v[184:187], v[196:199], v[68:71]
  ds_read_b64_tr_b16 v[220:221], v3 offset:3072
  v_mfma_f32_16x16x32_bf16 v[108:111], v[188:191], v[196:199], v[108:111]
  ds_read_b64_tr_b16 v[222:223], v3 offset:13312
  s_waitcnt lgkmcnt(10)
  v_mfma_f32_16x16x32_bf16 v[32:35], v[180:183], v[200:203], v[32:35]
  ds_read_b64_tr_b16 v[224:225], v2 offset:4096
  v_mfma_f32_16x16x32_bf16 v[72:75], v[184:187], v[200:203], v[72:75]
  ds_read_b64_tr_b16 v[226:227], v2 offset:14336
  v_mfma_f32_16x16x32_bf16 v[112:115], v[188:191], v[200:203], v[112:115]
  ds_read_b64_tr_b16 v[228:229], v3 offset:4096
  s_waitcnt lgkmcnt(11)
  v_mfma_f32_16x16x32_bf16 v[36:39], v[180:183], v[204:207], v[36:39]
  ds_read_b64_tr_b16 v[230:231], v3 offset:14336
  v_mfma_f32_16x16x32_bf16 v[76:79], v[184:187], v[204:207], v[76:79]
  v_mfma_f32_16x16x32_bf16 v[116:119], v[188:191], v[204:207], v[116:119]
  s_waitcnt lgkmcnt(10)
  v_mfma_f32_16x16x32_bf16 v[40:43], v[180:183], v[208:211], v[40:43]
  v_mfma_f32_16x16x32_bf16 v[80:83], v[184:187], v[208:211], v[80:83]
  v_mfma_f32_16x16x32_bf16 v[120:123], v[188:191], v[208:211], v[120:123]
  s_waitcnt lgkmcnt(0)
  s_barrier
  v_mfma_f32_16x16x32_bf16 v[44:47], v[180:183], v[212:215], v[44:47]
  ds_read_b128 v[168:171], v10
  ds_read_b128 v[172:175], v10 offset:1024
  v_mfma_f32_16x16x32_bf16 v[84:87], v[184:187], v[212:215], v[84:87]
  ds_read_b128 v[176:179], v10 offset:2048
  v_mfma_f32_16x16x32_bf16 v[124:127], v[188:191], v[212:215], v[124:127]
  ds_read_b128 v[156:159], v10 offset:3072
  v_mfma_f32_16x16x32_bf16 v[48:51], v[180:183], v[216:219], v[48:51]
  ds_read_b64 v[160:161], v11
  v_mfma_f32_16x16x32_bf16 v[88:91], v[184:187], v[216:219], v[88:91]
  ds_read_b64_tr_b16 v[232:233], v6
  v_mfma_f32_16x16x32_bf16 v[128:131], v[188:191], v[216:219], v[128:131]
  ds_read_b64_tr_b16 v[234:235], v6 offset:2048
  v_mfma_f32_16x16x32_bf16 v[52:55], v[180:183], v[220:223], v[52:55]
  ds_read_b64_tr_b16 v[236:237], v6 offset:4096
  v_mfma_f32_16x16x32_bf16 v[92:95], v[184:187], v[220:223], v[92:95]
  ds_read_b64_tr_b16 v[238:239], v7
  v_mfma_f32_16x16x32_bf16 v[132:135], v[188:191], v[220:223], v[132:135]
  ds_read_b64_tr_b16 v[240:241], v7 offset:2048
  v_mfma_f32_16x16x32_bf16 v[56:59], v[180:183], v[224:227], v[56:59]
  ds_read_b64_tr_b16 v[242:243], v7 offset:4096
  v_mfma_f32_16x16x32_bf16 v[96:99], v[184:187], v[224:227], v[96:99]
  v_add_u32 v2, 0xfffe2000, v2
  v_add_u32 v3, 0xfffe2000, v3
  ds_read_b64_tr_b16 v[192:193], v2
  ds_read_b64_tr_b16 v[194:195], v2 offset:10240
  v_mfma_f32_16x16x32_bf16 v[136:139], v[188:191], v[224:227], v[136:139]
  ds_read_b64_tr_b16 v[196:197], v3
  v_mfma_f32_16x16x32_bf16 v[60:63], v[180:183], v[228:231], v[60:63]
  ds_read_b64_tr_b16 v[198:199], v3 offset:10240
  v_mfma_f32_16x16x32_bf16 v[100:103], v[184:187], v[228:231], v[100:103]
  v_mfma_f32_16x16x32_bf16 v[140:143], v[188:191], v[228:231], v[140:143]
  v_cvt_pk_bf16_f32 v144, v24, v25
  v_cvt_pk_bf16_f32 v145, v26, v27
  v_cvt_pk_bf16_f32 v146, v64, v65
  v_cvt_pk_bf16_f32 v147, v66, v67
  v_cvt_pk_bf16_f32 v148, v104, v105
  v_cvt_pk_bf16_f32 v149, v106, v107
  s_waitcnt lgkmcnt(14)
  v_mfma_f32_16x16x32_bf16 v[24:27], v[144:147], v[168:171], 0
  v_cvt_pk_bf16_f32 v150, v28, v29
  v_cvt_pk_bf16_f32 v151, v30, v31
  s_waitcnt lgkmcnt(13)
  v_mfma_f32_16x16x32_bf16 v[64:67], v[144:147], v[172:175], 0
  v_cvt_pk_bf16_f32 v152, v68, v69
  s_waitcnt lgkmcnt(12)
  v_mfma_f32_16x16x32_bf16 v[104:107], v[144:147], v[176:179], 0
  v_cvt_pk_bf16_f32 v153, v70, v71
  v_cvt_pk_bf16_f32 v154, v108, v109
  s_waitcnt lgkmcnt(11)
  v_mfma_f32_16x16x16_bf16 v[24:27], v[148:149], v[156:157], v[24:27]
  v_cvt_pk_bf16_f32 v155, v110, v111
  v_mfma_f32_16x16x16_bf16 v[64:67], v[148:149], v[158:159], v[64:67]
  ds_read_b64_tr_b16 v[200:201], v2 offset:1024
  s_waitcnt lgkmcnt(11)
  v_mfma_f32_16x16x16_bf16 v[104:107], v[148:149], v[160:161], v[104:107]
  ds_read_b64_tr_b16 v[202:203], v2 offset:11264
  v_mfma_f32_16x16x32_bf16 v[28:31], v[150:153], v[168:171], 0
  v_cvt_pk_bf16_f32 v144, v32, v33
  v_cvt_pk_bf16_f32 v145, v34, v35
  v_mfma_f32_16x16x32_bf16 v[68:71], v[150:153], v[172:175], 0
  v_cvt_pk_bf16_f32 v146, v72, v73
  v_mfma_f32_16x16x32_bf16 v[108:111], v[150:153], v[176:179], 0
  v_cvt_pk_bf16_f32 v147, v74, v75
  v_cvt_pk_bf16_f32 v148, v112, v113
  v_mfma_f32_16x16x16_bf16 v[28:31], v[154:155], v[156:157], v[28:31]
  v_cvt_pk_bf16_f32 v149, v114, v115
  v_mfma_f32_16x16x16_bf16 v[68:71], v[154:155], v[158:159], v[68:71]
  ds_read_b64_tr_b16 v[204:205], v3 offset:1024
  v_mfma_f32_16x16x16_bf16 v[108:111], v[154:155], v[160:161], v[108:111]
  ds_read_b64_tr_b16 v[206:207], v3 offset:11264
  v_mfma_f32_16x16x32_bf16 v[32:35], v[144:147], v[168:171], 0
  v_cvt_pk_bf16_f32 v150, v36, v37
  v_cvt_pk_bf16_f32 v151, v38, v39
  v_mfma_f32_16x16x32_bf16 v[72:75], v[144:147], v[172:175], 0
  v_cvt_pk_bf16_f32 v152, v76, v77
  v_mfma_f32_16x16x32_bf16 v[112:115], v[144:147], v[176:179], 0
  v_cvt_pk_bf16_f32 v153, v78, v79
  v_cvt_pk_bf16_f32 v154, v116, v117
  v_mfma_f32_16x16x16_bf16 v[32:35], v[148:149], v[156:157], v[32:35]
  v_cvt_pk_bf16_f32 v155, v118, v119
  v_mfma_f32_16x16x16_bf16 v[72:75], v[148:149], v[158:159], v[72:75]
  ds_read_b64_tr_b16 v[208:209], v2 offset:2048
  v_mfma_f32_16x16x16_bf16 v[112:115], v[148:149], v[160:161], v[112:115]
  ds_read_b64_tr_b16 v[210:211], v2 offset:12288
  v_mfma_f32_16x16x32_bf16 v[36:39], v[150:153], v[168:171], 0
  v_cvt_pk_bf16_f32 v144, v40, v41
  v_cvt_pk_bf16_f32 v145, v42, v43
  v_mfma_f32_16x16x32_bf16 v[76:79], v[150:153], v[172:175], 0
  v_cvt_pk_bf16_f32 v146, v80, v81
  v_mfma_f32_16x16x32_bf16 v[116:119], v[150:153], v[176:179], 0
  v_cvt_pk_bf16_f32 v147, v82, v83
  v_cvt_pk_bf16_f32 v148, v120, v121
  v_mfma_f32_16x16x16_bf16 v[36:39], v[154:155], v[156:157], v[36:39]
  v_cvt_pk_bf16_f32 v149, v122, v123
  v_mfma_f32_16x16x16_bf16 v[76:79], v[154:155], v[158:159], v[76:79]
  ds_read_b128 v[244:247], v10 offset:36864
  v_mfma_f32_16x16x16_bf16 v[116:119], v[154:155], v[160:161], v[116:119]
  ds_read_b128 v[248:251], v10 offset:37888
  v_mfma_f32_16x16x32_bf16 v[40:43], v[144:147], v[168:171], 0
  v_cvt_pk_bf16_f32 v150, v44, v45
  v_cvt_pk_bf16_f32 v151, v46, v47
  v_mfma_f32_16x16x32_bf16 v[80:83], v[144:147], v[172:175], 0
  v_cvt_pk_bf16_f32 v152, v84, v85
  v_mfma_f32_16x16x32_bf16 v[120:123], v[144:147], v[176:179], 0
  v_cvt_pk_bf16_f32 v153, v86, v87
  v_cvt_pk_bf16_f32 v154, v124, v125
  v_mfma_f32_16x16x16_bf16 v[40:43], v[148:149], v[156:157], v[40:43]
  v_cvt_pk_bf16_f32 v155, v126, v127
  v_mfma_f32_16x16x16_bf16 v[80:83], v[148:149], v[158:159], v[80:83]
  ds_read_b128 v[252:255], v10 offset:38912
  v_mfma_f32_16x16x16_bf16 v[120:123], v[148:149], v[160:161], v[120:123]
  ds_read_b128 v[14:17], v10 offset:39936
  v_mfma_f32_16x16x32_bf16 v[44:47], v[150:153], v[168:171], 0
  v_cvt_pk_bf16_f32 v144, v48, v49
  v_cvt_pk_bf16_f32 v145, v50, v51
  v_mfma_f32_16x16x32_bf16 v[84:87], v[150:153], v[172:175], 0
  v_cvt_pk_bf16_f32 v146, v88, v89
  v_mfma_f32_16x16x32_bf16 v[124:127], v[150:153], v[176:179], 0
  v_cvt_pk_bf16_f32 v147, v90, v91
  v_cvt_pk_bf16_f32 v148, v128, v129
  v_mfma_f32_16x16x16_bf16 v[44:47], v[154:155], v[156:157], v[44:47]
  v_cvt_pk_bf16_f32 v149, v130, v131
  v_mfma_f32_16x16x16_bf16 v[84:87], v[154:155], v[158:159], v[84:87]
  ds_read_b64 v[18:19], v11 offset:1024
  v_mfma_f32_16x16x16_bf16 v[124:127], v[154:155], v[160:161], v[124:127]
  v_mfma_f32_16x16x32_bf16 v[48:51], v[144:147], v[168:171], 0
  v_cvt_pk_bf16_f32 v150, v52, v53
  v_cvt_pk_bf16_f32 v151, v54, v55
  v_mfma_f32_16x16x32_bf16 v[88:91], v[144:147], v[172:175], 0
  v_cvt_pk_bf16_f32 v152, v92, v93
  v_mfma_f32_16x16x32_bf16 v[128:131], v[144:147], v[176:179], 0
  v_cvt_pk_bf16_f32 v153, v94, v95
  v_cvt_pk_bf16_f32 v154, v132, v133
  v_mfma_f32_16x16x16_bf16 v[48:51], v[148:149], v[156:157], v[48:51]
  v_cvt_pk_bf16_f32 v155, v134, v135
  v_mfma_f32_16x16x16_bf16 v[88:91], v[148:149], v[158:159], v[88:91]
  v_mfma_f32_16x16x16_bf16 v[128:131], v[148:149], v[160:161], v[128:131]
  v_mfma_f32_16x16x32_bf16 v[52:55], v[150:153], v[168:171], 0
  v_cvt_pk_bf16_f32 v144, v56, v57
  v_cvt_pk_bf16_f32 v145, v58, v59
  v_mfma_f32_16x16x32_bf16 v[92:95], v[150:153], v[172:175], 0
  v_cvt_pk_bf16_f32 v146, v96, v97
  v_mfma_f32_16x16x32_bf16 v[132:135], v[150:153], v[176:179], 0
  v_cvt_pk_bf16_f32 v147, v98, v99
  v_cvt_pk_bf16_f32 v148, v136, v137
  v_mfma_f32_16x16x16_bf16 v[52:55], v[154:155], v[156:157], v[52:55]
  v_cvt_pk_bf16_f32 v149, v138, v139
  v_mfma_f32_16x16x16_bf16 v[92:95], v[154:155], v[158:159], v[92:95]
  v_mfma_f32_16x16x16_bf16 v[132:135], v[154:155], v[160:161], v[132:135]
  v_mfma_f32_16x16x32_bf16 v[56:59], v[144:147], v[168:171], 0
  v_cvt_pk_bf16_f32 v150, v60, v61
  v_cvt_pk_bf16_f32 v151, v62, v63
  v_mfma_f32_16x16x32_bf16 v[96:99], v[144:147], v[172:175], 0
  v_cvt_pk_bf16_f32 v152, v100, v101
  v_mfma_f32_16x16x32_bf16 v[136:139], v[144:147], v[176:179], 0
  v_cvt_pk_bf16_f32 v153, v102, v103
  v_cvt_pk_bf16_f32 v154, v140, v141
  v_mfma_f32_16x16x16_bf16 v[56:59], v[148:149], v[156:157], v[56:59]
  v_cvt_pk_bf16_f32 v155, v142, v143
  v_mfma_f32_16x16x16_bf16 v[96:99], v[148:149], v[158:159], v[96:99]
  v_mfma_f32_16x16x16_bf16 v[136:139], v[148:149], v[160:161], v[136:139]
  v_mfma_f32_16x16x32_bf16 v[60:63], v[150:153], v[168:171], 0
  v_mfma_f32_16x16x32_bf16 v[100:103], v[150:153], v[172:175], 0
  v_mfma_f32_16x16x32_bf16 v[140:143], v[150:153], v[176:179], 0
  v_mfma_f32_16x16x16_bf16 v[60:63], v[154:155], v[156:157], v[60:63]
  v_mfma_f32_16x16x16_bf16 v[100:103], v[154:155], v[158:159], v[100:103]
  v_mfma_f32_16x16x16_bf16 v[140:143], v[154:155], v[160:161], v[140:143]
  s_waitcnt lgkmcnt(4)
  v_mfma_f32_16x16x32_bf16 v[144:147], v[232:235], v[244:247], 0
  s_waitcnt lgkmcnt(3)
  v_mfma_f32_16x16x32_bf16 v[148:151], v[232:235], v[248:251], 0
  s_waitcnt lgkmcnt(2)
  v_mfma_f32_16x16x32_bf16 v[152:155], v[232:235], v[252:255], 0
  v_mfma_f32_16x16x32_bf16 v[156:159], v[238:241], v[244:247], 0
  v_mfma_f32_16x16x32_bf16 v[160:163], v[238:241], v[248:251], 0
  v_mfma_f32_16x16x32_bf16 v[164:167], v[238:241], v[252:255], 0
  s_waitcnt lgkmcnt(1)
  v_mfma_f32_16x16x16_bf16 v[144:147], v[236:237], v[14:15], v[144:147]
  v_mfma_f32_16x16x16_bf16 v[148:151], v[236:237], v[16:17], v[148:151]
  s_waitcnt lgkmcnt(0)
  v_mfma_f32_16x16x16_bf16 v[152:155], v[236:237], v[18:19], v[152:155]
  ds_read_b64_tr_b16 v[232:233], v8
  v_mfma_f32_16x16x16_bf16 v[156:159], v[242:243], v[14:15], v[156:159]
  ds_read_b64_tr_b16 v[234:235], v8 offset:2048
  v_mfma_f32_16x16x16_bf16 v[160:163], v[242:243], v[16:17], v[160:163]
  ds_read_b64_tr_b16 v[236:237], v8 offset:4096
  v_mfma_f32_16x16x16_bf16 v[164:167], v[242:243], v[18:19], v[164:167]
  ds_read_b64_tr_b16 v[238:239], v9
  ds_read_b64_tr_b16 v[240:241], v9 offset:2048
  ds_read_b64_tr_b16 v[242:243], v9 offset:4096
  v_cvt_pk_bf16_f32 v168, v144, v145
  v_cvt_pk_bf16_f32 v169, v146, v147
  v_cvt_pk_bf16_f32 v172, v148, v149
  v_cvt_pk_bf16_f32 v173, v150, v151
  v_cvt_pk_bf16_f32 v176, v152, v153
  v_cvt_pk_bf16_f32 v177, v154, v155
  v_cvt_pk_bf16_f32 v170, v156, v157
  v_cvt_pk_bf16_f32 v171, v158, v159
  v_cvt_pk_bf16_f32 v174, v160, v161
  v_cvt_pk_bf16_f32 v175, v162, v163
  v_cvt_pk_bf16_f32 v178, v164, v165
  v_cvt_pk_bf16_f32 v179, v166, v167
  s_waitcnt lgkmcnt(4)
  v_mfma_f32_16x16x32_bf16 v[144:147], v[232:235], v[244:247], 0
  v_mfma_f32_16x16x32_bf16 v[148:151], v[232:235], v[248:251], 0
  ds_read_b64_tr_b16 v[212:213], v3 offset:2048
  v_mfma_f32_16x16x32_bf16 v[152:155], v[232:235], v[252:255], 0
  ds_read_b64_tr_b16 v[214:215], v3 offset:12288
  s_waitcnt lgkmcnt(3)
  v_mfma_f32_16x16x32_bf16 v[156:159], v[238:241], v[244:247], 0
  ds_read_b64_tr_b16 v[216:217], v2 offset:3072
  v_mfma_f32_16x16x32_bf16 v[160:163], v[238:241], v[248:251], 0
  ds_read_b64_tr_b16 v[218:219], v2 offset:13312
  v_mfma_f32_16x16x32_bf16 v[164:167], v[238:241], v[252:255], 0
  ds_read_b64_tr_b16 v[220:221], v3 offset:3072
  v_mfma_f32_16x16x16_bf16 v[144:147], v[236:237], v[14:15], v[144:147]
  ds_read_b64_tr_b16 v[222:223], v3 offset:13312
  v_mfma_f32_16x16x16_bf16 v[148:151], v[236:237], v[16:17], v[148:151]
  ds_read_b64_tr_b16 v[224:225], v2 offset:4096
  v_mfma_f32_16x16x16_bf16 v[152:155], v[236:237], v[18:19], v[152:155]
  ds_read_b64_tr_b16 v[226:227], v2 offset:14336
  s_waitcnt lgkmcnt(8)
  v_mfma_f32_16x16x16_bf16 v[156:159], v[242:243], v[14:15], v[156:159]
  ds_read_b64_tr_b16 v[228:229], v3 offset:4096
  v_mfma_f32_16x16x16_bf16 v[160:163], v[242:243], v[16:17], v[160:163]
  ds_read_b64_tr_b16 v[230:231], v3 offset:14336
  v_mfma_f32_16x16x16_bf16 v[164:167], v[242:243], v[18:19], v[164:167]
  v_mfma_f32_16x16x32_bf16 v[24:27], v[192:195], v[168:171], v[24:27]
  v_mfma_f32_16x16x32_bf16 v[64:67], v[192:195], v[172:175], v[64:67]
  v_mfma_f32_16x16x32_bf16 v[104:107], v[192:195], v[176:179], v[104:107]
  v_cvt_pk_bf16_f32 v180, v144, v145
  v_mfma_f32_16x16x32_bf16 v[28:31], v[196:199], v[168:171], v[28:31]
  v_cvt_pk_bf16_f32 v181, v146, v147
  v_mfma_f32_16x16x32_bf16 v[68:71], v[196:199], v[172:175], v[68:71]
  v_cvt_pk_bf16_f32 v184, v148, v149
  v_mfma_f32_16x16x32_bf16 v[108:111], v[196:199], v[176:179], v[108:111]
  v_cvt_pk_bf16_f32 v185, v150, v151
  v_mfma_f32_16x16x32_bf16 v[32:35], v[200:203], v[168:171], v[32:35]
  v_cvt_pk_bf16_f32 v188, v152, v153
  v_mfma_f32_16x16x32_bf16 v[72:75], v[200:203], v[172:175], v[72:75]
  v_cvt_pk_bf16_f32 v189, v154, v155
  v_mfma_f32_16x16x32_bf16 v[112:115], v[200:203], v[176:179], v[112:115]
  v_cvt_pk_bf16_f32 v182, v156, v157
  v_mfma_f32_16x16x32_bf16 v[36:39], v[204:207], v[168:171], v[36:39]
  v_cvt_pk_bf16_f32 v183, v158, v159
  v_mfma_f32_16x16x32_bf16 v[76:79], v[204:207], v[172:175], v[76:79]
  v_cvt_pk_bf16_f32 v186, v160, v161
  v_mfma_f32_16x16x32_bf16 v[116:119], v[204:207], v[176:179], v[116:119]
  v_cvt_pk_bf16_f32 v187, v162, v163
  v_mfma_f32_16x16x32_bf16 v[40:43], v[208:211], v[168:171], v[40:43]
  v_cvt_pk_bf16_f32 v190, v164, v165
  v_mfma_f32_16x16x32_bf16 v[80:83], v[208:211], v[172:175], v[80:83]
  v_cvt_pk_bf16_f32 v191, v166, v167
  v_mfma_f32_16x16x32_bf16 v[120:123], v[208:211], v[176:179], v[120:123]
  s_waitcnt lgkmcnt(0)
  s_barrier
  v_mfma_f32_16x16x32_bf16 v[44:47], v[212:215], v[168:171], v[44:47]
  v_add_u32 v6, 0xfffe0000, v6
  v_add_u32 v7, 0xfffe0000, v7
  v_add_u32 v8, 0xfffe0000, v8
  v_add_u32 v9, 0xfffe0000, v9
  ds_read_b64_tr_b16 v[232:233], v6
  v_mfma_f32_16x16x32_bf16 v[84:87], v[212:215], v[172:175], v[84:87]
  ds_read_b64_tr_b16 v[234:235], v6 offset:2048
  v_mfma_f32_16x16x32_bf16 v[124:127], v[212:215], v[176:179], v[124:127]
  ds_read_b64_tr_b16 v[236:237], v6 offset:4096
  v_mfma_f32_16x16x32_bf16 v[48:51], v[216:219], v[168:171], v[48:51]
  ds_read_b64_tr_b16 v[238:239], v7
  v_mfma_f32_16x16x32_bf16 v[88:91], v[216:219], v[172:175], v[88:91]
  ds_read_b64_tr_b16 v[240:241], v7 offset:2048
  v_mfma_f32_16x16x32_bf16 v[128:131], v[216:219], v[176:179], v[128:131]
  ds_read_b64_tr_b16 v[242:243], v7 offset:4096
  v_mfma_f32_16x16x32_bf16 v[52:55], v[220:223], v[168:171], v[52:55]
  v_add_u32 v2, 0x8000, v2
  v_add_u32 v3, 0x8000, v3
  ds_read_b64_tr_b16 v[192:193], v2
  v_mfma_f32_16x16x32_bf16 v[92:95], v[220:223], v[172:175], v[92:95]
  ds_read_b64_tr_b16 v[194:195], v2 offset:10240
  v_mfma_f32_16x16x32_bf16 v[132:135], v[220:223], v[176:179], v[132:135]
  ds_read_b64_tr_b16 v[196:197], v3
  v_mfma_f32_16x16x32_bf16 v[56:59], v[224:227], v[168:171], v[56:59]
  ds_read_b64_tr_b16 v[198:199], v3 offset:10240
  v_mfma_f32_16x16x32_bf16 v[96:99], v[224:227], v[172:175], v[96:99]
  ds_read_b64_tr_b16 v[200:201], v2 offset:1024
  v_mfma_f32_16x16x32_bf16 v[136:139], v[224:227], v[176:179], v[136:139]
  ds_read_b64_tr_b16 v[202:203], v2 offset:11264
  v_mfma_f32_16x16x32_bf16 v[60:63], v[228:231], v[168:171], v[60:63]
  ds_read_b64_tr_b16 v[204:205], v3 offset:1024
  v_mfma_f32_16x16x32_bf16 v[100:103], v[228:231], v[172:175], v[100:103]
  ds_read_b64_tr_b16 v[206:207], v3 offset:11264
  v_mfma_f32_16x16x32_bf16 v[140:143], v[228:231], v[176:179], v[140:143]
  ds_read_b64_tr_b16 v[208:209], v2 offset:2048
  ds_read_b64_tr_b16 v[210:211], v2 offset:12288
  s_waitcnt lgkmcnt(14)
  v_mfma_f32_16x16x32_bf16 v[144:147], v[232:235], v[244:247], 0
  v_mfma_f32_16x16x32_bf16 v[148:151], v[232:235], v[248:251], 0
  ds_read_b64_tr_b16 v[212:213], v3 offset:2048
  v_mfma_f32_16x16x32_bf16 v[152:155], v[232:235], v[252:255], 0
  ds_read_b64_tr_b16 v[214:215], v3 offset:12288
  s_waitcnt lgkmcnt(13)
  v_mfma_f32_16x16x32_bf16 v[156:159], v[238:241], v[244:247], 0
  ds_read_b64_tr_b16 v[216:217], v2 offset:3072
  v_mfma_f32_16x16x32_bf16 v[160:163], v[238:241], v[248:251], 0
  ds_read_b64_tr_b16 v[218:219], v2 offset:13312
  v_mfma_f32_16x16x32_bf16 v[164:167], v[238:241], v[252:255], 0
  ds_read_b64_tr_b16 v[220:221], v3 offset:3072
  v_mfma_f32_16x16x16_bf16 v[144:147], v[236:237], v[14:15], v[144:147]
  ds_read_b64_tr_b16 v[222:223], v3 offset:13312
  v_mfma_f32_16x16x16_bf16 v[148:151], v[236:237], v[16:17], v[148:151]
  ds_read_b64_tr_b16 v[224:225], v2 offset:4096
  v_mfma_f32_16x16x16_bf16 v[152:155], v[236:237], v[18:19], v[152:155]
  ds_read_b64_tr_b16 v[226:227], v2 offset:14336
  s_waitcnt lgkmcnt(15)
  v_mfma_f32_16x16x16_bf16 v[156:159], v[242:243], v[14:15], v[156:159]
  ds_read_b64_tr_b16 v[228:229], v3 offset:4096
  v_mfma_f32_16x16x16_bf16 v[160:163], v[242:243], v[16:17], v[160:163]
  ds_read_b64_tr_b16 v[230:231], v3 offset:14336
  v_mfma_f32_16x16x16_bf16 v[164:167], v[242:243], v[18:19], v[164:167]
  v_mfma_f32_16x16x32_bf16 v[24:27], v[192:195], v[180:183], v[24:27]
  v_mfma_f32_16x16x32_bf16 v[64:67], v[192:195], v[184:187], v[64:67]
  v_mfma_f32_16x16x32_bf16 v[104:107], v[192:195], v[188:191], v[104:107]
  v_cvt_pk_bf16_f32 v168, v144, v145
  s_waitcnt lgkmcnt(15)
  v_mfma_f32_16x16x32_bf16 v[28:31], v[196:199], v[180:183], v[28:31]
  v_cvt_pk_bf16_f32 v169, v146, v147
  v_mfma_f32_16x16x32_bf16 v[68:71], v[196:199], v[184:187], v[68:71]
  v_cvt_pk_bf16_f32 v172, v148, v149
  v_mfma_f32_16x16x32_bf16 v[108:111], v[196:199], v[188:191], v[108:111]
  v_cvt_pk_bf16_f32 v173, v150, v151
  s_waitcnt lgkmcnt(14)
  v_mfma_f32_16x16x32_bf16 v[32:35], v[200:203], v[180:183], v[32:35]
  v_cvt_pk_bf16_f32 v176, v152, v153
  v_mfma_f32_16x16x32_bf16 v[72:75], v[200:203], v[184:187], v[72:75]
  v_cvt_pk_bf16_f32 v177, v154, v155
  v_mfma_f32_16x16x32_bf16 v[112:115], v[200:203], v[188:191], v[112:115]
  v_cvt_pk_bf16_f32 v170, v156, v157
  s_waitcnt lgkmcnt(12)
  v_mfma_f32_16x16x32_bf16 v[36:39], v[204:207], v[180:183], v[36:39]
  v_cvt_pk_bf16_f32 v171, v158, v159
  v_mfma_f32_16x16x32_bf16 v[76:79], v[204:207], v[184:187], v[76:79]
  v_cvt_pk_bf16_f32 v174, v160, v161
  v_mfma_f32_16x16x32_bf16 v[116:119], v[204:207], v[188:191], v[116:119]
  v_cvt_pk_bf16_f32 v175, v162, v163
  s_waitcnt lgkmcnt(10)
  v_mfma_f32_16x16x32_bf16 v[40:43], v[208:211], v[180:183], v[40:43]
  v_cvt_pk_bf16_f32 v178, v164, v165
  v_mfma_f32_16x16x32_bf16 v[80:83], v[208:211], v[184:187], v[80:83]
  v_cvt_pk_bf16_f32 v179, v166, v167
  v_mfma_f32_16x16x32_bf16 v[120:123], v[208:211], v[188:191], v[120:123]
  s_waitcnt lgkmcnt(0)
  s_barrier
  v_mfma_f32_16x16x32_bf16 v[44:47], v[212:215], v[180:183], v[44:47]
  ds_read_b64_tr_b16 v[232:233], v8
  v_mfma_f32_16x16x32_bf16 v[84:87], v[212:215], v[184:187], v[84:87]
  ds_read_b64_tr_b16 v[234:235], v8 offset:2048
  v_mfma_f32_16x16x32_bf16 v[124:127], v[212:215], v[188:191], v[124:127]
  ds_read_b64_tr_b16 v[236:237], v8 offset:4096
  v_mfma_f32_16x16x32_bf16 v[48:51], v[216:219], v[180:183], v[48:51]
  ds_read_b64_tr_b16 v[238:239], v9
  v_mfma_f32_16x16x32_bf16 v[88:91], v[216:219], v[184:187], v[88:91]
  ds_read_b64_tr_b16 v[240:241], v9 offset:2048
  v_mfma_f32_16x16x32_bf16 v[128:131], v[216:219], v[188:191], v[128:131]
  ds_read_b64_tr_b16 v[242:243], v9 offset:4096
  v_mfma_f32_16x16x32_bf16 v[52:55], v[220:223], v[180:183], v[52:55]
  v_add_u32 v2, 0x5000, v2
  v_add_u32 v3, 0x5000, v3
  ds_read_b64_tr_b16 v[192:193], v2
  v_mfma_f32_16x16x32_bf16 v[92:95], v[220:223], v[184:187], v[92:95]
  ds_read_b64_tr_b16 v[194:195], v2 offset:10240
  v_mfma_f32_16x16x32_bf16 v[132:135], v[220:223], v[188:191], v[132:135]
  ds_read_b64_tr_b16 v[196:197], v3
  v_mfma_f32_16x16x32_bf16 v[56:59], v[224:227], v[180:183], v[56:59]
  ds_read_b64_tr_b16 v[198:199], v3 offset:10240
  v_mfma_f32_16x16x32_bf16 v[96:99], v[224:227], v[184:187], v[96:99]
  ds_read_b64_tr_b16 v[200:201], v2 offset:1024
  v_mfma_f32_16x16x32_bf16 v[136:139], v[224:227], v[188:191], v[136:139]
  ds_read_b64_tr_b16 v[202:203], v2 offset:11264
  v_mfma_f32_16x16x32_bf16 v[60:63], v[228:231], v[180:183], v[60:63]
  ds_read_b64_tr_b16 v[204:205], v3 offset:1024
  v_mfma_f32_16x16x32_bf16 v[100:103], v[228:231], v[184:187], v[100:103]
  ds_read_b64_tr_b16 v[206:207], v3 offset:11264
  v_mfma_f32_16x16x32_bf16 v[140:143], v[228:231], v[188:191], v[140:143]
  ds_read_b64_tr_b16 v[208:209], v2 offset:2048
  ds_read_b64_tr_b16 v[210:211], v2 offset:12288
  s_waitcnt lgkmcnt(14)
  v_mfma_f32_16x16x32_bf16 v[144:147], v[232:235], v[244:247], 0
  v_mfma_f32_16x16x32_bf16 v[148:151], v[232:235], v[248:251], 0
  ds_read_b64_tr_b16 v[212:213], v3 offset:2048
  v_mfma_f32_16x16x32_bf16 v[152:155], v[232:235], v[252:255], 0
  ds_read_b64_tr_b16 v[214:215], v3 offset:12288
  s_waitcnt lgkmcnt(13)
  v_mfma_f32_16x16x32_bf16 v[156:159], v[238:241], v[244:247], 0
  ds_read_b64_tr_b16 v[216:217], v2 offset:3072
  v_mfma_f32_16x16x32_bf16 v[160:163], v[238:241], v[248:251], 0
  ds_read_b64_tr_b16 v[218:219], v2 offset:13312
  v_mfma_f32_16x16x32_bf16 v[164:167], v[238:241], v[252:255], 0
  ds_read_b64_tr_b16 v[220:221], v3 offset:3072
  v_mfma_f32_16x16x16_bf16 v[144:147], v[236:237], v[14:15], v[144:147]
  ds_read_b64_tr_b16 v[222:223], v3 offset:13312
  v_mfma_f32_16x16x16_bf16 v[148:151], v[236:237], v[16:17], v[148:151]
  ds_read_b64_tr_b16 v[224:225], v2 offset:4096
  v_mfma_f32_16x16x16_bf16 v[152:155], v[236:237], v[18:19], v[152:155]
  ds_read_b64_tr_b16 v[226:227], v2 offset:14336
  s_waitcnt lgkmcnt(15)
  v_mfma_f32_16x16x16_bf16 v[156:159], v[242:243], v[14:15], v[156:159]
  ds_read_b64_tr_b16 v[228:229], v3 offset:4096
  v_mfma_f32_16x16x16_bf16 v[160:163], v[242:243], v[16:17], v[160:163]
  ds_read_b64_tr_b16 v[230:231], v3 offset:14336
  v_mfma_f32_16x16x16_bf16 v[164:167], v[242:243], v[18:19], v[164:167]
  v_mfma_f32_16x16x32_bf16 v[24:27], v[192:195], v[168:171], v[24:27]
  v_mfma_f32_16x16x32_bf16 v[64:67], v[192:195], v[172:175], v[64:67]
  v_mfma_f32_16x16x32_bf16 v[104:107], v[192:195], v[176:179], v[104:107]
  v_cvt_pk_bf16_f32 v180, v144, v145
  s_waitcnt lgkmcnt(15)
  v_mfma_f32_16x16x32_bf16 v[28:31], v[196:199], v[168:171], v[28:31]
  v_cvt_pk_bf16_f32 v181, v146, v147
  v_mfma_f32_16x16x32_bf16 v[68:71], v[196:199], v[172:175], v[68:71]
  v_cvt_pk_bf16_f32 v184, v148, v149
  v_mfma_f32_16x16x32_bf16 v[108:111], v[196:199], v[176:179], v[108:111]
  v_cvt_pk_bf16_f32 v185, v150, v151
  s_waitcnt lgkmcnt(14)
  v_mfma_f32_16x16x32_bf16 v[32:35], v[200:203], v[168:171], v[32:35]
  v_cvt_pk_bf16_f32 v188, v152, v153
  v_mfma_f32_16x16x32_bf16 v[72:75], v[200:203], v[172:175], v[72:75]
  v_cvt_pk_bf16_f32 v189, v154, v155
  v_mfma_f32_16x16x32_bf16 v[112:115], v[200:203], v[176:179], v[112:115]
  v_cvt_pk_bf16_f32 v182, v156, v157
  s_waitcnt lgkmcnt(12)
  v_mfma_f32_16x16x32_bf16 v[36:39], v[204:207], v[168:171], v[36:39]
  v_cvt_pk_bf16_f32 v183, v158, v159
  v_mfma_f32_16x16x32_bf16 v[76:79], v[204:207], v[172:175], v[76:79]
  v_cvt_pk_bf16_f32 v186, v160, v161
  v_mfma_f32_16x16x32_bf16 v[116:119], v[204:207], v[176:179], v[116:119]
  v_cvt_pk_bf16_f32 v187, v162, v163
  s_waitcnt lgkmcnt(10)
  v_mfma_f32_16x16x32_bf16 v[40:43], v[208:211], v[168:171], v[40:43]
  v_cvt_pk_bf16_f32 v190, v164, v165
  v_mfma_f32_16x16x32_bf16 v[80:83], v[208:211], v[172:175], v[80:83]
  v_cvt_pk_bf16_f32 v191, v166, v167
  v_mfma_f32_16x16x32_bf16 v[120:123], v[208:211], v[176:179], v[120:123]
  s_waitcnt lgkmcnt(0)
  s_barrier
  v_mfma_f32_16x16x32_bf16 v[44:47], v[212:215], v[168:171], v[44:47]
  v_add_u32 v6, 0x12000, v6
  v_add_u32 v7, 0x12000, v7
  v_add_u32 v8, 0x12000, v8
  v_add_u32 v9, 0x12000, v9
  ds_read_b64_tr_b16 v[232:233], v6
  v_mfma_f32_16x16x32_bf16 v[84:87], v[212:215], v[172:175], v[84:87]
  ds_read_b64_tr_b16 v[234:235], v6 offset:2048
  v_mfma_f32_16x16x32_bf16 v[124:127], v[212:215], v[176:179], v[124:127]
  ds_read_b64_tr_b16 v[236:237], v6 offset:4096
  v_mfma_f32_16x16x32_bf16 v[48:51], v[216:219], v[168:171], v[48:51]
  ds_read_b64_tr_b16 v[238:239], v7
  v_mfma_f32_16x16x32_bf16 v[88:91], v[216:219], v[172:175], v[88:91]
  ds_read_b64_tr_b16 v[240:241], v7 offset:2048
  v_mfma_f32_16x16x32_bf16 v[128:131], v[216:219], v[176:179], v[128:131]
  ds_read_b64_tr_b16 v[242:243], v7 offset:4096
  v_mfma_f32_16x16x32_bf16 v[52:55], v[220:223], v[168:171], v[52:55]
  v_add_u32 v2, 0x5000, v2
  v_add_u32 v3, 0x5000, v3
  ds_read_b64_tr_b16 v[192:193], v2
  v_mfma_f32_16x16x32_bf16 v[92:95], v[220:223], v[172:175], v[92:95]
  ds_read_b64_tr_b16 v[194:195], v2 offset:10240
  v_mfma_f32_16x16x32_bf16 v[132:135], v[220:223], v[176:179], v[132:135]
  ds_read_b64_tr_b16 v[196:197], v3
  v_mfma_f32_16x16x32_bf16 v[56:59], v[224:227], v[168:171], v[56:59]
  ds_read_b64_tr_b16 v[198:199], v3 offset:10240
  v_mfma_f32_16x16x32_bf16 v[96:99], v[224:227], v[172:175], v[96:99]
  ds_read_b64_tr_b16 v[200:201], v2 offset:1024
  v_mfma_f32_16x16x32_bf16 v[136:139], v[224:227], v[176:179], v[136:139]
  ds_read_b64_tr_b16 v[202:203], v2 offset:11264
  v_mfma_f32_16x16x32_bf16 v[60:63], v[228:231], v[168:171], v[60:63]
  ds_read_b64_tr_b16 v[204:205], v3 offset:1024
  v_mfma_f32_16x16x32_bf16 v[100:103], v[228:231], v[172:175], v[100:103]
  ds_read_b64_tr_b16 v[206:207], v3 offset:11264
  v_mfma_f32_16x16x32_bf16 v[140:143], v[228:231], v[176:179], v[140:143]
  ds_read_b64_tr_b16 v[208:209], v2 offset:2048
  ds_read_b64_tr_b16 v[210:211], v2 offset:12288
  s_waitcnt lgkmcnt(14)
  v_mfma_f32_16x16x32_bf16 v[144:147], v[232:235], v[244:247], 0
  v_mfma_f32_16x16x32_bf16 v[148:151], v[232:235], v[248:251], 0
  ds_read_b64_tr_b16 v[212:213], v3 offset:2048
  v_mfma_f32_16x16x32_bf16 v[152:155], v[232:235], v[252:255], 0
  ds_read_b64_tr_b16 v[214:215], v3 offset:12288
  s_waitcnt lgkmcnt(13)
  v_mfma_f32_16x16x32_bf16 v[156:159], v[238:241], v[244:247], 0
  ds_read_b64_tr_b16 v[216:217], v2 offset:3072
  v_mfma_f32_16x16x32_bf16 v[160:163], v[238:241], v[248:251], 0
  ds_read_b64_tr_b16 v[218:219], v2 offset:13312
  v_mfma_f32_16x16x32_bf16 v[164:167], v[238:241], v[252:255], 0
  ds_read_b64_tr_b16 v[220:221], v3 offset:3072
  v_mfma_f32_16x16x16_bf16 v[144:147], v[236:237], v[14:15], v[144:147]
  ds_read_b64_tr_b16 v[222:223], v3 offset:13312
  v_mfma_f32_16x16x16_bf16 v[148:151], v[236:237], v[16:17], v[148:151]
  ds_read_b64_tr_b16 v[224:225], v2 offset:4096
  v_mfma_f32_16x16x16_bf16 v[152:155], v[236:237], v[18:19], v[152:155]
  ds_read_b64_tr_b16 v[226:227], v2 offset:14336
  s_waitcnt lgkmcnt(15)
  v_mfma_f32_16x16x16_bf16 v[156:159], v[242:243], v[14:15], v[156:159]
  ds_read_b64_tr_b16 v[228:229], v3 offset:4096
  v_mfma_f32_16x16x16_bf16 v[160:163], v[242:243], v[16:17], v[160:163]
  ds_read_b64_tr_b16 v[230:231], v3 offset:14336
  v_mfma_f32_16x16x16_bf16 v[164:167], v[242:243], v[18:19], v[164:167]
  v_mfma_f32_16x16x32_bf16 v[24:27], v[192:195], v[180:183], v[24:27]
  v_mfma_f32_16x16x32_bf16 v[64:67], v[192:195], v[184:187], v[64:67]
  v_mfma_f32_16x16x32_bf16 v[104:107], v[192:195], v[188:191], v[104:107]
  v_cvt_pk_bf16_f32 v168, v144, v145
  s_waitcnt lgkmcnt(15)
  v_mfma_f32_16x16x32_bf16 v[28:31], v[196:199], v[180:183], v[28:31]
  v_cvt_pk_bf16_f32 v169, v146, v147
  v_mfma_f32_16x16x32_bf16 v[68:71], v[196:199], v[184:187], v[68:71]
  v_cvt_pk_bf16_f32 v172, v148, v149
  v_mfma_f32_16x16x32_bf16 v[108:111], v[196:199], v[188:191], v[108:111]
  v_cvt_pk_bf16_f32 v173, v150, v151
  s_waitcnt lgkmcnt(14)
  v_mfma_f32_16x16x32_bf16 v[32:35], v[200:203], v[180:183], v[32:35]
  v_cvt_pk_bf16_f32 v176, v152, v153
  v_mfma_f32_16x16x32_bf16 v[72:75], v[200:203], v[184:187], v[72:75]
  v_cvt_pk_bf16_f32 v177, v154, v155
  v_mfma_f32_16x16x32_bf16 v[112:115], v[200:203], v[188:191], v[112:115]
  v_cvt_pk_bf16_f32 v170, v156, v157
  s_waitcnt lgkmcnt(12)
  v_mfma_f32_16x16x32_bf16 v[36:39], v[204:207], v[180:183], v[36:39]
  v_cvt_pk_bf16_f32 v171, v158, v159
  v_mfma_f32_16x16x32_bf16 v[76:79], v[204:207], v[184:187], v[76:79]
  v_cvt_pk_bf16_f32 v174, v160, v161
  v_mfma_f32_16x16x32_bf16 v[116:119], v[204:207], v[188:191], v[116:119]
  v_cvt_pk_bf16_f32 v175, v162, v163
  s_waitcnt lgkmcnt(10)
  v_mfma_f32_16x16x32_bf16 v[40:43], v[208:211], v[180:183], v[40:43]
  v_cvt_pk_bf16_f32 v178, v164, v165
  v_mfma_f32_16x16x32_bf16 v[80:83], v[208:211], v[184:187], v[80:83]
  v_cvt_pk_bf16_f32 v179, v166, v167
  v_mfma_f32_16x16x32_bf16 v[120:123], v[208:211], v[188:191], v[120:123]
  s_waitcnt lgkmcnt(0)
  s_barrier
  v_mfma_f32_16x16x32_bf16 v[44:47], v[212:215], v[180:183], v[44:47]
  ds_read_b64_tr_b16 v[232:233], v8
  v_mfma_f32_16x16x32_bf16 v[84:87], v[212:215], v[184:187], v[84:87]
  ds_read_b64_tr_b16 v[234:235], v8 offset:2048
  v_mfma_f32_16x16x32_bf16 v[124:127], v[212:215], v[188:191], v[124:127]
  ds_read_b64_tr_b16 v[236:237], v8 offset:4096
  v_mfma_f32_16x16x32_bf16 v[48:51], v[216:219], v[180:183], v[48:51]
  ds_read_b64_tr_b16 v[238:239], v9
  v_mfma_f32_16x16x32_bf16 v[88:91], v[216:219], v[184:187], v[88:91]
  ds_read_b64_tr_b16 v[240:241], v9 offset:2048
  v_mfma_f32_16x16x32_bf16 v[128:131], v[216:219], v[188:191], v[128:131]
  ds_read_b64_tr_b16 v[242:243], v9 offset:4096
  v_mfma_f32_16x16x32_bf16 v[52:55], v[220:223], v[180:183], v[52:55]
  v_add_u32 v2, 0xc000, v2
  v_add_u32 v3, 0xc000, v3
  ds_read_b64_tr_b16 v[192:193], v2
  v_mfma_f32_16x16x32_bf16 v[92:95], v[220:223], v[184:187], v[92:95]
  ds_read_b64_tr_b16 v[194:195], v2 offset:10240
  v_mfma_f32_16x16x32_bf16 v[132:135], v[220:223], v[188:191], v[132:135]
  ds_read_b64_tr_b16 v[196:197], v3
  v_mfma_f32_16x16x32_bf16 v[56:59], v[224:227], v[180:183], v[56:59]
  ds_read_b64_tr_b16 v[198:199], v3 offset:10240
  v_mfma_f32_16x16x32_bf16 v[96:99], v[224:227], v[184:187], v[96:99]
  ds_read_b64_tr_b16 v[200:201], v2 offset:1024
  v_mfma_f32_16x16x32_bf16 v[136:139], v[224:227], v[188:191], v[136:139]
  ds_read_b64_tr_b16 v[202:203], v2 offset:11264
  v_mfma_f32_16x16x32_bf16 v[60:63], v[228:231], v[180:183], v[60:63]
  ds_read_b64_tr_b16 v[204:205], v3 offset:1024
  v_mfma_f32_16x16x32_bf16 v[100:103], v[228:231], v[184:187], v[100:103]
  ds_read_b64_tr_b16 v[206:207], v3 offset:11264
  v_mfma_f32_16x16x32_bf16 v[140:143], v[228:231], v[188:191], v[140:143]
  ds_read_b64_tr_b16 v[208:209], v2 offset:2048
  ds_read_b64_tr_b16 v[210:211], v2 offset:12288
  s_waitcnt lgkmcnt(14)
  v_mfma_f32_16x16x32_bf16 v[144:147], v[232:235], v[244:247], 0
  v_mfma_f32_16x16x32_bf16 v[148:151], v[232:235], v[248:251], 0
  ds_read_b64_tr_b16 v[212:213], v3 offset:2048
  v_mfma_f32_16x16x32_bf16 v[152:155], v[232:235], v[252:255], 0
  ds_read_b64_tr_b16 v[214:215], v3 offset:12288
  s_waitcnt lgkmcnt(13)
  v_mfma_f32_16x16x32_bf16 v[156:159], v[238:241], v[244:247], 0
  ds_read_b64_tr_b16 v[216:217], v2 offset:3072
  v_mfma_f32_16x16x32_bf16 v[160:163], v[238:241], v[248:251], 0
  ds_read_b64_tr_b16 v[218:219], v2 offset:13312
  v_mfma_f32_16x16x32_bf16 v[164:167], v[238:241], v[252:255], 0
  ds_read_b64_tr_b16 v[220:221], v3 offset:3072
  v_mfma_f32_16x16x16_bf16 v[144:147], v[236:237], v[14:15], v[144:147]
  ds_read_b64_tr_b16 v[222:223], v3 offset:13312
  v_mfma_f32_16x16x16_bf16 v[148:151], v[236:237], v[16:17], v[148:151]
  ds_read_b64_tr_b16 v[224:225], v2 offset:4096
  v_mfma_f32_16x16x16_bf16 v[152:155], v[236:237], v[18:19], v[152:155]
  ds_read_b64_tr_b16 v[226:227], v2 offset:14336
  s_waitcnt lgkmcnt(15)
  v_mfma_f32_16x16x16_bf16 v[156:159], v[242:243], v[14:15], v[156:159]
  ds_read_b64_tr_b16 v[228:229], v3 offset:4096
  v_mfma_f32_16x16x16_bf16 v[160:163], v[242:243], v[16:17], v[160:163]
  ds_read_b64_tr_b16 v[230:231], v3 offset:14336
  v_mfma_f32_16x16x16_bf16 v[164:167], v[242:243], v[18:19], v[164:167]
  v_mfma_f32_16x16x32_bf16 v[24:27], v[192:195], v[168:171], v[24:27]
  ds_read_b128 v[244:247], v10
  v_mfma_f32_16x16x32_bf16 v[64:67], v[192:195], v[172:175], v[64:67]
  ds_read_b128 v[248:251], v10 offset:1024
  v_mfma_f32_16x16x32_bf16 v[104:107], v[192:195], v[176:179], v[104:107]
  v_cvt_pk_bf16_f32 v180, v144, v145
  ds_read_b128 v[252:255], v10 offset:2048
  s_waitcnt lgkmcnt(15)
  v_mfma_f32_16x16x32_bf16 v[28:31], v[196:199], v[168:171], v[28:31]
  v_cvt_pk_bf16_f32 v181, v146, v147
  ds_read_b128 v[14:17], v10 offset:3072
  v_mfma_f32_16x16x32_bf16 v[68:71], v[196:199], v[172:175], v[68:71]
  v_cvt_pk_bf16_f32 v184, v148, v149
  ds_read_b64 v[18:19], v11
  v_mfma_f32_16x16x32_bf16 v[108:111], v[196:199], v[176:179], v[108:111]
  v_cvt_pk_bf16_f32 v185, v150, v151
  v_mfma_f32_16x16x32_bf16 v[32:35], v[200:203], v[168:171], v[32:35]
  v_cvt_pk_bf16_f32 v188, v152, v153
  v_mfma_f32_16x16x32_bf16 v[72:75], v[200:203], v[172:175], v[72:75]
  v_cvt_pk_bf16_f32 v189, v154, v155
  v_mfma_f32_16x16x32_bf16 v[112:115], v[200:203], v[176:179], v[112:115]
  v_cvt_pk_bf16_f32 v182, v156, v157
  v_mfma_f32_16x16x32_bf16 v[36:39], v[204:207], v[168:171], v[36:39]
  v_cvt_pk_bf16_f32 v183, v158, v159
  v_mfma_f32_16x16x32_bf16 v[76:79], v[204:207], v[172:175], v[76:79]
  v_cvt_pk_bf16_f32 v186, v160, v161
  v_mfma_f32_16x16x32_bf16 v[116:119], v[204:207], v[176:179], v[116:119]
  v_cvt_pk_bf16_f32 v187, v162, v163
  s_waitcnt lgkmcnt(15)
  v_mfma_f32_16x16x32_bf16 v[40:43], v[208:211], v[168:171], v[40:43]
  v_cvt_pk_bf16_f32 v190, v164, v165
  v_mfma_f32_16x16x32_bf16 v[80:83], v[208:211], v[172:175], v[80:83]
  v_cvt_pk_bf16_f32 v191, v166, v167
  v_mfma_f32_16x16x32_bf16 v[120:123], v[208:211], v[176:179], v[120:123]
  s_waitcnt lgkmcnt(0)
  s_barrier
  v_mfma_f32_16x16x32_bf16 v[44:47], v[212:215], v[168:171], v[44:47]
  v_add_u32 v6, 0xe000, v6
  v_add_u32 v7, 0xe000, v7
  v_add_u32 v8, 0xe000, v8
  v_add_u32 v9, 0xe000, v9
  ds_read_b64_tr_b16 v[232:233], v6
  v_mfma_f32_16x16x32_bf16 v[84:87], v[212:215], v[172:175], v[84:87]
  ds_read_b64_tr_b16 v[234:235], v6 offset:2048
  v_mfma_f32_16x16x32_bf16 v[124:127], v[212:215], v[176:179], v[124:127]
  ds_read_b64_tr_b16 v[236:237], v6 offset:4096
  v_mfma_f32_16x16x32_bf16 v[48:51], v[216:219], v[168:171], v[48:51]
  ds_read_b64_tr_b16 v[238:239], v7
  v_mfma_f32_16x16x32_bf16 v[88:91], v[216:219], v[172:175], v[88:91]
  ds_read_b64_tr_b16 v[240:241], v7 offset:2048
  v_mfma_f32_16x16x32_bf16 v[128:131], v[216:219], v[176:179], v[128:131]
  ds_read_b64_tr_b16 v[242:243], v7 offset:4096
  v_mfma_f32_16x16x32_bf16 v[52:55], v[220:223], v[168:171], v[52:55]
  v_add_u32 v2, 0xfffe2000, v2
  v_add_u32 v3, 0xfffe2000, v3
  ds_read_b64_tr_b16 v[192:193], v2
  v_mfma_f32_16x16x32_bf16 v[92:95], v[220:223], v[172:175], v[92:95]
  ds_read_b64_tr_b16 v[194:195], v2 offset:10240
  v_mfma_f32_16x16x32_bf16 v[132:135], v[220:223], v[176:179], v[132:135]
  ds_read_b64_tr_b16 v[196:197], v3
  v_mfma_f32_16x16x32_bf16 v[56:59], v[224:227], v[168:171], v[56:59]
  ds_read_b64_tr_b16 v[198:199], v3 offset:10240
  v_mfma_f32_16x16x32_bf16 v[96:99], v[224:227], v[172:175], v[96:99]
  ds_read_b64_tr_b16 v[200:201], v2 offset:1024
  v_mfma_f32_16x16x32_bf16 v[136:139], v[224:227], v[176:179], v[136:139]
  ds_read_b64_tr_b16 v[202:203], v2 offset:11264
  v_mfma_f32_16x16x32_bf16 v[60:63], v[228:231], v[168:171], v[60:63]
  ds_read_b64_tr_b16 v[204:205], v3 offset:1024
  v_mfma_f32_16x16x32_bf16 v[100:103], v[228:231], v[172:175], v[100:103]
  ds_read_b64_tr_b16 v[206:207], v3 offset:11264
  v_mfma_f32_16x16x32_bf16 v[140:143], v[228:231], v[176:179], v[140:143]
  ds_read_b64_tr_b16 v[208:209], v2 offset:2048
  ds_read_b64_tr_b16 v[210:211], v2 offset:12288
  s_waitcnt lgkmcnt(14)
  v_mfma_f32_16x16x32_bf16 v[144:147], v[232:235], v[244:247], 0
  v_mfma_f32_16x16x32_bf16 v[148:151], v[232:235], v[248:251], 0
  ds_read_b64_tr_b16 v[212:213], v3 offset:2048
  v_mfma_f32_16x16x32_bf16 v[152:155], v[232:235], v[252:255], 0
  ds_read_b64_tr_b16 v[214:215], v3 offset:12288
  s_waitcnt lgkmcnt(13)
  v_mfma_f32_16x16x32_bf16 v[156:159], v[238:241], v[244:247], 0
  ds_read_b64_tr_b16 v[216:217], v2 offset:3072
  v_mfma_f32_16x16x32_bf16 v[160:163], v[238:241], v[248:251], 0
  ds_read_b64_tr_b16 v[218:219], v2 offset:13312
  v_mfma_f32_16x16x32_bf16 v[164:167], v[238:241], v[252:255], 0
  ds_read_b64_tr_b16 v[220:221], v3 offset:3072
  v_mfma_f32_16x16x16_bf16 v[144:147], v[236:237], v[14:15], v[144:147]
  ds_read_b64_tr_b16 v[222:223], v3 offset:13312
  v_mfma_f32_16x16x16_bf16 v[148:151], v[236:237], v[16:17], v[148:151]
  ds_read_b64_tr_b16 v[224:225], v2 offset:4096
  v_mfma_f32_16x16x16_bf16 v[152:155], v[236:237], v[18:19], v[152:155]
  ds_read_b64_tr_b16 v[226:227], v2 offset:14336
  s_waitcnt lgkmcnt(15)
  v_mfma_f32_16x16x16_bf16 v[156:159], v[242:243], v[14:15], v[156:159]
  ds_read_b64_tr_b16 v[228:229], v3 offset:4096
  v_mfma_f32_16x16x16_bf16 v[160:163], v[242:243], v[16:17], v[160:163]
  ds_read_b64_tr_b16 v[230:231], v3 offset:14336
  v_mfma_f32_16x16x16_bf16 v[164:167], v[242:243], v[18:19], v[164:167]
  v_mfma_f32_16x16x32_bf16 v[24:27], v[192:195], v[180:183], v[24:27]
  v_mfma_f32_16x16x32_bf16 v[64:67], v[192:195], v[184:187], v[64:67]
  v_mfma_f32_16x16x32_bf16 v[104:107], v[192:195], v[188:191], v[104:107]
  v_cvt_pk_bf16_f32 v168, v144, v145
  s_waitcnt lgkmcnt(15)
  v_mfma_f32_16x16x32_bf16 v[28:31], v[196:199], v[180:183], v[28:31]
  v_cvt_pk_bf16_f32 v169, v146, v147
  v_mfma_f32_16x16x32_bf16 v[68:71], v[196:199], v[184:187], v[68:71]
  v_cvt_pk_bf16_f32 v172, v148, v149
  v_mfma_f32_16x16x32_bf16 v[108:111], v[196:199], v[188:191], v[108:111]
  v_cvt_pk_bf16_f32 v173, v150, v151
  s_waitcnt lgkmcnt(14)
  v_mfma_f32_16x16x32_bf16 v[32:35], v[200:203], v[180:183], v[32:35]
  v_cvt_pk_bf16_f32 v176, v152, v153
  v_mfma_f32_16x16x32_bf16 v[72:75], v[200:203], v[184:187], v[72:75]
  v_cvt_pk_bf16_f32 v177, v154, v155
  v_mfma_f32_16x16x32_bf16 v[112:115], v[200:203], v[188:191], v[112:115]
  v_cvt_pk_bf16_f32 v170, v156, v157
  s_waitcnt lgkmcnt(12)
  v_mfma_f32_16x16x32_bf16 v[36:39], v[204:207], v[180:183], v[36:39]
  v_cvt_pk_bf16_f32 v171, v158, v159
  v_mfma_f32_16x16x32_bf16 v[76:79], v[204:207], v[184:187], v[76:79]
  v_cvt_pk_bf16_f32 v174, v160, v161
  v_mfma_f32_16x16x32_bf16 v[116:119], v[204:207], v[188:191], v[116:119]
  v_cvt_pk_bf16_f32 v175, v162, v163
  s_waitcnt lgkmcnt(10)
  v_mfma_f32_16x16x32_bf16 v[40:43], v[208:211], v[180:183], v[40:43]
  v_cvt_pk_bf16_f32 v178, v164, v165
  v_mfma_f32_16x16x32_bf16 v[80:83], v[208:211], v[184:187], v[80:83]
  v_cvt_pk_bf16_f32 v179, v166, v167
  v_mfma_f32_16x16x32_bf16 v[120:123], v[208:211], v[188:191], v[120:123]
  s_waitcnt lgkmcnt(0)
  s_barrier
  v_mfma_f32_16x16x32_bf16 v[44:47], v[212:215], v[180:183], v[44:47]
  ds_read_b64_tr_b16 v[232:233], v8
  v_mfma_f32_16x16x32_bf16 v[84:87], v[212:215], v[184:187], v[84:87]
  ds_read_b64_tr_b16 v[234:235], v8 offset:2048
  v_mfma_f32_16x16x32_bf16 v[124:127], v[212:215], v[188:191], v[124:127]
  ds_read_b64_tr_b16 v[236:237], v8 offset:4096
  v_mfma_f32_16x16x32_bf16 v[48:51], v[216:219], v[180:183], v[48:51]
  ds_read_b64_tr_b16 v[238:239], v9
  v_mfma_f32_16x16x32_bf16 v[88:91], v[216:219], v[184:187], v[88:91]
  ds_read_b64_tr_b16 v[240:241], v9 offset:2048
  v_mfma_f32_16x16x32_bf16 v[128:131], v[216:219], v[188:191], v[128:131]
  ds_read_b64_tr_b16 v[242:243], v9 offset:4096
  v_mfma_f32_16x16x32_bf16 v[52:55], v[220:223], v[180:183], v[52:55]
  v_add_u32 v2, 0x8000, v2
  v_add_u32 v3, 0x8000, v3
  ds_read_b64_tr_b16 v[192:193], v2
  v_mfma_f32_16x16x32_bf16 v[92:95], v[220:223], v[184:187], v[92:95]
  ds_read_b64_tr_b16 v[194:195], v2 offset:10240
  v_mfma_f32_16x16x32_bf16 v[132:135], v[220:223], v[188:191], v[132:135]
  ds_read_b64_tr_b16 v[196:197], v3
  v_mfma_f32_16x16x32_bf16 v[56:59], v[224:227], v[180:183], v[56:59]
  ds_read_b64_tr_b16 v[198:199], v3 offset:10240
  v_mfma_f32_16x16x32_bf16 v[96:99], v[224:227], v[184:187], v[96:99]
  ds_read_b64_tr_b16 v[200:201], v2 offset:1024
  v_mfma_f32_16x16x32_bf16 v[136:139], v[224:227], v[188:191], v[136:139]
  ds_read_b64_tr_b16 v[202:203], v2 offset:11264
  v_mfma_f32_16x16x32_bf16 v[60:63], v[228:231], v[180:183], v[60:63]
  ds_read_b64_tr_b16 v[204:205], v3 offset:1024
  v_mfma_f32_16x16x32_bf16 v[100:103], v[228:231], v[184:187], v[100:103]
  ds_read_b64_tr_b16 v[206:207], v3 offset:11264
  v_mfma_f32_16x16x32_bf16 v[140:143], v[228:231], v[188:191], v[140:143]
  ds_read_b64_tr_b16 v[208:209], v2 offset:2048
  ds_read_b64_tr_b16 v[210:211], v2 offset:12288
  s_waitcnt lgkmcnt(14)
  v_mfma_f32_16x16x32_bf16 v[144:147], v[232:235], v[244:247], 0
  v_mfma_f32_16x16x32_bf16 v[148:151], v[232:235], v[248:251], 0
  ds_read_b64_tr_b16 v[212:213], v3 offset:2048
  v_mfma_f32_16x16x32_bf16 v[152:155], v[232:235], v[252:255], 0
  ds_read_b64_tr_b16 v[214:215], v3 offset:12288
  s_waitcnt lgkmcnt(13)
  v_mfma_f32_16x16x32_bf16 v[156:159], v[238:241], v[244:247], 0
  ds_read_b64_tr_b16 v[216:217], v2 offset:3072
  v_mfma_f32_16x16x32_bf16 v[160:163], v[238:241], v[248:251], 0
  ds_read_b64_tr_b16 v[218:219], v2 offset:13312
  v_mfma_f32_16x16x32_bf16 v[164:167], v[238:241], v[252:255], 0
  ds_read_b64_tr_b16 v[220:221], v3 offset:3072
  v_mfma_f32_16x16x16_bf16 v[144:147], v[236:237], v[14:15], v[144:147]
  ds_read_b64_tr_b16 v[222:223], v3 offset:13312
  v_mfma_f32_16x16x16_bf16 v[148:151], v[236:237], v[16:17], v[148:151]
  ds_read_b64_tr_b16 v[224:225], v2 offset:4096
  v_mfma_f32_16x16x16_bf16 v[152:155], v[236:237], v[18:19], v[152:155]
  ds_read_b64_tr_b16 v[226:227], v2 offset:14336
  s_waitcnt lgkmcnt(15)
  v_mfma_f32_16x16x16_bf16 v[156:159], v[242:243], v[14:15], v[156:159]
  ds_read_b64_tr_b16 v[228:229], v3 offset:4096
  v_mfma_f32_16x16x16_bf16 v[160:163], v[242:243], v[16:17], v[160:163]
  ds_read_b64_tr_b16 v[230:231], v3 offset:14336
  v_mfma_f32_16x16x16_bf16 v[164:167], v[242:243], v[18:19], v[164:167]
  v_mfma_f32_16x16x32_bf16 v[24:27], v[192:195], v[168:171], v[24:27]
  v_mfma_f32_16x16x32_bf16 v[64:67], v[192:195], v[172:175], v[64:67]
  v_mfma_f32_16x16x32_bf16 v[104:107], v[192:195], v[176:179], v[104:107]
  v_cvt_pk_bf16_f32 v180, v144, v145
  s_waitcnt lgkmcnt(15)
  v_mfma_f32_16x16x32_bf16 v[28:31], v[196:199], v[168:171], v[28:31]
  v_cvt_pk_bf16_f32 v181, v146, v147
  v_mfma_f32_16x16x32_bf16 v[68:71], v[196:199], v[172:175], v[68:71]
  v_cvt_pk_bf16_f32 v184, v148, v149
  v_mfma_f32_16x16x32_bf16 v[108:111], v[196:199], v[176:179], v[108:111]
  v_cvt_pk_bf16_f32 v185, v150, v151
  s_waitcnt lgkmcnt(14)
  v_mfma_f32_16x16x32_bf16 v[32:35], v[200:203], v[168:171], v[32:35]
  v_cvt_pk_bf16_f32 v188, v152, v153
  v_mfma_f32_16x16x32_bf16 v[72:75], v[200:203], v[172:175], v[72:75]
  v_cvt_pk_bf16_f32 v189, v154, v155
  v_mfma_f32_16x16x32_bf16 v[112:115], v[200:203], v[176:179], v[112:115]
  v_cvt_pk_bf16_f32 v182, v156, v157
  s_waitcnt lgkmcnt(12)
  v_mfma_f32_16x16x32_bf16 v[36:39], v[204:207], v[168:171], v[36:39]
  v_cvt_pk_bf16_f32 v183, v158, v159
  v_mfma_f32_16x16x32_bf16 v[76:79], v[204:207], v[172:175], v[76:79]
  v_cvt_pk_bf16_f32 v186, v160, v161
  v_mfma_f32_16x16x32_bf16 v[116:119], v[204:207], v[176:179], v[116:119]
  v_cvt_pk_bf16_f32 v187, v162, v163
  s_waitcnt lgkmcnt(10)
  v_mfma_f32_16x16x32_bf16 v[40:43], v[208:211], v[168:171], v[40:43]
  v_cvt_pk_bf16_f32 v190, v164, v165
  v_mfma_f32_16x16x32_bf16 v[80:83], v[208:211], v[172:175], v[80:83]
  v_cvt_pk_bf16_f32 v191, v166, v167
  v_mfma_f32_16x16x32_bf16 v[120:123], v[208:211], v[176:179], v[120:123]
  s_waitcnt lgkmcnt(0)
  s_barrier
  v_mfma_f32_16x16x32_bf16 v[44:47], v[212:215], v[168:171], v[44:47]
  v_add_u32 v6, 0xfffe0000, v6
  v_add_u32 v7, 0xfffe0000, v7
  v_add_u32 v8, 0xfffe0000, v8
  v_add_u32 v9, 0xfffe0000, v9
  ds_read_b64_tr_b16 v[232:233], v6
  v_mfma_f32_16x16x32_bf16 v[84:87], v[212:215], v[172:175], v[84:87]
  ds_read_b64_tr_b16 v[234:235], v6 offset:2048
  v_mfma_f32_16x16x32_bf16 v[124:127], v[212:215], v[176:179], v[124:127]
  ds_read_b64_tr_b16 v[236:237], v6 offset:4096
  v_mfma_f32_16x16x32_bf16 v[48:51], v[216:219], v[168:171], v[48:51]
  ds_read_b64_tr_b16 v[238:239], v7
  v_mfma_f32_16x16x32_bf16 v[88:91], v[216:219], v[172:175], v[88:91]
  ds_read_b64_tr_b16 v[240:241], v7 offset:2048
  v_mfma_f32_16x16x32_bf16 v[128:131], v[216:219], v[176:179], v[128:131]
  ds_read_b64_tr_b16 v[242:243], v7 offset:4096
  v_mfma_f32_16x16x32_bf16 v[52:55], v[220:223], v[168:171], v[52:55]
  v_add_u32 v2, 0x5000, v2
  v_add_u32 v3, 0x5000, v3
  ds_read_b64_tr_b16 v[192:193], v2
  v_mfma_f32_16x16x32_bf16 v[92:95], v[220:223], v[172:175], v[92:95]
  ds_read_b64_tr_b16 v[194:195], v2 offset:10240
  v_mfma_f32_16x16x32_bf16 v[132:135], v[220:223], v[176:179], v[132:135]
  ds_read_b64_tr_b16 v[196:197], v3
  v_mfma_f32_16x16x32_bf16 v[56:59], v[224:227], v[168:171], v[56:59]
  ds_read_b64_tr_b16 v[198:199], v3 offset:10240
  v_mfma_f32_16x16x32_bf16 v[96:99], v[224:227], v[172:175], v[96:99]
  ds_read_b64_tr_b16 v[200:201], v2 offset:1024
  v_mfma_f32_16x16x32_bf16 v[136:139], v[224:227], v[176:179], v[136:139]
  ds_read_b64_tr_b16 v[202:203], v2 offset:11264
  v_mfma_f32_16x16x32_bf16 v[60:63], v[228:231], v[168:171], v[60:63]
  ds_read_b64_tr_b16 v[204:205], v3 offset:1024
  v_mfma_f32_16x16x32_bf16 v[100:103], v[228:231], v[172:175], v[100:103]
  ds_read_b64_tr_b16 v[206:207], v3 offset:11264
  v_mfma_f32_16x16x32_bf16 v[140:143], v[228:231], v[176:179], v[140:143]
  ds_read_b64_tr_b16 v[208:209], v2 offset:2048
  ds_read_b64_tr_b16 v[210:211], v2 offset:12288
  s_waitcnt lgkmcnt(14)
  v_mfma_f32_16x16x32_bf16 v[144:147], v[232:235], v[244:247], 0
  v_mfma_f32_16x16x32_bf16 v[148:151], v[232:235], v[248:251], 0
  ds_read_b64_tr_b16 v[212:213], v3 offset:2048
  v_mfma_f32_16x16x32_bf16 v[152:155], v[232:235], v[252:255], 0
  ds_read_b64_tr_b16 v[214:215], v3 offset:12288
  s_waitcnt lgkmcnt(13)
  v_mfma_f32_16x16x32_bf16 v[156:159], v[238:241], v[244:247], 0
  ds_read_b64_tr_b16 v[216:217], v2 offset:3072
  v_mfma_f32_16x16x32_bf16 v[160:163], v[238:241], v[248:251], 0
  ds_read_b64_tr_b16 v[218:219], v2 offset:13312
  v_mfma_f32_16x16x32_bf16 v[164:167], v[238:241], v[252:255], 0
  ds_read_b64_tr_b16 v[220:221], v3 offset:3072
  v_mfma_f32_16x16x16_bf16 v[144:147], v[236:237], v[14:15], v[144:147]
  ds_read_b64_tr_b16 v[222:223], v3 offset:13312
  v_mfma_f32_16x16x16_bf16 v[148:151], v[236:237], v[16:17], v[148:151]
  ds_read_b64_tr_b16 v[224:225], v2 offset:4096
  v_mfma_f32_16x16x16_bf16 v[152:155], v[236:237], v[18:19], v[152:155]
  ds_read_b64_tr_b16 v[226:227], v2 offset:14336
  s_waitcnt lgkmcnt(15)
  v_mfma_f32_16x16x16_bf16 v[156:159], v[242:243], v[14:15], v[156:159]
  ds_read_b64_tr_b16 v[228:229], v3 offset:4096
  v_mfma_f32_16x16x16_bf16 v[160:163], v[242:243], v[16:17], v[160:163]
  ds_read_b64_tr_b16 v[230:231], v3 offset:14336
  v_mfma_f32_16x16x16_bf16 v[164:167], v[242:243], v[18:19], v[164:167]
  v_mfma_f32_16x16x32_bf16 v[24:27], v[192:195], v[180:183], v[24:27]
  v_mfma_f32_16x16x32_bf16 v[64:67], v[192:195], v[184:187], v[64:67]
  v_mfma_f32_16x16x32_bf16 v[104:107], v[192:195], v[188:191], v[104:107]
  v_cvt_pk_bf16_f32 v168, v144, v145
  s_waitcnt lgkmcnt(15)
  v_mfma_f32_16x16x32_bf16 v[28:31], v[196:199], v[180:183], v[28:31]
  v_cvt_pk_bf16_f32 v169, v146, v147
  v_mfma_f32_16x16x32_bf16 v[68:71], v[196:199], v[184:187], v[68:71]
  v_cvt_pk_bf16_f32 v172, v148, v149
  v_mfma_f32_16x16x32_bf16 v[108:111], v[196:199], v[188:191], v[108:111]
  v_cvt_pk_bf16_f32 v173, v150, v151
  s_waitcnt lgkmcnt(14)
  v_mfma_f32_16x16x32_bf16 v[32:35], v[200:203], v[180:183], v[32:35]
  v_cvt_pk_bf16_f32 v176, v152, v153
  v_mfma_f32_16x16x32_bf16 v[72:75], v[200:203], v[184:187], v[72:75]
  v_cvt_pk_bf16_f32 v177, v154, v155
  v_mfma_f32_16x16x32_bf16 v[112:115], v[200:203], v[188:191], v[112:115]
  v_cvt_pk_bf16_f32 v170, v156, v157
  s_waitcnt lgkmcnt(12)
  v_mfma_f32_16x16x32_bf16 v[36:39], v[204:207], v[180:183], v[36:39]
  v_cvt_pk_bf16_f32 v171, v158, v159
  v_mfma_f32_16x16x32_bf16 v[76:79], v[204:207], v[184:187], v[76:79]
  v_cvt_pk_bf16_f32 v174, v160, v161
  v_mfma_f32_16x16x32_bf16 v[116:119], v[204:207], v[188:191], v[116:119]
  v_cvt_pk_bf16_f32 v175, v162, v163
  s_waitcnt lgkmcnt(10)
  v_mfma_f32_16x16x32_bf16 v[40:43], v[208:211], v[180:183], v[40:43]
  v_cvt_pk_bf16_f32 v178, v164, v165
  v_mfma_f32_16x16x32_bf16 v[80:83], v[208:211], v[184:187], v[80:83]
  v_cvt_pk_bf16_f32 v179, v166, v167
  v_mfma_f32_16x16x32_bf16 v[120:123], v[208:211], v[188:191], v[120:123]
  s_waitcnt lgkmcnt(0)
  s_barrier
  v_mfma_f32_16x16x32_bf16 v[44:47], v[212:215], v[180:183], v[44:47]
  ds_read_b64_tr_b16 v[232:233], v8
  v_mfma_f32_16x16x32_bf16 v[84:87], v[212:215], v[184:187], v[84:87]
  ds_read_b64_tr_b16 v[234:235], v8 offset:2048
  v_mfma_f32_16x16x32_bf16 v[124:127], v[212:215], v[188:191], v[124:127]
  ds_read_b64_tr_b16 v[236:237], v8 offset:4096
  v_mfma_f32_16x16x32_bf16 v[48:51], v[216:219], v[180:183], v[48:51]
  ds_read_b64_tr_b16 v[238:239], v9
  v_mfma_f32_16x16x32_bf16 v[88:91], v[216:219], v[184:187], v[88:91]
  ds_read_b64_tr_b16 v[240:241], v9 offset:2048
  v_mfma_f32_16x16x32_bf16 v[128:131], v[216:219], v[188:191], v[128:131]
  ds_read_b64_tr_b16 v[242:243], v9 offset:4096
  v_mfma_f32_16x16x32_bf16 v[52:55], v[220:223], v[180:183], v[52:55]
  v_add_u32 v2, 0x5000, v2
  v_add_u32 v3, 0x5000, v3
  ds_read_b64_tr_b16 v[192:193], v2
  v_mfma_f32_16x16x32_bf16 v[92:95], v[220:223], v[184:187], v[92:95]
  ds_read_b64_tr_b16 v[194:195], v2 offset:10240
  v_mfma_f32_16x16x32_bf16 v[132:135], v[220:223], v[188:191], v[132:135]
  ds_read_b64_tr_b16 v[196:197], v3
  v_mfma_f32_16x16x32_bf16 v[56:59], v[224:227], v[180:183], v[56:59]
  ds_read_b64_tr_b16 v[198:199], v3 offset:10240
  v_mfma_f32_16x16x32_bf16 v[96:99], v[224:227], v[184:187], v[96:99]
  ds_read_b64_tr_b16 v[200:201], v2 offset:1024
  v_mfma_f32_16x16x32_bf16 v[136:139], v[224:227], v[188:191], v[136:139]
  ds_read_b64_tr_b16 v[202:203], v2 offset:11264
  v_mfma_f32_16x16x32_bf16 v[60:63], v[228:231], v[180:183], v[60:63]
  ds_read_b64_tr_b16 v[204:205], v3 offset:1024
  v_mfma_f32_16x16x32_bf16 v[100:103], v[228:231], v[184:187], v[100:103]
  ds_read_b64_tr_b16 v[206:207], v3 offset:11264
  v_mfma_f32_16x16x32_bf16 v[140:143], v[228:231], v[188:191], v[140:143]
  ds_read_b64_tr_b16 v[208:209], v2 offset:2048
  ds_read_b64_tr_b16 v[210:211], v2 offset:12288
  s_waitcnt lgkmcnt(14)
  v_mfma_f32_16x16x32_bf16 v[144:147], v[232:235], v[244:247], 0
  v_mfma_f32_16x16x32_bf16 v[148:151], v[232:235], v[248:251], 0
  ds_read_b64_tr_b16 v[212:213], v3 offset:2048
  v_mfma_f32_16x16x32_bf16 v[152:155], v[232:235], v[252:255], 0
  ds_read_b64_tr_b16 v[214:215], v3 offset:12288
  s_waitcnt lgkmcnt(13)
  v_mfma_f32_16x16x32_bf16 v[156:159], v[238:241], v[244:247], 0
  ds_read_b64_tr_b16 v[216:217], v2 offset:3072
  v_mfma_f32_16x16x32_bf16 v[160:163], v[238:241], v[248:251], 0
  ds_read_b64_tr_b16 v[218:219], v2 offset:13312
  v_mfma_f32_16x16x32_bf16 v[164:167], v[238:241], v[252:255], 0
  ds_read_b64_tr_b16 v[220:221], v3 offset:3072
  v_mfma_f32_16x16x16_bf16 v[144:147], v[236:237], v[14:15], v[144:147]
  ds_read_b64_tr_b16 v[222:223], v3 offset:13312
  v_mfma_f32_16x16x16_bf16 v[148:151], v[236:237], v[16:17], v[148:151]
  ds_read_b64_tr_b16 v[224:225], v2 offset:4096
  v_mfma_f32_16x16x16_bf16 v[152:155], v[236:237], v[18:19], v[152:155]
  ds_read_b64_tr_b16 v[226:227], v2 offset:14336
  s_waitcnt lgkmcnt(15)
  v_mfma_f32_16x16x16_bf16 v[156:159], v[242:243], v[14:15], v[156:159]
  ds_read_b64_tr_b16 v[228:229], v3 offset:4096
  v_mfma_f32_16x16x16_bf16 v[160:163], v[242:243], v[16:17], v[160:163]
  ds_read_b64_tr_b16 v[230:231], v3 offset:14336
  v_mfma_f32_16x16x16_bf16 v[164:167], v[242:243], v[18:19], v[164:167]
  v_mfma_f32_16x16x32_bf16 v[24:27], v[192:195], v[168:171], v[24:27]
  v_mfma_f32_16x16x32_bf16 v[64:67], v[192:195], v[172:175], v[64:67]
  v_mfma_f32_16x16x32_bf16 v[104:107], v[192:195], v[176:179], v[104:107]
  v_cvt_pk_bf16_f32 v180, v144, v145
  s_waitcnt lgkmcnt(15)
  v_mfma_f32_16x16x32_bf16 v[28:31], v[196:199], v[168:171], v[28:31]
  v_cvt_pk_bf16_f32 v181, v146, v147
  v_mfma_f32_16x16x32_bf16 v[68:71], v[196:199], v[172:175], v[68:71]
  v_cvt_pk_bf16_f32 v184, v148, v149
  v_mfma_f32_16x16x32_bf16 v[108:111], v[196:199], v[176:179], v[108:111]
  v_cvt_pk_bf16_f32 v185, v150, v151
  s_waitcnt lgkmcnt(14)
  v_mfma_f32_16x16x32_bf16 v[32:35], v[200:203], v[168:171], v[32:35]
  v_cvt_pk_bf16_f32 v188, v152, v153
  v_mfma_f32_16x16x32_bf16 v[72:75], v[200:203], v[172:175], v[72:75]
  v_cvt_pk_bf16_f32 v189, v154, v155
  v_mfma_f32_16x16x32_bf16 v[112:115], v[200:203], v[176:179], v[112:115]
  v_cvt_pk_bf16_f32 v182, v156, v157
  s_waitcnt lgkmcnt(12)
  v_mfma_f32_16x16x32_bf16 v[36:39], v[204:207], v[168:171], v[36:39]
  v_cvt_pk_bf16_f32 v183, v158, v159
  v_mfma_f32_16x16x32_bf16 v[76:79], v[204:207], v[172:175], v[76:79]
  v_cvt_pk_bf16_f32 v186, v160, v161
  v_mfma_f32_16x16x32_bf16 v[116:119], v[204:207], v[176:179], v[116:119]
  v_cvt_pk_bf16_f32 v187, v162, v163
  s_waitcnt lgkmcnt(10)
  v_mfma_f32_16x16x32_bf16 v[40:43], v[208:211], v[168:171], v[40:43]
  v_cvt_pk_bf16_f32 v190, v164, v165
  v_mfma_f32_16x16x32_bf16 v[80:83], v[208:211], v[172:175], v[80:83]
  v_cvt_pk_bf16_f32 v191, v166, v167
  v_mfma_f32_16x16x32_bf16 v[120:123], v[208:211], v[176:179], v[120:123]
  s_waitcnt lgkmcnt(0)
  s_barrier
  v_mfma_f32_16x16x32_bf16 v[44:47], v[212:215], v[168:171], v[44:47]
  v_add_u32 v6, 0x12000, v6
  v_add_u32 v7, 0x12000, v7
  v_add_u32 v8, 0x12000, v8
  v_add_u32 v9, 0x12000, v9
  ds_read_b64_tr_b16 v[232:233], v6
  v_mfma_f32_16x16x32_bf16 v[84:87], v[212:215], v[172:175], v[84:87]
  ds_read_b64_tr_b16 v[234:235], v6 offset:2048
  v_mfma_f32_16x16x32_bf16 v[124:127], v[212:215], v[176:179], v[124:127]
  ds_read_b64_tr_b16 v[236:237], v6 offset:4096
  v_mfma_f32_16x16x32_bf16 v[48:51], v[216:219], v[168:171], v[48:51]
  ds_read_b64_tr_b16 v[238:239], v7
  v_mfma_f32_16x16x32_bf16 v[88:91], v[216:219], v[172:175], v[88:91]
  ds_read_b64_tr_b16 v[240:241], v7 offset:2048
  v_mfma_f32_16x16x32_bf16 v[128:131], v[216:219], v[176:179], v[128:131]
  ds_read_b64_tr_b16 v[242:243], v7 offset:4096
  v_mfma_f32_16x16x32_bf16 v[52:55], v[220:223], v[168:171], v[52:55]
  v_add_u32 v2, 0xc000, v2
  v_add_u32 v3, 0xc000, v3
  ds_read_b64_tr_b16 v[192:193], v2
  v_mfma_f32_16x16x32_bf16 v[92:95], v[220:223], v[172:175], v[92:95]
  ds_read_b64_tr_b16 v[194:195], v2 offset:10240
  v_mfma_f32_16x16x32_bf16 v[132:135], v[220:223], v[176:179], v[132:135]
  ds_read_b64_tr_b16 v[196:197], v3
  v_mfma_f32_16x16x32_bf16 v[56:59], v[224:227], v[168:171], v[56:59]
  ds_read_b64_tr_b16 v[198:199], v3 offset:10240
  v_mfma_f32_16x16x32_bf16 v[96:99], v[224:227], v[172:175], v[96:99]
  ds_read_b64_tr_b16 v[200:201], v2 offset:1024
  v_mfma_f32_16x16x32_bf16 v[136:139], v[224:227], v[176:179], v[136:139]
  ds_read_b64_tr_b16 v[202:203], v2 offset:11264
  v_mfma_f32_16x16x32_bf16 v[60:63], v[228:231], v[168:171], v[60:63]
  ds_read_b64_tr_b16 v[204:205], v3 offset:1024
  v_mfma_f32_16x16x32_bf16 v[100:103], v[228:231], v[172:175], v[100:103]
  ds_read_b64_tr_b16 v[206:207], v3 offset:11264
  v_mfma_f32_16x16x32_bf16 v[140:143], v[228:231], v[176:179], v[140:143]
  ds_read_b64_tr_b16 v[208:209], v2 offset:2048
  ds_read_b64_tr_b16 v[210:211], v2 offset:12288
  s_waitcnt lgkmcnt(14)
  v_mfma_f32_16x16x32_bf16 v[144:147], v[232:235], v[244:247], 0
  v_mfma_f32_16x16x32_bf16 v[148:151], v[232:235], v[248:251], 0
  ds_read_b64_tr_b16 v[212:213], v3 offset:2048
  v_mfma_f32_16x16x32_bf16 v[152:155], v[232:235], v[252:255], 0
  ds_read_b64_tr_b16 v[214:215], v3 offset:12288
  s_waitcnt lgkmcnt(13)
  v_mfma_f32_16x16x32_bf16 v[156:159], v[238:241], v[244:247], 0
  ds_read_b64_tr_b16 v[216:217], v2 offset:3072
  v_mfma_f32_16x16x32_bf16 v[160:163], v[238:241], v[248:251], 0
  ds_read_b64_tr_b16 v[218:219], v2 offset:13312
  v_mfma_f32_16x16x32_bf16 v[164:167], v[238:241], v[252:255], 0
  ds_read_b64_tr_b16 v[220:221], v3 offset:3072
  v_mfma_f32_16x16x16_bf16 v[144:147], v[236:237], v[14:15], v[144:147]
  ds_read_b64_tr_b16 v[222:223], v3 offset:13312
  v_mfma_f32_16x16x16_bf16 v[148:151], v[236:237], v[16:17], v[148:151]
  ds_read_b64_tr_b16 v[224:225], v2 offset:4096
  v_mfma_f32_16x16x16_bf16 v[152:155], v[236:237], v[18:19], v[152:155]
  ds_read_b64_tr_b16 v[226:227], v2 offset:14336
  s_waitcnt lgkmcnt(15)
  v_mfma_f32_16x16x16_bf16 v[156:159], v[242:243], v[14:15], v[156:159]
  ds_read_b64_tr_b16 v[228:229], v3 offset:4096
  v_mfma_f32_16x16x16_bf16 v[160:163], v[242:243], v[16:17], v[160:163]
  ds_read_b64_tr_b16 v[230:231], v3 offset:14336
  v_mfma_f32_16x16x16_bf16 v[164:167], v[242:243], v[18:19], v[164:167]
  v_mfma_f32_16x16x32_bf16 v[24:27], v[192:195], v[180:183], v[24:27]
  v_mfma_f32_16x16x32_bf16 v[64:67], v[192:195], v[184:187], v[64:67]
  v_mfma_f32_16x16x32_bf16 v[104:107], v[192:195], v[188:191], v[104:107]
  v_cvt_pk_bf16_f32 v168, v144, v145
  s_waitcnt lgkmcnt(15)
  v_mfma_f32_16x16x32_bf16 v[28:31], v[196:199], v[180:183], v[28:31]
  v_cvt_pk_bf16_f32 v169, v146, v147
  v_mfma_f32_16x16x32_bf16 v[68:71], v[196:199], v[184:187], v[68:71]
  v_cvt_pk_bf16_f32 v172, v148, v149
  v_mfma_f32_16x16x32_bf16 v[108:111], v[196:199], v[188:191], v[108:111]
  v_cvt_pk_bf16_f32 v173, v150, v151
  s_waitcnt lgkmcnt(14)
  v_mfma_f32_16x16x32_bf16 v[32:35], v[200:203], v[180:183], v[32:35]
  v_cvt_pk_bf16_f32 v176, v152, v153
  v_mfma_f32_16x16x32_bf16 v[72:75], v[200:203], v[184:187], v[72:75]
  v_cvt_pk_bf16_f32 v177, v154, v155
  v_mfma_f32_16x16x32_bf16 v[112:115], v[200:203], v[188:191], v[112:115]
  v_cvt_pk_bf16_f32 v170, v156, v157
  s_waitcnt lgkmcnt(12)
  v_mfma_f32_16x16x32_bf16 v[36:39], v[204:207], v[180:183], v[36:39]
  v_cvt_pk_bf16_f32 v171, v158, v159
  v_mfma_f32_16x16x32_bf16 v[76:79], v[204:207], v[184:187], v[76:79]
  v_cvt_pk_bf16_f32 v174, v160, v161
  v_mfma_f32_16x16x32_bf16 v[116:119], v[204:207], v[188:191], v[116:119]
  v_cvt_pk_bf16_f32 v175, v162, v163
  s_waitcnt lgkmcnt(10)
  v_mfma_f32_16x16x32_bf16 v[40:43], v[208:211], v[180:183], v[40:43]
  v_cvt_pk_bf16_f32 v178, v164, v165
  v_mfma_f32_16x16x32_bf16 v[80:83], v[208:211], v[184:187], v[80:83]
  v_cvt_pk_bf16_f32 v179, v166, v167
  v_mfma_f32_16x16x32_bf16 v[120:123], v[208:211], v[188:191], v[120:123]
  s_waitcnt lgkmcnt(0)
  s_barrier
  v_mfma_f32_16x16x32_bf16 v[44:47], v[212:215], v[180:183], v[44:47]
  ds_read_b64_tr_b16 v[232:233], v8
  v_mfma_f32_16x16x32_bf16 v[84:87], v[212:215], v[184:187], v[84:87]
  ds_read_b64_tr_b16 v[234:235], v8 offset:2048
  v_mfma_f32_16x16x32_bf16 v[124:127], v[212:215], v[188:191], v[124:127]
  ds_read_b64_tr_b16 v[236:237], v8 offset:4096
  v_mfma_f32_16x16x32_bf16 v[48:51], v[216:219], v[180:183], v[48:51]
  ds_read_b64_tr_b16 v[238:239], v9
  v_mfma_f32_16x16x32_bf16 v[88:91], v[216:219], v[184:187], v[88:91]
  ds_read_b64_tr_b16 v[240:241], v9 offset:2048
  v_mfma_f32_16x16x32_bf16 v[128:131], v[216:219], v[188:191], v[128:131]
  ds_read_b64_tr_b16 v[242:243], v9 offset:4096
  v_mfma_f32_16x16x32_bf16 v[52:55], v[220:223], v[180:183], v[52:55]
  v_add_u32 v2, 0xfffe2000, v2
  v_add_u32 v3, 0xfffe2000, v3
  ds_read_b64_tr_b16 v[192:193], v2
  v_mfma_f32_16x16x32_bf16 v[92:95], v[220:223], v[184:187], v[92:95]
  ds_read_b64_tr_b16 v[194:195], v2 offset:10240
  v_mfma_f32_16x16x32_bf16 v[132:135], v[220:223], v[188:191], v[132:135]
  ds_read_b64_tr_b16 v[196:197], v3
  v_mfma_f32_16x16x32_bf16 v[56:59], v[224:227], v[180:183], v[56:59]
  ds_read_b64_tr_b16 v[198:199], v3 offset:10240
  v_mfma_f32_16x16x32_bf16 v[96:99], v[224:227], v[184:187], v[96:99]
  ds_read_b64_tr_b16 v[200:201], v2 offset:1024
  v_mfma_f32_16x16x32_bf16 v[136:139], v[224:227], v[188:191], v[136:139]
  ds_read_b64_tr_b16 v[202:203], v2 offset:11264
  v_mfma_f32_16x16x32_bf16 v[60:63], v[228:231], v[180:183], v[60:63]
  ds_read_b64_tr_b16 v[204:205], v3 offset:1024
  v_mfma_f32_16x16x32_bf16 v[100:103], v[228:231], v[184:187], v[100:103]
  ds_read_b64_tr_b16 v[206:207], v3 offset:11264
  v_mfma_f32_16x16x32_bf16 v[140:143], v[228:231], v[188:191], v[140:143]
  ds_read_b64_tr_b16 v[208:209], v2 offset:2048
  ds_read_b64_tr_b16 v[210:211], v2 offset:12288
  s_waitcnt lgkmcnt(14)
  v_mfma_f32_16x16x32_bf16 v[144:147], v[232:235], v[244:247], 0
  v_mfma_f32_16x16x32_bf16 v[148:151], v[232:235], v[248:251], 0
  ds_read_b64_tr_b16 v[212:213], v3 offset:2048
  v_mfma_f32_16x16x32_bf16 v[152:155], v[232:235], v[252:255], 0
  ds_read_b64_tr_b16 v[214:215], v3 offset:12288
  s_waitcnt lgkmcnt(13)
  v_mfma_f32_16x16x32_bf16 v[156:159], v[238:241], v[244:247], 0
  ds_read_b64_tr_b16 v[216:217], v2 offset:3072
  v_mfma_f32_16x16x32_bf16 v[160:163], v[238:241], v[248:251], 0
  ds_read_b64_tr_b16 v[218:219], v2 offset:13312
  v_mfma_f32_16x16x32_bf16 v[164:167], v[238:241], v[252:255], 0
  ds_read_b64_tr_b16 v[220:221], v3 offset:3072
  v_mfma_f32_16x16x16_bf16 v[144:147], v[236:237], v[14:15], v[144:147]
  ds_read_b64_tr_b16 v[222:223], v3 offset:13312
  v_mfma_f32_16x16x16_bf16 v[148:151], v[236:237], v[16:17], v[148:151]
  ds_read_b64_tr_b16 v[224:225], v2 offset:4096
  v_mfma_f32_16x16x16_bf16 v[152:155], v[236:237], v[18:19], v[152:155]
  ds_read_b64_tr_b16 v[226:227], v2 offset:14336
  s_waitcnt lgkmcnt(15)
  v_mfma_f32_16x16x16_bf16 v[156:159], v[242:243], v[14:15], v[156:159]
  ds_read_b64_tr_b16 v[228:229], v3 offset:4096
  v_mfma_f32_16x16x16_bf16 v[160:163], v[242:243], v[16:17], v[160:163]
  ds_read_b64_tr_b16 v[230:231], v3 offset:14336
  v_mfma_f32_16x16x16_bf16 v[164:167], v[242:243], v[18:19], v[164:167]
  v_mfma_f32_16x16x32_bf16 v[24:27], v[192:195], v[168:171], v[24:27]
  ds_read_b128 v[244:247], v10 offset:36864
  v_mfma_f32_16x16x32_bf16 v[64:67], v[192:195], v[172:175], v[64:67]
  ds_read_b128 v[248:251], v10 offset:37888
  v_mfma_f32_16x16x32_bf16 v[104:107], v[192:195], v[176:179], v[104:107]
  v_cvt_pk_bf16_f32 v180, v144, v145
  ds_read_b128 v[252:255], v10 offset:38912
  s_waitcnt lgkmcnt(15)
  v_mfma_f32_16x16x32_bf16 v[28:31], v[196:199], v[168:171], v[28:31]
  v_cvt_pk_bf16_f32 v181, v146, v147
  ds_read_b128 v[14:17], v10 offset:39936
  v_mfma_f32_16x16x32_bf16 v[68:71], v[196:199], v[172:175], v[68:71]
  v_cvt_pk_bf16_f32 v184, v148, v149
  ds_read_b64 v[18:19], v11 offset:1024
  v_mfma_f32_16x16x32_bf16 v[108:111], v[196:199], v[176:179], v[108:111]
  v_cvt_pk_bf16_f32 v185, v150, v151
  v_mfma_f32_16x16x32_bf16 v[32:35], v[200:203], v[168:171], v[32:35]
  v_cvt_pk_bf16_f32 v188, v152, v153
  v_mfma_f32_16x16x32_bf16 v[72:75], v[200:203], v[172:175], v[72:75]
  v_cvt_pk_bf16_f32 v189, v154, v155
  v_mfma_f32_16x16x32_bf16 v[112:115], v[200:203], v[176:179], v[112:115]
  v_cvt_pk_bf16_f32 v182, v156, v157
  v_mfma_f32_16x16x32_bf16 v[36:39], v[204:207], v[168:171], v[36:39]
  v_cvt_pk_bf16_f32 v183, v158, v159
  v_mfma_f32_16x16x32_bf16 v[76:79], v[204:207], v[172:175], v[76:79]
  v_cvt_pk_bf16_f32 v186, v160, v161
  v_mfma_f32_16x16x32_bf16 v[116:119], v[204:207], v[176:179], v[116:119]
  v_cvt_pk_bf16_f32 v187, v162, v163
  s_waitcnt lgkmcnt(15)
  v_mfma_f32_16x16x32_bf16 v[40:43], v[208:211], v[168:171], v[40:43]
  v_cvt_pk_bf16_f32 v190, v164, v165
  v_mfma_f32_16x16x32_bf16 v[80:83], v[208:211], v[172:175], v[80:83]
  v_cvt_pk_bf16_f32 v191, v166, v167
  v_mfma_f32_16x16x32_bf16 v[120:123], v[208:211], v[176:179], v[120:123]
  s_waitcnt lgkmcnt(0)
  s_barrier
  v_mfma_f32_16x16x32_bf16 v[44:47], v[212:215], v[168:171], v[44:47]
  v_add_u32 v6, 0xe000, v6
  v_add_u32 v7, 0xe000, v7
  v_add_u32 v8, 0xe000, v8
  v_add_u32 v9, 0xe000, v9
  ds_read_b64_tr_b16 v[232:233], v6
  v_mfma_f32_16x16x32_bf16 v[84:87], v[212:215], v[172:175], v[84:87]
  ds_read_b64_tr_b16 v[234:235], v6 offset:2048
  v_mfma_f32_16x16x32_bf16 v[124:127], v[212:215], v[176:179], v[124:127]
  ds_read_b64_tr_b16 v[236:237], v6 offset:4096
  v_mfma_f32_16x16x32_bf16 v[48:51], v[216:219], v[168:171], v[48:51]
  ds_read_b64_tr_b16 v[238:239], v7
  v_mfma_f32_16x16x32_bf16 v[88:91], v[216:219], v[172:175], v[88:91]
  ds_read_b64_tr_b16 v[240:241], v7 offset:2048
  v_mfma_f32_16x16x32_bf16 v[128:131], v[216:219], v[176:179], v[128:131]
  ds_read_b64_tr_b16 v[242:243], v7 offset:4096
  v_mfma_f32_16x16x32_bf16 v[52:55], v[220:223], v[168:171], v[52:55]
  v_add_u32 v2, 0x8000, v2
  v_add_u32 v3, 0x8000, v3
  ds_read_b64_tr_b16 v[192:193], v2
  v_mfma_f32_16x16x32_bf16 v[92:95], v[220:223], v[172:175], v[92:95]
  ds_read_b64_tr_b16 v[194:195], v2 offset:10240
  v_mfma_f32_16x16x32_bf16 v[132:135], v[220:223], v[176:179], v[132:135]
  ds_read_b64_tr_b16 v[196:197], v3
  v_mfma_f32_16x16x32_bf16 v[56:59], v[224:227], v[168:171], v[56:59]
  ds_read_b64_tr_b16 v[198:199], v3 offset:10240
  v_mfma_f32_16x16x32_bf16 v[96:99], v[224:227], v[172:175], v[96:99]
  ds_read_b64_tr_b16 v[200:201], v2 offset:1024
  v_mfma_f32_16x16x32_bf16 v[136:139], v[224:227], v[176:179], v[136:139]
  ds_read_b64_tr_b16 v[202:203], v2 offset:11264
  v_mfma_f32_16x16x32_bf16 v[60:63], v[228:231], v[168:171], v[60:63]
  ds_read_b64_tr_b16 v[204:205], v3 offset:1024
  v_mfma_f32_16x16x32_bf16 v[100:103], v[228:231], v[172:175], v[100:103]
  ds_read_b64_tr_b16 v[206:207], v3 offset:11264
  v_mfma_f32_16x16x32_bf16 v[140:143], v[228:231], v[176:179], v[140:143]
  ds_read_b64_tr_b16 v[208:209], v2 offset:2048
  ds_read_b64_tr_b16 v[210:211], v2 offset:12288
  s_waitcnt lgkmcnt(14)
  v_mfma_f32_16x16x32_bf16 v[144:147], v[232:235], v[244:247], 0
  v_mfma_f32_16x16x32_bf16 v[148:151], v[232:235], v[248:251], 0
  ds_read_b64_tr_b16 v[212:213], v3 offset:2048
  v_mfma_f32_16x16x32_bf16 v[152:155], v[232:235], v[252:255], 0
  ds_read_b64_tr_b16 v[214:215], v3 offset:12288
  s_waitcnt lgkmcnt(13)
  v_mfma_f32_16x16x32_bf16 v[156:159], v[238:241], v[244:247], 0
  ds_read_b64_tr_b16 v[216:217], v2 offset:3072
  v_mfma_f32_16x16x32_bf16 v[160:163], v[238:241], v[248:251], 0
  ds_read_b64_tr_b16 v[218:219], v2 offset:13312
  v_mfma_f32_16x16x32_bf16 v[164:167], v[238:241], v[252:255], 0
  ds_read_b64_tr_b16 v[220:221], v3 offset:3072
  v_mfma_f32_16x16x16_bf16 v[144:147], v[236:237], v[14:15], v[144:147]
  ds_read_b64_tr_b16 v[222:223], v3 offset:13312
  v_mfma_f32_16x16x16_bf16 v[148:151], v[236:237], v[16:17], v[148:151]
  ds_read_b64_tr_b16 v[224:225], v2 offset:4096
  v_mfma_f32_16x16x16_bf16 v[152:155], v[236:237], v[18:19], v[152:155]
  ds_read_b64_tr_b16 v[226:227], v2 offset:14336
  s_waitcnt lgkmcnt(15)
  v_mfma_f32_16x16x16_bf16 v[156:159], v[242:243], v[14:15], v[156:159]
  ds_read_b64_tr_b16 v[228:229], v3 offset:4096
  v_mfma_f32_16x16x16_bf16 v[160:163], v[242:243], v[16:17], v[160:163]
  ds_read_b64_tr_b16 v[230:231], v3 offset:14336
  v_mfma_f32_16x16x16_bf16 v[164:167], v[242:243], v[18:19], v[164:167]
  v_mfma_f32_16x16x32_bf16 v[24:27], v[192:195], v[180:183], v[24:27]
  v_mfma_f32_16x16x32_bf16 v[64:67], v[192:195], v[184:187], v[64:67]
  v_mfma_f32_16x16x32_bf16 v[104:107], v[192:195], v[188:191], v[104:107]
  v_cvt_pk_bf16_f32 v168, v144, v145
  s_waitcnt lgkmcnt(15)
  v_mfma_f32_16x16x32_bf16 v[28:31], v[196:199], v[180:183], v[28:31]
  v_cvt_pk_bf16_f32 v169, v146, v147
  v_mfma_f32_16x16x32_bf16 v[68:71], v[196:199], v[184:187], v[68:71]
  v_cvt_pk_bf16_f32 v172, v148, v149
  v_mfma_f32_16x16x32_bf16 v[108:111], v[196:199], v[188:191], v[108:111]
  v_cvt_pk_bf16_f32 v173, v150, v151
  s_waitcnt lgkmcnt(14)
  v_mfma_f32_16x16x32_bf16 v[32:35], v[200:203], v[180:183], v[32:35]
  v_cvt_pk_bf16_f32 v176, v152, v153
  v_mfma_f32_16x16x32_bf16 v[72:75], v[200:203], v[184:187], v[72:75]
  v_cvt_pk_bf16_f32 v177, v154, v155
  v_mfma_f32_16x16x32_bf16 v[112:115], v[200:203], v[188:191], v[112:115]
  v_cvt_pk_bf16_f32 v170, v156, v157
  s_waitcnt lgkmcnt(12)
  v_mfma_f32_16x16x32_bf16 v[36:39], v[204:207], v[180:183], v[36:39]
  v_cvt_pk_bf16_f32 v171, v158, v159
  v_mfma_f32_16x16x32_bf16 v[76:79], v[204:207], v[184:187], v[76:79]
  v_cvt_pk_bf16_f32 v174, v160, v161
  v_mfma_f32_16x16x32_bf16 v[116:119], v[204:207], v[188:191], v[116:119]
  v_cvt_pk_bf16_f32 v175, v162, v163
  s_waitcnt lgkmcnt(10)
  v_mfma_f32_16x16x32_bf16 v[40:43], v[208:211], v[180:183], v[40:43]
  v_cvt_pk_bf16_f32 v178, v164, v165
  v_mfma_f32_16x16x32_bf16 v[80:83], v[208:211], v[184:187], v[80:83]
  v_cvt_pk_bf16_f32 v179, v166, v167
  v_mfma_f32_16x16x32_bf16 v[120:123], v[208:211], v[188:191], v[120:123]
  s_waitcnt lgkmcnt(0)
  s_barrier
  v_mfma_f32_16x16x32_bf16 v[44:47], v[212:215], v[180:183], v[44:47]
  ds_read_b64_tr_b16 v[232:233], v8
  v_mfma_f32_16x16x32_bf16 v[84:87], v[212:215], v[184:187], v[84:87]
  ds_read_b64_tr_b16 v[234:235], v8 offset:2048
  v_mfma_f32_16x16x32_bf16 v[124:127], v[212:215], v[188:191], v[124:127]
  ds_read_b64_tr_b16 v[236:237], v8 offset:4096
  v_mfma_f32_16x16x32_bf16 v[48:51], v[216:219], v[180:183], v[48:51]
  ds_read_b64_tr_b16 v[238:239], v9
  v_mfma_f32_16x16x32_bf16 v[88:91], v[216:219], v[184:187], v[88:91]
  ds_read_b64_tr_b16 v[240:241], v9 offset:2048
  v_mfma_f32_16x16x32_bf16 v[128:131], v[216:219], v[188:191], v[128:131]
  ds_read_b64_tr_b16 v[242:243], v9 offset:4096
  v_mfma_f32_16x16x32_bf16 v[52:55], v[220:223], v[180:183], v[52:55]
  v_add_u32 v2, 0x5000, v2
  v_add_u32 v3, 0x5000, v3
  ds_read_b64_tr_b16 v[192:193], v2
  v_mfma_f32_16x16x32_bf16 v[92:95], v[220:223], v[184:187], v[92:95]
  ds_read_b64_tr_b16 v[194:195], v2 offset:10240
  v_mfma_f32_16x16x32_bf16 v[132:135], v[220:223], v[188:191], v[132:135]
  ds_read_b64_tr_b16 v[196:197], v3
  v_mfma_f32_16x16x32_bf16 v[56:59], v[224:227], v[180:183], v[56:59]
  ds_read_b64_tr_b16 v[198:199], v3 offset:10240
  v_mfma_f32_16x16x32_bf16 v[96:99], v[224:227], v[184:187], v[96:99]
  ds_read_b64_tr_b16 v[200:201], v2 offset:1024
  v_mfma_f32_16x16x32_bf16 v[136:139], v[224:227], v[188:191], v[136:139]
  ds_read_b64_tr_b16 v[202:203], v2 offset:11264
  v_mfma_f32_16x16x32_bf16 v[60:63], v[228:231], v[180:183], v[60:63]
  ds_read_b64_tr_b16 v[204:205], v3 offset:1024
  v_mfma_f32_16x16x32_bf16 v[100:103], v[228:231], v[184:187], v[100:103]
  ds_read_b64_tr_b16 v[206:207], v3 offset:11264
  v_mfma_f32_16x16x32_bf16 v[140:143], v[228:231], v[188:191], v[140:143]
  ds_read_b64_tr_b16 v[208:209], v2 offset:2048
  ds_read_b64_tr_b16 v[210:211], v2 offset:12288
  s_waitcnt lgkmcnt(14)
  v_mfma_f32_16x16x32_bf16 v[144:147], v[232:235], v[244:247], 0
  v_mfma_f32_16x16x32_bf16 v[148:151], v[232:235], v[248:251], 0
  ds_read_b64_tr_b16 v[212:213], v3 offset:2048
  v_mfma_f32_16x16x32_bf16 v[152:155], v[232:235], v[252:255], 0
  ds_read_b64_tr_b16 v[214:215], v3 offset:12288
  s_waitcnt lgkmcnt(13)
  v_mfma_f32_16x16x32_bf16 v[156:159], v[238:241], v[244:247], 0
  ds_read_b64_tr_b16 v[216:217], v2 offset:3072
  v_mfma_f32_16x16x32_bf16 v[160:163], v[238:241], v[248:251], 0
  ds_read_b64_tr_b16 v[218:219], v2 offset:13312
  v_mfma_f32_16x16x32_bf16 v[164:167], v[238:241], v[252:255], 0
  ds_read_b64_tr_b16 v[220:221], v3 offset:3072
  v_mfma_f32_16x16x16_bf16 v[144:147], v[236:237], v[14:15], v[144:147]
  ds_read_b64_tr_b16 v[222:223], v3 offset:13312
  v_mfma_f32_16x16x16_bf16 v[148:151], v[236:237], v[16:17], v[148:151]
  ds_read_b64_tr_b16 v[224:225], v2 offset:4096
  v_mfma_f32_16x16x16_bf16 v[152:155], v[236:237], v[18:19], v[152:155]
  ds_read_b64_tr_b16 v[226:227], v2 offset:14336
  s_waitcnt lgkmcnt(15)
  v_mfma_f32_16x16x16_bf16 v[156:159], v[242:243], v[14:15], v[156:159]
  ds_read_b64_tr_b16 v[228:229], v3 offset:4096
  v_mfma_f32_16x16x16_bf16 v[160:163], v[242:243], v[16:17], v[160:163]
  ds_read_b64_tr_b16 v[230:231], v3 offset:14336
  v_mfma_f32_16x16x16_bf16 v[164:167], v[242:243], v[18:19], v[164:167]
  v_mfma_f32_16x16x32_bf16 v[24:27], v[192:195], v[168:171], v[24:27]
  v_mfma_f32_16x16x32_bf16 v[64:67], v[192:195], v[172:175], v[64:67]
  v_mfma_f32_16x16x32_bf16 v[104:107], v[192:195], v[176:179], v[104:107]
  v_cvt_pk_bf16_f32 v180, v144, v145
  s_waitcnt lgkmcnt(15)
  v_mfma_f32_16x16x32_bf16 v[28:31], v[196:199], v[168:171], v[28:31]
  v_cvt_pk_bf16_f32 v181, v146, v147
  v_mfma_f32_16x16x32_bf16 v[68:71], v[196:199], v[172:175], v[68:71]
  v_cvt_pk_bf16_f32 v184, v148, v149
  v_mfma_f32_16x16x32_bf16 v[108:111], v[196:199], v[176:179], v[108:111]
  v_cvt_pk_bf16_f32 v185, v150, v151
  s_waitcnt lgkmcnt(14)
  v_mfma_f32_16x16x32_bf16 v[32:35], v[200:203], v[168:171], v[32:35]
  v_cvt_pk_bf16_f32 v188, v152, v153
  v_mfma_f32_16x16x32_bf16 v[72:75], v[200:203], v[172:175], v[72:75]
  v_cvt_pk_bf16_f32 v189, v154, v155
  v_mfma_f32_16x16x32_bf16 v[112:115], v[200:203], v[176:179], v[112:115]
  v_cvt_pk_bf16_f32 v182, v156, v157
  s_waitcnt lgkmcnt(12)
  v_mfma_f32_16x16x32_bf16 v[36:39], v[204:207], v[168:171], v[36:39]
  v_cvt_pk_bf16_f32 v183, v158, v159
  v_mfma_f32_16x16x32_bf16 v[76:79], v[204:207], v[172:175], v[76:79]
  v_cvt_pk_bf16_f32 v186, v160, v161
  v_mfma_f32_16x16x32_bf16 v[116:119], v[204:207], v[176:179], v[116:119]
  v_cvt_pk_bf16_f32 v187, v162, v163
  s_waitcnt lgkmcnt(10)
  v_mfma_f32_16x16x32_bf16 v[40:43], v[208:211], v[168:171], v[40:43]
  v_cvt_pk_bf16_f32 v190, v164, v165
  v_mfma_f32_16x16x32_bf16 v[80:83], v[208:211], v[172:175], v[80:83]
  v_cvt_pk_bf16_f32 v191, v166, v167
  v_mfma_f32_16x16x32_bf16 v[120:123], v[208:211], v[176:179], v[120:123]
  s_waitcnt lgkmcnt(0)
  s_barrier
  v_mfma_f32_16x16x32_bf16 v[44:47], v[212:215], v[168:171], v[44:47]
  v_add_u32 v6, 0xfffe0000, v6
  v_add_u32 v7, 0xfffe0000, v7
  v_add_u32 v8, 0xfffe0000, v8
  v_add_u32 v9, 0xfffe0000, v9
  ds_read_b64_tr_b16 v[232:233], v6
  v_mfma_f32_16x16x32_bf16 v[84:87], v[212:215], v[172:175], v[84:87]
  ds_read_b64_tr_b16 v[234:235], v6 offset:2048
  v_mfma_f32_16x16x32_bf16 v[124:127], v[212:215], v[176:179], v[124:127]
  ds_read_b64_tr_b16 v[236:237], v6 offset:4096
  v_mfma_f32_16x16x32_bf16 v[48:51], v[216:219], v[168:171], v[48:51]
  ds_read_b64_tr_b16 v[238:239], v7
  v_mfma_f32_16x16x32_bf16 v[88:91], v[216:219], v[172:175], v[88:91]
  ds_read_b64_tr_b16 v[240:241], v7 offset:2048
  v_mfma_f32_16x16x32_bf16 v[128:131], v[216:219], v[176:179], v[128:131]
  ds_read_b64_tr_b16 v[242:243], v7 offset:4096
  v_mfma_f32_16x16x32_bf16 v[52:55], v[220:223], v[168:171], v[52:55]
  v_add_u32 v2, 0x5000, v2
  v_add_u32 v3, 0x5000, v3
  ds_read_b64_tr_b16 v[192:193], v2
  v_mfma_f32_16x16x32_bf16 v[92:95], v[220:223], v[172:175], v[92:95]
  ds_read_b64_tr_b16 v[194:195], v2 offset:10240
  v_mfma_f32_16x16x32_bf16 v[132:135], v[220:223], v[176:179], v[132:135]
  ds_read_b64_tr_b16 v[196:197], v3
  v_mfma_f32_16x16x32_bf16 v[56:59], v[224:227], v[168:171], v[56:59]
  ds_read_b64_tr_b16 v[198:199], v3 offset:10240
  v_mfma_f32_16x16x32_bf16 v[96:99], v[224:227], v[172:175], v[96:99]
  ds_read_b64_tr_b16 v[200:201], v2 offset:1024
  v_mfma_f32_16x16x32_bf16 v[136:139], v[224:227], v[176:179], v[136:139]
  ds_read_b64_tr_b16 v[202:203], v2 offset:11264
  v_mfma_f32_16x16x32_bf16 v[60:63], v[228:231], v[168:171], v[60:63]
  ds_read_b64_tr_b16 v[204:205], v3 offset:1024
  v_mfma_f32_16x16x32_bf16 v[100:103], v[228:231], v[172:175], v[100:103]
  ds_read_b64_tr_b16 v[206:207], v3 offset:11264
  v_mfma_f32_16x16x32_bf16 v[140:143], v[228:231], v[176:179], v[140:143]
  ds_read_b64_tr_b16 v[208:209], v2 offset:2048
  ds_read_b64_tr_b16 v[210:211], v2 offset:12288
  s_waitcnt lgkmcnt(14)
  v_mfma_f32_16x16x32_bf16 v[144:147], v[232:235], v[244:247], 0
  v_mfma_f32_16x16x32_bf16 v[148:151], v[232:235], v[248:251], 0
  ds_read_b64_tr_b16 v[212:213], v3 offset:2048
  v_mfma_f32_16x16x32_bf16 v[152:155], v[232:235], v[252:255], 0
  ds_read_b64_tr_b16 v[214:215], v3 offset:12288
  s_waitcnt lgkmcnt(13)
  v_mfma_f32_16x16x32_bf16 v[156:159], v[238:241], v[244:247], 0
  ds_read_b64_tr_b16 v[216:217], v2 offset:3072
  v_mfma_f32_16x16x32_bf16 v[160:163], v[238:241], v[248:251], 0
  ds_read_b64_tr_b16 v[218:219], v2 offset:13312
  v_mfma_f32_16x16x32_bf16 v[164:167], v[238:241], v[252:255], 0
  ds_read_b64_tr_b16 v[220:221], v3 offset:3072
  v_mfma_f32_16x16x16_bf16 v[144:147], v[236:237], v[14:15], v[144:147]
  ds_read_b64_tr_b16 v[222:223], v3 offset:13312
  v_mfma_f32_16x16x16_bf16 v[148:151], v[236:237], v[16:17], v[148:151]
  ds_read_b64_tr_b16 v[224:225], v2 offset:4096
  v_mfma_f32_16x16x16_bf16 v[152:155], v[236:237], v[18:19], v[152:155]
  ds_read_b64_tr_b16 v[226:227], v2 offset:14336
  s_waitcnt lgkmcnt(15)
  v_mfma_f32_16x16x16_bf16 v[156:159], v[242:243], v[14:15], v[156:159]
  ds_read_b64_tr_b16 v[228:229], v3 offset:4096
  v_mfma_f32_16x16x16_bf16 v[160:163], v[242:243], v[16:17], v[160:163]
  ds_read_b64_tr_b16 v[230:231], v3 offset:14336
  v_mfma_f32_16x16x16_bf16 v[164:167], v[242:243], v[18:19], v[164:167]
  v_mfma_f32_16x16x32_bf16 v[24:27], v[192:195], v[180:183], v[24:27]
  v_mfma_f32_16x16x32_bf16 v[64:67], v[192:195], v[184:187], v[64:67]
  v_mfma_f32_16x16x32_bf16 v[104:107], v[192:195], v[188:191], v[104:107]
  v_cvt_pk_bf16_f32 v168, v144, v145
  s_waitcnt lgkmcnt(15)
  v_mfma_f32_16x16x32_bf16 v[28:31], v[196:199], v[180:183], v[28:31]
  v_cvt_pk_bf16_f32 v169, v146, v147
  v_mfma_f32_16x16x32_bf16 v[68:71], v[196:199], v[184:187], v[68:71]
  v_cvt_pk_bf16_f32 v172, v148, v149
  v_mfma_f32_16x16x32_bf16 v[108:111], v[196:199], v[188:191], v[108:111]
  v_cvt_pk_bf16_f32 v173, v150, v151
  s_waitcnt lgkmcnt(14)
  v_mfma_f32_16x16x32_bf16 v[32:35], v[200:203], v[180:183], v[32:35]
  v_cvt_pk_bf16_f32 v176, v152, v153
  v_mfma_f32_16x16x32_bf16 v[72:75], v[200:203], v[184:187], v[72:75]
  v_cvt_pk_bf16_f32 v177, v154, v155
  v_mfma_f32_16x16x32_bf16 v[112:115], v[200:203], v[188:191], v[112:115]
  v_cvt_pk_bf16_f32 v170, v156, v157
  s_waitcnt lgkmcnt(12)
  v_mfma_f32_16x16x32_bf16 v[36:39], v[204:207], v[180:183], v[36:39]
  v_cvt_pk_bf16_f32 v171, v158, v159
  v_mfma_f32_16x16x32_bf16 v[76:79], v[204:207], v[184:187], v[76:79]
  v_cvt_pk_bf16_f32 v174, v160, v161
  v_mfma_f32_16x16x32_bf16 v[116:119], v[204:207], v[188:191], v[116:119]
  v_cvt_pk_bf16_f32 v175, v162, v163
  s_waitcnt lgkmcnt(10)
  v_mfma_f32_16x16x32_bf16 v[40:43], v[208:211], v[180:183], v[40:43]
  v_cvt_pk_bf16_f32 v178, v164, v165
  v_mfma_f32_16x16x32_bf16 v[80:83], v[208:211], v[184:187], v[80:83]
  v_cvt_pk_bf16_f32 v179, v166, v167
  v_mfma_f32_16x16x32_bf16 v[120:123], v[208:211], v[188:191], v[120:123]
  s_waitcnt lgkmcnt(0)
  s_barrier
  v_mfma_f32_16x16x32_bf16 v[44:47], v[212:215], v[180:183], v[44:47]
  ds_read_b64_tr_b16 v[232:233], v8
  v_mfma_f32_16x16x32_bf16 v[84:87], v[212:215], v[184:187], v[84:87]
  ds_read_b64_tr_b16 v[234:235], v8 offset:2048
  v_mfma_f32_16x16x32_bf16 v[124:127], v[212:215], v[188:191], v[124:127]
  ds_read_b64_tr_b16 v[236:237], v8 offset:4096
  v_mfma_f32_16x16x32_bf16 v[48:51], v[216:219], v[180:183], v[48:51]
  ds_read_b64_tr_b16 v[238:239], v9
  v_mfma_f32_16x16x32_bf16 v[88:91], v[216:219], v[184:187], v[88:91]
  ds_read_b64_tr_b16 v[240:241], v9 offset:2048
  v_mfma_f32_16x16x32_bf16 v[128:131], v[216:219], v[188:191], v[128:131]
  ds_read_b64_tr_b16 v[242:243], v9 offset:4096
  v_mfma_f32_16x16x32_bf16 v[52:55], v[220:223], v[180:183], v[52:55]
  v_add_u32 v2, 0xc000, v2
  v_add_u32 v3, 0xc000, v3
  ds_read_b64_tr_b16 v[192:193], v2
  v_mfma_f32_16x16x32_bf16 v[92:95], v[220:223], v[184:187], v[92:95]
  ds_read_b64_tr_b16 v[194:195], v2 offset:10240
  v_mfma_f32_16x16x32_bf16 v[132:135], v[220:223], v[188:191], v[132:135]
  ds_read_b64_tr_b16 v[196:197], v3
  v_mfma_f32_16x16x32_bf16 v[56:59], v[224:227], v[180:183], v[56:59]
  ds_read_b64_tr_b16 v[198:199], v3 offset:10240
  v_mfma_f32_16x16x32_bf16 v[96:99], v[224:227], v[184:187], v[96:99]
  ds_read_b64_tr_b16 v[200:201], v2 offset:1024
  v_mfma_f32_16x16x32_bf16 v[136:139], v[224:227], v[188:191], v[136:139]
  ds_read_b64_tr_b16 v[202:203], v2 offset:11264
  v_mfma_f32_16x16x32_bf16 v[60:63], v[228:231], v[180:183], v[60:63]
  ds_read_b64_tr_b16 v[204:205], v3 offset:1024
  v_mfma_f32_16x16x32_bf16 v[100:103], v[228:231], v[184:187], v[100:103]
  ds_read_b64_tr_b16 v[206:207], v3 offset:11264
  v_mfma_f32_16x16x32_bf16 v[140:143], v[228:231], v[188:191], v[140:143]
  ds_read_b64_tr_b16 v[208:209], v2 offset:2048
  ds_read_b64_tr_b16 v[210:211], v2 offset:12288
  s_waitcnt lgkmcnt(14)
  v_mfma_f32_16x16x32_bf16 v[144:147], v[232:235], v[244:247], 0
  v_mfma_f32_16x16x32_bf16 v[148:151], v[232:235], v[248:251], 0
  ds_read_b64_tr_b16 v[212:213], v3 offset:2048
  v_mfma_f32_16x16x32_bf16 v[152:155], v[232:235], v[252:255], 0
  ds_read_b64_tr_b16 v[214:215], v3 offset:12288
  s_waitcnt lgkmcnt(13)
  v_mfma_f32_16x16x32_bf16 v[156:159], v[238:241], v[244:247], 0
  ds_read_b64_tr_b16 v[216:217], v2 offset:3072
  v_mfma_f32_16x16x32_bf16 v[160:163], v[238:241], v[248:251], 0
  ds_read_b64_tr_b16 v[218:219], v2 offset:13312
  v_mfma_f32_16x16x32_bf16 v[164:167], v[238:241], v[252:255], 0
  ds_read_b64_tr_b16 v[220:221], v3 offset:3072
  v_mfma_f32_16x16x16_bf16 v[144:147], v[236:237], v[14:15], v[144:147]
  ds_read_b64_tr_b16 v[222:223], v3 offset:13312
  v_mfma_f32_16x16x16_bf16 v[148:151], v[236:237], v[16:17], v[148:151]
  ds_read_b64_tr_b16 v[224:225], v2 offset:4096
  v_mfma_f32_16x16x16_bf16 v[152:155], v[236:237], v[18:19], v[152:155]
  ds_read_b64_tr_b16 v[226:227], v2 offset:14336
  s_waitcnt lgkmcnt(15)
  v_mfma_f32_16x16x16_bf16 v[156:159], v[242:243], v[14:15], v[156:159]
  ds_read_b64_tr_b16 v[228:229], v3 offset:4096
  v_mfma_f32_16x16x16_bf16 v[160:163], v[242:243], v[16:17], v[160:163]
  ds_read_b64_tr_b16 v[230:231], v3 offset:14336
  v_mfma_f32_16x16x16_bf16 v[164:167], v[242:243], v[18:19], v[164:167]
  v_mfma_f32_16x16x32_bf16 v[24:27], v[192:195], v[168:171], v[24:27]
  v_mfma_f32_16x16x32_bf16 v[64:67], v[192:195], v[172:175], v[64:67]
  v_mfma_f32_16x16x32_bf16 v[104:107], v[192:195], v[176:179], v[104:107]
  v_cvt_pk_bf16_f32 v180, v144, v145
  s_waitcnt lgkmcnt(15)
  v_mfma_f32_16x16x32_bf16 v[28:31], v[196:199], v[168:171], v[28:31]
  v_cvt_pk_bf16_f32 v181, v146, v147
  v_mfma_f32_16x16x32_bf16 v[68:71], v[196:199], v[172:175], v[68:71]
  v_cvt_pk_bf16_f32 v184, v148, v149
  v_mfma_f32_16x16x32_bf16 v[108:111], v[196:199], v[176:179], v[108:111]
  v_cvt_pk_bf16_f32 v185, v150, v151
  s_waitcnt lgkmcnt(14)
  v_mfma_f32_16x16x32_bf16 v[32:35], v[200:203], v[168:171], v[32:35]
  v_cvt_pk_bf16_f32 v188, v152, v153
  v_mfma_f32_16x16x32_bf16 v[72:75], v[200:203], v[172:175], v[72:75]
  v_cvt_pk_bf16_f32 v189, v154, v155
  v_mfma_f32_16x16x32_bf16 v[112:115], v[200:203], v[176:179], v[112:115]
  v_cvt_pk_bf16_f32 v182, v156, v157
  s_waitcnt lgkmcnt(12)
  v_mfma_f32_16x16x32_bf16 v[36:39], v[204:207], v[168:171], v[36:39]
  v_cvt_pk_bf16_f32 v183, v158, v159
  v_mfma_f32_16x16x32_bf16 v[76:79], v[204:207], v[172:175], v[76:79]
  v_cvt_pk_bf16_f32 v186, v160, v161
  v_mfma_f32_16x16x32_bf16 v[116:119], v[204:207], v[176:179], v[116:119]
  v_cvt_pk_bf16_f32 v187, v162, v163
  s_waitcnt lgkmcnt(10)
  v_mfma_f32_16x16x32_bf16 v[40:43], v[208:211], v[168:171], v[40:43]
  v_cvt_pk_bf16_f32 v190, v164, v165
  v_mfma_f32_16x16x32_bf16 v[80:83], v[208:211], v[172:175], v[80:83]
  v_cvt_pk_bf16_f32 v191, v166, v167
  v_mfma_f32_16x16x32_bf16 v[120:123], v[208:211], v[176:179], v[120:123]
  s_waitcnt lgkmcnt(0)
  s_barrier
  v_mfma_f32_16x16x32_bf16 v[44:47], v[212:215], v[168:171], v[44:47]
  v_add_u32 v6, 0x12000, v6
  v_add_u32 v7, 0x12000, v7
  v_add_u32 v8, 0x12000, v8
  v_add_u32 v9, 0x12000, v9
  ds_read_b64_tr_b16 v[232:233], v6
  v_mfma_f32_16x16x32_bf16 v[84:87], v[212:215], v[172:175], v[84:87]
  ds_read_b64_tr_b16 v[234:235], v6 offset:2048
  v_mfma_f32_16x16x32_bf16 v[124:127], v[212:215], v[176:179], v[124:127]
  ds_read_b64_tr_b16 v[236:237], v6 offset:4096
  v_mfma_f32_16x16x32_bf16 v[48:51], v[216:219], v[168:171], v[48:51]
  ds_read_b64_tr_b16 v[238:239], v7
  v_mfma_f32_16x16x32_bf16 v[88:91], v[216:219], v[172:175], v[88:91]
  ds_read_b64_tr_b16 v[240:241], v7 offset:2048
  v_mfma_f32_16x16x32_bf16 v[128:131], v[216:219], v[176:179], v[128:131]
  ds_read_b64_tr_b16 v[242:243], v7 offset:4096
  v_mfma_f32_16x16x32_bf16 v[52:55], v[220:223], v[168:171], v[52:55]
  v_add_u32 v2, 0xfffe2000, v2
  v_add_u32 v3, 0xfffe2000, v3
  ds_read_b64_tr_b16 v[192:193], v2
  v_mfma_f32_16x16x32_bf16 v[92:95], v[220:223], v[172:175], v[92:95]
  ds_read_b64_tr_b16 v[194:195], v2 offset:10240
  v_mfma_f32_16x16x32_bf16 v[132:135], v[220:223], v[176:179], v[132:135]
  ds_read_b64_tr_b16 v[196:197], v3
  v_mfma_f32_16x16x32_bf16 v[56:59], v[224:227], v[168:171], v[56:59]
  ds_read_b64_tr_b16 v[198:199], v3 offset:10240
  v_mfma_f32_16x16x32_bf16 v[96:99], v[224:227], v[172:175], v[96:99]
  ds_read_b64_tr_b16 v[200:201], v2 offset:1024
  v_mfma_f32_16x16x32_bf16 v[136:139], v[224:227], v[176:179], v[136:139]
  ds_read_b64_tr_b16 v[202:203], v2 offset:11264
  v_mfma_f32_16x16x32_bf16 v[60:63], v[228:231], v[168:171], v[60:63]
  ds_read_b64_tr_b16 v[204:205], v3 offset:1024
  v_mfma_f32_16x16x32_bf16 v[100:103], v[228:231], v[172:175], v[100:103]
  ds_read_b64_tr_b16 v[206:207], v3 offset:11264
  v_mfma_f32_16x16x32_bf16 v[140:143], v[228:231], v[176:179], v[140:143]
  ds_read_b64_tr_b16 v[208:209], v2 offset:2048
  ds_read_b64_tr_b16 v[210:211], v2 offset:12288
  s_waitcnt lgkmcnt(14)
  v_mfma_f32_16x16x32_bf16 v[144:147], v[232:235], v[244:247], 0
  v_mfma_f32_16x16x32_bf16 v[148:151], v[232:235], v[248:251], 0
  ds_read_b64_tr_b16 v[212:213], v3 offset:2048
  v_mfma_f32_16x16x32_bf16 v[152:155], v[232:235], v[252:255], 0
  ds_read_b64_tr_b16 v[214:215], v3 offset:12288
  s_waitcnt lgkmcnt(13)
  v_mfma_f32_16x16x32_bf16 v[156:159], v[238:241], v[244:247], 0
  ds_read_b64_tr_b16 v[216:217], v2 offset:3072
  v_mfma_f32_16x16x32_bf16 v[160:163], v[238:241], v[248:251], 0
  ds_read_b64_tr_b16 v[218:219], v2 offset:13312
  v_mfma_f32_16x16x32_bf16 v[164:167], v[238:241], v[252:255], 0
  ds_read_b64_tr_b16 v[220:221], v3 offset:3072
  v_mfma_f32_16x16x16_bf16 v[144:147], v[236:237], v[14:15], v[144:147]
  ds_read_b64_tr_b16 v[222:223], v3 offset:13312
  v_mfma_f32_16x16x16_bf16 v[148:151], v[236:237], v[16:17], v[148:151]
  ds_read_b64_tr_b16 v[224:225], v2 offset:4096
  v_mfma_f32_16x16x16_bf16 v[152:155], v[236:237], v[18:19], v[152:155]
  ds_read_b64_tr_b16 v[226:227], v2 offset:14336
  s_waitcnt lgkmcnt(15)
  v_mfma_f32_16x16x16_bf16 v[156:159], v[242:243], v[14:15], v[156:159]
  ds_read_b64_tr_b16 v[228:229], v3 offset:4096
  v_mfma_f32_16x16x16_bf16 v[160:163], v[242:243], v[16:17], v[160:163]
  ds_read_b64_tr_b16 v[230:231], v3 offset:14336
  v_mfma_f32_16x16x16_bf16 v[164:167], v[242:243], v[18:19], v[164:167]
  v_mfma_f32_16x16x32_bf16 v[24:27], v[192:195], v[180:183], v[24:27]
  v_mfma_f32_16x16x32_bf16 v[64:67], v[192:195], v[184:187], v[64:67]
  v_mfma_f32_16x16x32_bf16 v[104:107], v[192:195], v[188:191], v[104:107]
  v_cvt_pk_bf16_f32 v168, v144, v145
  s_waitcnt lgkmcnt(15)
  v_mfma_f32_16x16x32_bf16 v[28:31], v[196:199], v[180:183], v[28:31]
  v_cvt_pk_bf16_f32 v169, v146, v147
  v_mfma_f32_16x16x32_bf16 v[68:71], v[196:199], v[184:187], v[68:71]
  v_cvt_pk_bf16_f32 v172, v148, v149
  v_mfma_f32_16x16x32_bf16 v[108:111], v[196:199], v[188:191], v[108:111]
  v_cvt_pk_bf16_f32 v173, v150, v151
  s_waitcnt lgkmcnt(14)
  v_mfma_f32_16x16x32_bf16 v[32:35], v[200:203], v[180:183], v[32:35]
  v_cvt_pk_bf16_f32 v176, v152, v153
  v_mfma_f32_16x16x32_bf16 v[72:75], v[200:203], v[184:187], v[72:75]
  v_cvt_pk_bf16_f32 v177, v154, v155
  v_mfma_f32_16x16x32_bf16 v[112:115], v[200:203], v[188:191], v[112:115]
  v_cvt_pk_bf16_f32 v170, v156, v157
  s_waitcnt lgkmcnt(12)
  v_mfma_f32_16x16x32_bf16 v[36:39], v[204:207], v[180:183], v[36:39]
  v_cvt_pk_bf16_f32 v171, v158, v159
  v_mfma_f32_16x16x32_bf16 v[76:79], v[204:207], v[184:187], v[76:79]
  v_cvt_pk_bf16_f32 v174, v160, v161
  v_mfma_f32_16x16x32_bf16 v[116:119], v[204:207], v[188:191], v[116:119]
  v_cvt_pk_bf16_f32 v175, v162, v163
  s_waitcnt lgkmcnt(10)
  v_mfma_f32_16x16x32_bf16 v[40:43], v[208:211], v[180:183], v[40:43]
  v_cvt_pk_bf16_f32 v178, v164, v165
  v_mfma_f32_16x16x32_bf16 v[80:83], v[208:211], v[184:187], v[80:83]
  v_cvt_pk_bf16_f32 v179, v166, v167
  v_mfma_f32_16x16x32_bf16 v[120:123], v[208:211], v[188:191], v[120:123]
  s_waitcnt lgkmcnt(0)
  s_barrier
  v_mfma_f32_16x16x32_bf16 v[44:47], v[212:215], v[180:183], v[44:47]
  ds_read_b64_tr_b16 v[232:233], v8
  v_mfma_f32_16x16x32_bf16 v[84:87], v[212:215], v[184:187], v[84:87]
  ds_read_b64_tr_b16 v[234:235], v8 offset:2048
  v_mfma_f32_16x16x32_bf16 v[124:127], v[212:215], v[188:191], v[124:127]
  ds_read_b64_tr_b16 v[236:237], v8 offset:4096
  v_mfma_f32_16x16x32_bf16 v[48:51], v[216:219], v[180:183], v[48:51]
  ds_read_b64_tr_b16 v[238:239], v9
  v_mfma_f32_16x16x32_bf16 v[88:91], v[216:219], v[184:187], v[88:91]
  ds_read_b64_tr_b16 v[240:241], v9 offset:2048
  v_mfma_f32_16x16x32_bf16 v[128:131], v[216:219], v[188:191], v[128:131]
  ds_read_b64_tr_b16 v[242:243], v9 offset:4096
  v_mfma_f32_16x16x32_bf16 v[52:55], v[220:223], v[180:183], v[52:55]
  v_add_u32 v2, 0x8000, v2
  v_add_u32 v3, 0x8000, v3
  ds_read_b64_tr_b16 v[192:193], v2
  v_mfma_f32_16x16x32_bf16 v[92:95], v[220:223], v[184:187], v[92:95]
  ds_read_b64_tr_b16 v[194:195], v2 offset:10240
  v_mfma_f32_16x16x32_bf16 v[132:135], v[220:223], v[188:191], v[132:135]
  ds_read_b64_tr_b16 v[196:197], v3
  v_mfma_f32_16x16x32_bf16 v[56:59], v[224:227], v[180:183], v[56:59]
  ds_read_b64_tr_b16 v[198:199], v3 offset:10240
  v_mfma_f32_16x16x32_bf16 v[96:99], v[224:227], v[184:187], v[96:99]
  ds_read_b64_tr_b16 v[200:201], v2 offset:1024
  v_mfma_f32_16x16x32_bf16 v[136:139], v[224:227], v[188:191], v[136:139]
  ds_read_b64_tr_b16 v[202:203], v2 offset:11264
  v_mfma_f32_16x16x32_bf16 v[60:63], v[228:231], v[180:183], v[60:63]
  ds_read_b64_tr_b16 v[204:205], v3 offset:1024
  v_mfma_f32_16x16x32_bf16 v[100:103], v[228:231], v[184:187], v[100:103]
  ds_read_b64_tr_b16 v[206:207], v3 offset:11264
  v_mfma_f32_16x16x32_bf16 v[140:143], v[228:231], v[188:191], v[140:143]
  ds_read_b64_tr_b16 v[208:209], v2 offset:2048
  ds_read_b64_tr_b16 v[210:211], v2 offset:12288
  s_waitcnt lgkmcnt(14)
  v_mfma_f32_16x16x32_bf16 v[144:147], v[232:235], v[244:247], 0
  v_mfma_f32_16x16x32_bf16 v[148:151], v[232:235], v[248:251], 0
  v_add_u32 v2, 0x5000, v2
  v_add_u32 v3, 0x5000, v3
  ds_read_b64_tr_b16 v[212:213], v2
  v_mfma_f32_16x16x32_bf16 v[152:155], v[232:235], v[252:255], 0
  ds_read_b64_tr_b16 v[214:215], v2 offset:10240
  s_waitcnt lgkmcnt(13)
  v_mfma_f32_16x16x32_bf16 v[156:159], v[238:241], v[244:247], 0
  ds_read_b64_tr_b16 v[216:217], v3
  v_mfma_f32_16x16x32_bf16 v[160:163], v[238:241], v[248:251], 0
  ds_read_b64_tr_b16 v[218:219], v3 offset:10240
  v_mfma_f32_16x16x32_bf16 v[164:167], v[238:241], v[252:255], 0
  ds_read_b64_tr_b16 v[220:221], v2 offset:1024
  v_mfma_f32_16x16x16_bf16 v[144:147], v[236:237], v[14:15], v[144:147]
  ds_read_b64_tr_b16 v[222:223], v2 offset:11264
  v_mfma_f32_16x16x16_bf16 v[148:151], v[236:237], v[16:17], v[148:151]
  ds_read_b64_tr_b16 v[224:225], v3 offset:1024
  v_mfma_f32_16x16x16_bf16 v[152:155], v[236:237], v[18:19], v[152:155]
  ds_read_b64_tr_b16 v[226:227], v3 offset:11264
  s_waitcnt lgkmcnt(15)
  v_mfma_f32_16x16x16_bf16 v[156:159], v[242:243], v[14:15], v[156:159]
  ds_read_b64_tr_b16 v[228:229], v2 offset:2048
  v_mfma_f32_16x16x16_bf16 v[160:163], v[242:243], v[16:17], v[160:163]
  ds_read_b64_tr_b16 v[230:231], v2 offset:12288
  v_mfma_f32_16x16x16_bf16 v[164:167], v[242:243], v[18:19], v[164:167]
  v_mfma_f32_16x16x32_bf16 v[24:27], v[192:195], v[168:171], v[24:27]
  v_mfma_f32_16x16x32_bf16 v[64:67], v[192:195], v[172:175], v[64:67]
  v_mfma_f32_16x16x32_bf16 v[104:107], v[192:195], v[176:179], v[104:107]
  v_cvt_pk_bf16_f32 v180, v144, v145
  s_waitcnt lgkmcnt(15)
  v_mfma_f32_16x16x32_bf16 v[28:31], v[196:199], v[168:171], v[28:31]
  v_cvt_pk_bf16_f32 v181, v146, v147
  v_mfma_f32_16x16x32_bf16 v[68:71], v[196:199], v[172:175], v[68:71]
  v_cvt_pk_bf16_f32 v184, v148, v149
  v_mfma_f32_16x16x32_bf16 v[108:111], v[196:199], v[176:179], v[108:111]
  v_cvt_pk_bf16_f32 v185, v150, v151
  s_waitcnt lgkmcnt(14)
  v_mfma_f32_16x16x32_bf16 v[32:35], v[200:203], v[168:171], v[32:35]
  v_cvt_pk_bf16_f32 v188, v152, v153
  v_mfma_f32_16x16x32_bf16 v[72:75], v[200:203], v[172:175], v[72:75]
  v_cvt_pk_bf16_f32 v189, v154, v155
  v_mfma_f32_16x16x32_bf16 v[112:115], v[200:203], v[176:179], v[112:115]
  v_cvt_pk_bf16_f32 v182, v156, v157
  s_waitcnt lgkmcnt(12)
  v_mfma_f32_16x16x32_bf16 v[36:39], v[204:207], v[168:171], v[36:39]
  v_cvt_pk_bf16_f32 v183, v158, v159
  v_mfma_f32_16x16x32_bf16 v[76:79], v[204:207], v[172:175], v[76:79]
  v_cvt_pk_bf16_f32 v186, v160, v161
  v_mfma_f32_16x16x32_bf16 v[116:119], v[204:207], v[176:179], v[116:119]
  v_cvt_pk_bf16_f32 v187, v162, v163
  s_waitcnt lgkmcnt(10)
  v_mfma_f32_16x16x32_bf16 v[40:43], v[208:211], v[168:171], v[40:43]
  v_cvt_pk_bf16_f32 v190, v164, v165
  v_mfma_f32_16x16x32_bf16 v[80:83], v[208:211], v[172:175], v[80:83]
  v_cvt_pk_bf16_f32 v191, v166, v167
  v_mfma_f32_16x16x32_bf16 v[120:123], v[208:211], v[176:179], v[120:123]
  s_waitcnt lgkmcnt(8)
  v_mfma_f32_16x16x32_bf16 v[24:27], v[212:215], v[180:183], v[24:27]
  s_lshl_b32 s83, s37, 1
  s_sub_u32 s83, s38, s83
  s_and_b32 s83, s83, 7
  s_lshl_b32 s42, s37, 10
  s_add_u32 s42, s42, 0x1a000
  v_add_u32 v22, s42, v12
  v_mfma_f32_16x16x32_bf16 v[64:67], v[212:215], v[184:187], v[64:67]
  v_mfma_f32_16x16x32_bf16 v[104:107], v[212:215], v[188:191], v[104:107]
  s_waitcnt lgkmcnt(6)
  v_mfma_f32_16x16x32_bf16 v[28:31], v[216:219], v[180:183], v[28:31]
  v_mfma_f32_16x16x32_bf16 v[68:71], v[216:219], v[184:187], v[68:71]
  v_add_u32 v2, 0xffffb000, v2
  v_add_u32 v3, 0xffffb000, v3
  ds_read_b64_tr_b16 v[192:193], v3 offset:2048
  v_mfma_f32_16x16x32_bf16 v[108:111], v[216:219], v[188:191], v[108:111]
  ds_read_b64_tr_b16 v[194:195], v3 offset:12288
  s_waitcnt lgkmcnt(6)
  v_mfma_f32_16x16x32_bf16 v[32:35], v[220:223], v[180:183], v[32:35]
  ds_read_b64_tr_b16 v[196:197], v2 offset:3072
  v_mfma_f32_16x16x32_bf16 v[72:75], v[220:223], v[184:187], v[72:75]
  ds_read_b64_tr_b16 v[198:199], v2 offset:13312
  v_mfma_f32_16x16x32_bf16 v[112:115], v[220:223], v[188:191], v[112:115]
  ds_read_b64_tr_b16 v[200:201], v3 offset:3072
  s_waitcnt lgkmcnt(7)
  v_mfma_f32_16x16x32_bf16 v[36:39], v[224:227], v[180:183], v[36:39]
  ds_read_b64_tr_b16 v[202:203], v3 offset:13312
  v_mfma_f32_16x16x32_bf16 v[76:79], v[224:227], v[184:187], v[76:79]
  ds_read_b64_tr_b16 v[204:205], v2 offset:4096
  v_mfma_f32_16x16x32_bf16 v[116:119], v[224:227], v[188:191], v[116:119]
  ds_read_b64_tr_b16 v[206:207], v2 offset:14336
  s_waitcnt lgkmcnt(8)
  v_mfma_f32_16x16x32_bf16 v[40:43], v[228:231], v[180:183], v[40:43]
  ds_read_b64_tr_b16 v[208:209], v3 offset:4096
  v_mfma_f32_16x16x32_bf16 v[80:83], v[228:231], v[184:187], v[80:83]
  ds_read_b64_tr_b16 v[210:211], v3 offset:14336
  v_mfma_f32_16x16x32_bf16 v[120:123], v[228:231], v[188:191], v[120:123]
  s_waitcnt lgkmcnt(8)
  v_mfma_f32_16x16x32_bf16 v[44:47], v[192:195], v[168:171], v[44:47]
  v_mfma_f32_16x16x32_bf16 v[84:87], v[192:195], v[172:175], v[84:87]
  v_mfma_f32_16x16x32_bf16 v[124:127], v[192:195], v[176:179], v[124:127]
  s_waitcnt lgkmcnt(6)
  v_mfma_f32_16x16x32_bf16 v[48:51], v[196:199], v[168:171], v[48:51]
  v_add_u32 v2, 0x5000, v2
  v_add_u32 v3, 0x5000, v3
  ds_read_b64_tr_b16 v[212:213], v3 offset:2048
  v_cvt_pk_bf16_f32 v24, v24, v25
  v_mfma_f32_16x16x32_bf16 v[88:91], v[196:199], v[172:175], v[88:91]
  ds_read_b64_tr_b16 v[214:215], v3 offset:12288
  v_cvt_pk_bf16_f32 v25, v26, v27
  v_mfma_f32_16x16x32_bf16 v[128:131], v[196:199], v[176:179], v[128:131]
  ds_read_b64_tr_b16 v[216:217], v2 offset:3072
  v_cvt_pk_bf16_f32 v26, v28, v29
  s_waitcnt lgkmcnt(7)
  v_mfma_f32_16x16x32_bf16 v[52:55], v[200:203], v[168:171], v[52:55]
  ds_read_b64_tr_b16 v[218:219], v2 offset:13312
  v_cvt_pk_bf16_f32 v27, v30, v31
  v_mfma_f32_16x16x32_bf16 v[92:95], v[200:203], v[172:175], v[92:95]
  ds_read_b64_tr_b16 v[220:221], v3 offset:3072
  s_mov_b32 s61, 0
  s_cmp_eq_u32 s83, 0
  s_cselect_b64 exec, 0, -1
  buffer_store_dwordx4 v[24:27], v12, s[68:71], s61 offen sc1
  s_not_b64 exec, exec
  ds_write_b128 v22, v[24:27]
  s_mov_b64 exec, -1
  v_mfma_f32_16x16x32_bf16 v[132:135], v[200:203], v[176:179], v[132:135]
  ds_read_b64_tr_b16 v[222:223], v3 offset:13312
  v_cvt_pk_bf16_f32 v64, v64, v65
  s_waitcnt lgkmcnt(9)
  v_mfma_f32_16x16x32_bf16 v[56:59], v[204:207], v[168:171], v[56:59]
  ds_read_b64_tr_b16 v[224:225], v2 offset:4096
  v_cvt_pk_bf16_f32 v65, v66, v67
  v_mfma_f32_16x16x32_bf16 v[96:99], v[204:207], v[172:175], v[96:99]
  ds_read_b64_tr_b16 v[226:227], v2 offset:14336
  v_cvt_pk_bf16_f32 v66, v68, v69
  v_mfma_f32_16x16x32_bf16 v[136:139], v[204:207], v[176:179], v[136:139]
  ds_read_b64_tr_b16 v[228:229], v3 offset:4096
  v_cvt_pk_bf16_f32 v67, v70, v71
  s_waitcnt lgkmcnt(10)
  v_mfma_f32_16x16x32_bf16 v[60:63], v[208:211], v[168:171], v[60:63]
  ds_read_b64_tr_b16 v[230:231], v3 offset:14336
  s_mov_b32 s61, 0x2000
  s_cmp_eq_u32 s83, 1
  s_cselect_b64 exec, 0, -1
  buffer_store_dwordx4 v[64:67], v12, s[68:71], s61 offen sc1
  s_not_b64 exec, exec
  ds_write_b128 v22, v[64:67]
  s_mov_b64 exec, -1
  v_mfma_f32_16x16x32_bf16 v[100:103], v[208:211], v[172:175], v[100:103]
  v_cvt_pk_bf16_f32 v104, v104, v105
  v_mfma_f32_16x16x32_bf16 v[140:143], v[208:211], v[176:179], v[140:143]
  v_cvt_pk_bf16_f32 v105, v106, v107
  s_waitcnt lgkmcnt(10)
  v_mfma_f32_16x16x32_bf16 v[44:47], v[212:215], v[180:183], v[44:47]
  v_cvt_pk_bf16_f32 v106, v108, v109
  v_cvt_pk_bf16_f32 v107, v110, v111
  v_mfma_f32_16x16x32_bf16 v[84:87], v[212:215], v[184:187], v[84:87]
  s_mov_b32 s61, 0x4000
  s_cmp_eq_u32 s83, 2
  s_cselect_b64 exec, 0, -1
  buffer_store_dwordx4 v[104:107], v12, s[68:71], s61 offen sc1
  s_not_b64 exec, exec
  ds_write_b128 v22, v[104:107]
  s_mov_b64 exec, -1
  v_mfma_f32_16x16x32_bf16 v[124:127], v[212:215], v[188:191], v[124:127]
  v_cvt_pk_bf16_f32 v32, v32, v33
  s_waitcnt lgkmcnt(9)
  v_mfma_f32_16x16x32_bf16 v[48:51], v[216:219], v[180:183], v[48:51]
  v_cvt_pk_bf16_f32 v33, v34, v35
  v_mfma_f32_16x16x32_bf16 v[88:91], v[216:219], v[184:187], v[88:91]
  v_cvt_pk_bf16_f32 v34, v36, v37
  v_cvt_pk_bf16_f32 v35, v38, v39
  v_mfma_f32_16x16x32_bf16 v[128:131], v[216:219], v[188:191], v[128:131]
  s_mov_b32 s61, 0x6000
  s_cmp_eq_u32 s83, 3
  s_cselect_b64 exec, 0, -1
  buffer_store_dwordx4 v[32:35], v12, s[68:71], s61 offen sc1
  s_not_b64 exec, exec
  ds_write_b128 v22, v[32:35]
  s_mov_b64 exec, -1
  s_waitcnt lgkmcnt(7)
  v_mfma_f32_16x16x32_bf16 v[52:55], v[220:223], v[180:183], v[52:55]
  v_cvt_pk_bf16_f32 v72, v72, v73
  v_mfma_f32_16x16x32_bf16 v[92:95], v[220:223], v[184:187], v[92:95]
  v_cvt_pk_bf16_f32 v73, v74, v75
  v_mfma_f32_16x16x32_bf16 v[132:135], v[220:223], v[188:191], v[132:135]
  v_cvt_pk_bf16_f32 v74, v76, v77
  v_cvt_pk_bf16_f32 v75, v78, v79
  s_waitcnt lgkmcnt(5)
  v_mfma_f32_16x16x32_bf16 v[56:59], v[224:227], v[180:183], v[56:59]
  s_mov_b32 s61, 0x8000
  s_cmp_eq_u32 s83, 4
  s_cselect_b64 exec, 0, -1
  buffer_store_dwordx4 v[72:75], v12, s[68:71], s61 offen sc1
  s_not_b64 exec, exec
  ds_write_b128 v22, v[72:75]
  s_mov_b64 exec, -1
  v_mfma_f32_16x16x32_bf16 v[96:99], v[224:227], v[184:187], v[96:99]
  v_cvt_pk_bf16_f32 v112, v112, v113
  v_mfma_f32_16x16x32_bf16 v[136:139], v[224:227], v[188:191], v[136:139]
  v_cvt_pk_bf16_f32 v113, v114, v115
  s_waitcnt lgkmcnt(4)
  v_mfma_f32_16x16x32_bf16 v[60:63], v[228:231], v[180:183], v[60:63]
  v_cvt_pk_bf16_f32 v114, v116, v117
  v_cvt_pk_bf16_f32 v115, v118, v119
  v_mfma_f32_16x16x32_bf16 v[100:103], v[228:231], v[184:187], v[100:103]
  s_mov_b32 s61, 0xa000
  s_cmp_eq_u32 s83, 5
  s_cselect_b64 exec, 0, -1
  buffer_store_dwordx4 v[112:115], v12, s[68:71], s61 offen sc1
  s_not_b64 exec, exec
  ds_write_b128 v22, v[112:115]
  s_mov_b64 exec, -1
  v_mfma_f32_16x16x32_bf16 v[140:143], v[228:231], v[188:191], v[140:143]
  v_mov_b32 v20, 0
  v_mov_b32 v21, 1
  v_cvt_pk_bf16_f32 v40, v40, v41
  v_cvt_pk_bf16_f32 v41, v42, v43
  v_cvt_pk_bf16_f32 v42, v44, v45
  v_cvt_pk_bf16_f32 v43, v46, v47
  s_mov_b32 s61, 0xc000
  s_cmp_eq_u32 s83, 6
  s_cselect_b64 exec, 0, -1
  buffer_store_dwordx4 v[40:43], v12, s[68:71], s61 offen sc1
  s_not_b64 exec, exec
  ds_write_b128 v22, v[40:43]
  s_mov_b64 exec, -1
  v_cvt_pk_bf16_f32 v80, v80, v81
  v_cvt_pk_bf16_f32 v81, v82, v83
  v_cvt_pk_bf16_f32 v82, v84, v85
  v_cvt_pk_bf16_f32 v83, v86, v87
  s_mov_b32 s61, 0xe000
  s_cmp_eq_u32 s83, 7
  s_cselect_b64 exec, 0, -1
  buffer_store_dwordx4 v[80:83], v12, s[68:71], s61 offen sc1
  s_not_b64 exec, exec
  ds_write_b128 v22, v[80:83]
  s_mov_b64 exec, -1
  v_cvt_pk_bf16_f32 v120, v120, v121
  v_cvt_pk_bf16_f32 v121, v122, v123
  v_cvt_pk_bf16_f32 v122, v124, v125
  v_cvt_pk_bf16_f32 v123, v126, v127
  s_mov_b32 s61, 0x10000
  s_cmp_eq_u32 s83, 0
  s_cselect_b64 exec, 0, -1
  buffer_store_dwordx4 v[120:123], v12, s[68:71], s61 offen sc1
  s_not_b64 exec, exec
  ds_write_b128 v22, v[120:123] offset:4096
  s_mov_b64 exec, -1
  v_cvt_pk_bf16_f32 v48, v48, v49
  v_cvt_pk_bf16_f32 v49, v50, v51
  v_cvt_pk_bf16_f32 v50, v52, v53
  v_cvt_pk_bf16_f32 v51, v54, v55
  s_mov_b32 s61, 0x12000
  s_cmp_eq_u32 s83, 1
  s_cselect_b64 exec, 0, -1
  buffer_store_dwordx4 v[48:51], v12, s[68:71], s61 offen sc1
  s_not_b64 exec, exec
  ds_write_b128 v22, v[48:51] offset:4096
  s_mov_b64 exec, -1
  v_cvt_pk_bf16_f32 v88, v88, v89
  v_cvt_pk_bf16_f32 v89, v90, v91
  v_cvt_pk_bf16_f32 v90, v92, v93
  v_cvt_pk_bf16_f32 v91, v94, v95
  s_mov_b32 s61, 0x14000
  s_cmp_eq_u32 s83, 2
  s_cselect_b64 exec, 0, -1
  buffer_store_dwordx4 v[88:91], v12, s[68:71], s61 offen sc1
  s_not_b64 exec, exec
  ds_write_b128 v22, v[88:91] offset:4096
  s_mov_b64 exec, -1
  v_cvt_pk_bf16_f32 v128, v128, v129
  v_cvt_pk_bf16_f32 v129, v130, v131
  v_cvt_pk_bf16_f32 v130, v132, v133
  v_cvt_pk_bf16_f32 v131, v134, v135
  s_mov_b32 s61, 0x16000
  s_cmp_eq_u32 s83, 3
  s_cselect_b64 exec, 0, -1
  buffer_store_dwordx4 v[128:131], v12, s[68:71], s61 offen sc1
  s_not_b64 exec, exec
  ds_write_b128 v22, v[128:131] offset:4096
  s_mov_b64 exec, -1
  v_cvt_pk_bf16_f32 v56, v56, v57
  v_cvt_pk_bf16_f32 v57, v58, v59
  v_cvt_pk_bf16_f32 v58, v60, v61
  v_cvt_pk_bf16_f32 v59, v62, v63
  s_mov_b32 s61, 0x18000
  s_cmp_eq_u32 s83, 4
  s_cselect_b64 exec, 0, -1
  buffer_store_dwordx4 v[56:59], v12, s[68:71], s61 offen sc1
  s_not_b64 exec, exec
  ds_write_b128 v22, v[56:59] offset:4096
  s_mov_b64 exec, -1
  v_cvt_pk_bf16_f32 v96, v96, v97
  v_cvt_pk_bf16_f32 v97, v98, v99
  v_cvt_pk_bf16_f32 v98, v100, v101
  v_cvt_pk_bf16_f32 v99, v102, v103
  s_mov_b32 s61, 0x1a000
  s_cmp_eq_u32 s83, 5
  s_cselect_b64 exec, 0, -1
  buffer_store_dwordx4 v[96:99], v12, s[68:71], s61 offen sc1
  s_not_b64 exec, exec
  ds_write_b128 v22, v[96:99] offset:4096
  s_mov_b64 exec, -1
  v_cvt_pk_bf16_f32 v136, v136, v137
  v_cvt_pk_bf16_f32 v137, v138, v139
  v_cvt_pk_bf16_f32 v138, v140, v141
  v_cvt_pk_bf16_f32 v139, v142, v143
  s_mov_b32 s61, 0x1c000
  s_cmp_eq_u32 s83, 6
  s_cselect_b64 exec, 0, -1
  buffer_store_dwordx4 v[136:139], v12, s[68:71], s61 offen sc1
  s_not_b64 exec, exec
  ds_write_b128 v22, v[136:139] offset:4096
  s_mov_b64 exec, -1
  s_lshl_b32 s44, s34, 3
  s_add_u32 s44, s44, s39
  s_lshl_b32 s44, s44, 1
  s_add_u32 s44, s44, s40
  s_and_b32 s80, s37, 3
  s_lshl_b32 s42, s80, 1
  s_sub_u32 s76, s38, s42
  s_and_b32 s76, s76, 7
  s_add_u32 s76, s76, 8
  s_mul_i32 s43, s76, 0x5556
  s_lshr_b32 s43, s43, 16
  s_mul_i32 s45, s43, 3
  s_sub_u32 s42, s76, s45
  s_add_u32 s45, s38, 1
  s_and_b32 s45, s45, 7
  s_lshl_b32 s8, s45, 10
  s_add_u32 s45, s38, 2
  s_and_b32 s45, s45, 7
  s_lshl_b32 s9, s45, 10
  s_add_u32 s45, s38, 3
  s_and_b32 s45, s45, 7
  s_lshl_b32 s10, s45, 10
  s_add_u32 s45, s38, 4
  s_and_b32 s45, s45, 7
  s_lshl_b32 s11, s45, 10
  s_add_u32 s45, s38, 5
  s_and_b32 s45, s45, 7
  s_lshl_b32 s12, s45, 10
  s_add_u32 s45, s38, 6
  s_and_b32 s45, s45, 7
  s_lshl_b32 s13, s45, 10
  s_add_u32 s45, s38, 7
  s_and_b32 s45, s45, 7
  s_lshl_b32 s14, s45, 10
  s_lshl_b32 s45, s80, 10
  s_add_u32 s45, s45, 0x1b000
  v_lshlrev_b32 v149, 4, v1
  v_add_u32 v149, s45, v149
  s_lshl_b32 s81, s44, 2
  s_add_u32 s81, s81, s80
  s_lshl_b32 s82, s81, 7
  s_add_u32 s82, s82, 0x2008000
  s_add_u32 s72, s32, s82
  s_addc_u32 s73, s33, 0
  s_mov_b32 s74, 32
  s_mov_b32 s75, 0x20000
  s_mul_i32 s81, s81, 15
  s_mul_i32 s45, s43, 3
  s_add_u32 s81, s81, s45
  s_add_u32 s81, s81, s42
  s_lshl_b32 s81, s81, 13
  s_add_u32 s81, s81, 0x800000
  s_add_u32 s64, s32, s81
  s_addc_u32 s65, s33, 0
  s_mov_b32 s66, 0x2000
  s_mov_b32 s67, 0x20000
  s_lshl_b32 s81, s42, 4
  s_lshl_b32 s82, s43, 7
  s_and_b32 s42, s80, 1
  s_lshl_b32 s43, s39, 1
  s_add_u32 s42, s42, s43
  s_mul_i32 s42, s42, 48
  s_add_u32 s81, s81, s42
  s_lshr_b32 s42, s80, 1
  s_lshl_b32 s42, s42, 6
  s_add_u32 s82, s82, s42
  s_mul_i32 s42, s40, 0x280
  s_add_u32 s82, s82, s42
  s_mul_i32 s42, s34, 0x500
  s_add_u32 s82, s82, s42
  s_mul_i32 s81, s81, 0xa00
  s_add_u32 s81, s81, s82
  s_add_u32 s84, s28, s81
  s_addc_u32 s85, s29, 0
  s_mov_b32 s86, 0x9640
  s_mov_b32 s87, 0x20000
  s_mov_b32 s77, 0xffff0000
  s_mov_b32 s79, 0x1000
  v_lshlrev_b32 v144, 4, v1
  v_lshlrev_b32 v146, 2, v1
  v_and_b32 v147, 15, v1
  v_mul_u32_u24 v145, 0xa00, v147
  v_bfe_u32 v147, v1, 4, 1
  v_lshl_add_u32 v145, v147, 5, v145
  v_lshrrev_b32 v147, 5, v1
  v_lshl_add_u32 v145, v147, 4, v145
  s_waitcnt vmcnt(6)
  s_mov_b64 exec, 1
  buffer_store_dword v21, v20, s[52:55], s60 offen sc1
  s_mov_b64 exec, -1
  s_waitcnt lgkmcnt(0)
  s_barrier
  s_add_u32 s60, s60, 0x4000
  s_waitcnt vmcnt(0)
  s_mov_b64 exec, 1
  buffer_store_dword v21, v20, s[52:55], s60 offen sc1
  s_mov_b64 exec, -1
  s_cmp_ge_u32 s76, 15
  s_cbranch_scc1 L_nored_1
  s_mov_b32 s78, 0x20000
  s_mov_b64 exec, 255
L_poll_2:
  buffer_load_dword v147, v146, s[72:75], 0 offen sc1
  s_sub_u32 s78, s78, 1
  s_cbranch_scc1 L_polled_3
  s_waitcnt vmcnt(0)
  v_cmp_ne_u32 vcc, 1, v147
  s_nop 4
  s_cbranch_vccnz L_poll_2
L_polled_3:
  s_waitcnt vmcnt(0)
  s_mov_b64 exec, -1
  ds_read_b128 v[160:163], v149
  buffer_load_dwordx4 v[164:167], v144, s[64:67], s8 offen sc1
  buffer_load_dwordx4 v[168:171], v144, s[64:67], s9 offen sc1
  buffer_load_dwordx4 v[172:175], v144, s[64:67], s10 offen sc1
  buffer_load_dwordx4 v[176:179], v144, s[64:67], s11 offen sc1
  buffer_load_dwordx4 v[180:183], v144, s[64:67], s12 offen sc1
  buffer_load_dwordx4 v[184:187], v144, s[64:67], s13 offen sc1
  buffer_load_dwordx4 v[188:191], v144, s[64:67], s14 offen sc1
  s_waitcnt lgkmcnt(0)
  v_lshlrev_b32 v152, 16, v160
  v_and_b32 v153, s77, v160
  v_lshlrev_b32 v154, 16, v161
  v_and_b32 v155, s77, v161
  v_lshlrev_b32 v156, 16, v162
  v_and_b32 v157, s77, v162
  v_lshlrev_b32 v158, 16, v163
  v_and_b32 v159, s77, v163
  s_waitcnt vmcnt(6)
  v_lshlrev_b32 v147, 16, v164
  v_and_b32 v148, s77, v164
  v_add_f32 v152, v152, v147
  v_add_f32 v153, v153, v148
  v_lshlrev_b32 v147, 16, v165
  v_and_b32 v148, s77, v165
  v_add_f32 v154, v154, v147
  v_add_f32 v155, v155, v148
  v_lshlrev_b32 v147, 16, v166
  v_and_b32 v148, s77, v166
  v_add_f32 v156, v156, v147
  v_add_f32 v157, v157, v148
  v_lshlrev_b32 v147, 16, v167
  v_and_b32 v148, s77, v167
  v_add_f32 v158, v158, v147
  v_add_f32 v159, v159, v148
  s_waitcnt vmcnt(5)
  v_lshlrev_b32 v147, 16, v168
  v_and_b32 v148, s77, v168
  v_add_f32 v152, v152, v147
  v_add_f32 v153, v153, v148
  v_lshlrev_b32 v147, 16, v169
  v_and_b32 v148, s77, v169
  v_add_f32 v154, v154, v147
  v_add_f32 v155, v155, v148
  v_lshlrev_b32 v147, 16, v170
  v_and_b32 v148, s77, v170
  v_add_f32 v156, v156, v147
  v_add_f32 v157, v157, v148
  v_lshlrev_b32 v147, 16, v171
  v_and_b32 v148, s77, v171
  v_add_f32 v158, v158, v147
  v_add_f32 v159, v159, v148
  s_waitcnt vmcnt(4)
  v_lshlrev_b32 v147, 16, v172
  v_and_b32 v148, s77, v172
  v_add_f32 v152, v152, v147
  v_add_f32 v153, v153, v148
  v_lshlrev_b32 v147, 16, v173
  v_and_b32 v148, s77, v173
  v_add_f32 v154, v154, v147
  v_add_f32 v155, v155, v148
  v_lshlrev_b32 v147, 16, v174
  v_and_b32 v148, s77, v174
  v_add_f32 v156, v156, v147
  v_add_f32 v157, v157, v148
  v_lshlrev_b32 v147, 16, v175
  v_and_b32 v148, s77, v175
  v_add_f32 v158, v158, v147
  v_add_f32 v159, v159, v148
  s_waitcnt vmcnt(3)
  v_lshlrev_b32 v147, 16, v176
  v_and_b32 v148, s77, v176
  v_add_f32 v152, v152, v147
  v_add_f32 v153, v153, v148
  v_lshlrev_b32 v147, 16, v177
  v_and_b32 v148, s77, v177
  v_add_f32 v154, v154, v147
  v_add_f32 v155, v155, v148
  v_lshlrev_b32 v147, 16, v178
  v_and_b32 v148, s77, v178
  v_add_f32 v156, v156, v147
  v_add_f32 v157, v157, v148
  v_lshlrev_b32 v147, 16, v179
  v_and_b32 v148, s77, v179
  v_add_f32 v158, v158, v147
  v_add_f32 v159, v159, v148
  s_waitcnt vmcnt(2)
  v_lshlrev_b32 v147, 16, v180
  v_and_b32 v148, s77, v180
  v_add_f32 v152, v152, v147
  v_add_f32 v153, v153, v148
  v_lshlrev_b32 v147, 16, v181
  v_and_b32 v148, s77, v181
  v_add_f32 v154, v154, v147
  v_add_f32 v155, v155, v148
  v_lshlrev_b32 v147, 16, v182
  v_and_b32 v148, s77, v182
  v_add_f32 v156, v156, v147
  v_add_f32 v157, v157, v148
  v_lshlrev_b32 v147, 16, v183
  v_and_b32 v148, s77, v183
  v_add_f32 v158, v158, v147
  v_add_f32 v159, v159, v148
  s_waitcnt vmcnt(1)
  v_lshlrev_b32 v147, 16, v184
  v_and_b32 v148, s77, v184
  v_add_f32 v152, v152, v147
  v_add_f32 v153, v153, v148
  v_lshlrev_b32 v147, 16, v185
  v_and_b32 v148, s77, v185
  v_add_f32 v154, v154, v147
  v_add_f32 v155, v155, v148
  v_lshlrev_b32 v147, 16, v186
  v_and_b32 v148, s77, v186
  v_add_f32 v156, v156, v147
  v_add_f32 v157, v157, v148
  v_lshlrev_b32 v147, 16, v187
  v_and_b32 v148, s77, v187
  v_add_f32 v158, v158, v147
  v_add_f32 v159, v159, v148
  s_waitcnt vmcnt(0)
  v_lshlrev_b32 v147, 16, v188
  v_and_b32 v148, s77, v188
  v_add_f32 v152, v152, v147
  v_add_f32 v153, v153, v148
  v_lshlrev_b32 v147, 16, v189
  v_and_b32 v148, s77, v189
  v_add_f32 v154, v154, v147
  v_add_f32 v155, v155, v148
  v_lshlrev_b32 v147, 16, v190
  v_and_b32 v148, s77, v190
  v_add_f32 v156, v156, v147
  v_add_f32 v157, v157, v148
  v_lshlrev_b32 v147, 16, v191
  v_and_b32 v148, s77, v191
  v_add_f32 v158, v158, v147
  v_add_f32 v159, v159, v148
  v_cvt_pk_bf16_f32 v160, v152, v153
  v_cvt_pk_bf16_f32 v161, v154, v155
  v_cvt_pk_bf16_f32 v162, v156, v157
  v_cvt_pk_bf16_f32 v163, v158, v159
  s_nop 0
  v_permlane16_swap_b32 v160, v162
  v_permlane16_swap_b32 v161, v163
  buffer_store_dwordx4 v[160:163], v145, s[84:87], 0 offen
L_nored_1:
  s_endpgm
L_loader:
  s_sub_u32 s48, s37, 4
  v_lshrrev_b32 v2, 3, v1
  v_lshrrev_b32 v4, 4, v1
  v_mul_u32_u24 v3, 0x3000, v2
  v_and_b32 v5, 1, v4
  v_bfe_u32 v6, v1, 1, 2
  v_xor_b32 v6, v6, v5
  v_and_b32 v5, 1, v1
  v_lshl_add_u32 v3, v5, 4, v3
  v_lshl_add_u32 v6, v6, 5, v3
  v_mul_u32_u24 v3, 0x500, v2
  v_and_b32 v5, 7, v1
  v_xor_b32 v5, v5, v4
  v_lshl_add_u32 v7, v5, 4, v3
  s_lshr_b32 s42, s36, 1
  s_mul_i32 s42, s42, 12
  s_add_u32 s42, s42, s48
  s_add_u32 s42, s42, 0
  s_cmp_ge_u32 s42, 24
  s_cselect_b32 s43, 24, 0
  s_sub_u32 s42, s42, s43
  s_lshl_b32 s68, s42, 10
  s_mul_i32 s43, s42, 0x5556
  s_lshr_b32 s43, s43, 16
  s_mul_i32 s44, s43, 3
  s_sub_u32 s42, s42, s44
  s_lshl_b32 s42, s42, 7
  s_mul_i32 s44, s43, 0x18000
  s_add_u32 s42, s42, s44
  s_and_b32 s43, s43, 1
  s_lshl_b32 s43, s43, 6
  v_xor_b32 v8, s43, v6
  v_add_u32 v8, s42, v8
  s_bfe_u32 s42, s35, 0x20001
  s_mul_i32 s42, s42, 6
  s_add_u32 s42, s42, s48
  s_add_u32 s42, s42, 0
  s_cmp_ge_u32 s42, 24
  s_cselect_b32 s43, 24, 0
  s_sub_u32 s42, s42, s43
  s_lshl_b32 s74, s42, 10
  s_add_u32 s74, s74, 0x6000
  s_and_b32 s43, s42, 1
  s_lshl_b32 s43, s43, 6
  s_mul_i32 s42, s42, 0x2800
  v_xor_b32 v14, s43, v7
  v_add_u32 v14, s42, v14
  s_waitcnt lgkmcnt(0)
  s_cmp_eq_u32 s34, 1
  s_cselect_b32 s46, s24, s14
  s_cselect_b32 s47, s25, s15
  s_mul_i32 s42, s35, 0x180
  s_add_u32 s52, s46, s42
  s_addc_u32 s53, s47, 0
  s_mov_b32 s54, 0
  s_mov_b32 s55, 0x20000
  s_sub_u32 s54, 0x780000, s42
  s_cmp_eq_u32 s34, 1
  s_cselect_b32 s46, s18, s8
  s_cselect_b32 s47, s19, s9
  s_mul_i32 s42, s36, 0x3c000
  s_add_u32 s56, s46, s42
  s_addc_u32 s57, s47, 0
  s_mov_b32 s58, 0x3c000
  s_mov_b32 s59, 0x20000
  s_mov_b32 s64, 0
  s_add_u32 m0, s68, 0
  s_nop 0
  buffer_load_dwordx4 v8, s[52:55], s64 offen lds
  s_mov_b32 s65, 0
  s_add_u32 m0, s74, 0
  s_nop 0
  buffer_load_dwordx4 v14, s[56:59], s65 offen lds
  s_lshr_b32 s42, s36, 1
  s_mul_i32 s42, s42, 12
  s_add_u32 s42, s42, s48
  s_add_u32 s42, s42, 4
  s_cmp_ge_u32 s42, 24
  s_cselect_b32 s43, 24, 0
  s_sub_u32 s42, s42, s43
  s_lshl_b32 s69, s42, 10
  s_mul_i32 s43, s42, 0x5556
  s_lshr_b32 s43, s43, 16
  s_mul_i32 s44, s43, 3
  s_sub_u32 s42, s42, s44
  s_lshl_b32 s42, s42, 7
  s_mul_i32 s44, s43, 0x18000
  s_add_u32 s42, s42, s44
  s_and_b32 s43, s43, 1
  s_lshl_b32 s43, s43, 6
  v_xor_b32 v9, s43, v6
  v_add_u32 v9, s42, v9
  s_add_u32 m0, s69, 0
  s_nop 0
  buffer_load_dwordx4 v9, s[52:55], s64 offen lds
  s_bfe_u32 s42, s35, 0x20001
  s_mul_i32 s42, s42, 6
  s_add_u32 s42, s42, s48
  s_add_u32 s42, s42, 4
  s_cmp_ge_u32 s42, 24
  s_cselect_b32 s43, 24, 0
  s_sub_u32 s42, s42, s43
  s_lshl_b32 s75, s42, 10
  s_add_u32 s75, s75, 0x6000
  s_and_b32 s43, s42, 1
  s_lshl_b32 s43, s43, 6
  s_mul_i32 s42, s42, 0x2800
  v_xor_b32 v15, s43, v7
  v_add_u32 v15, s42, v15
  s_add_u32 m0, s75, 0
  s_nop 0
  buffer_load_dwordx4 v15, s[56:59], s65 offen lds
  s_lshr_b32 s42, s36, 1
  s_mul_i32 s42, s42, 12
  s_add_u32 s42, s42, s48
  s_add_u32 s42, s42, 8
  s_cmp_ge_u32 s42, 24
  s_cselect_b32 s43, 24, 0
  s_sub_u32 s42, s42, s43
  s_lshl_b32 s70, s42, 10
  s_mul_i32 s43, s42, 0x5556
  s_lshr_b32 s43, s43, 16
  s_mul_i32 s44, s43, 3
  s_sub_u32 s42, s42, s44
  s_lshl_b32 s42, s42, 7
  s_mul_i32 s44, s43, 0x18000
  s_add_u32 s42, s42, s44
  s_and_b32 s43, s43, 1
  s_lshl_b32 s43, s43, 6
  v_xor_b32 v10, s43, v6
  v_add_u32 v10, s42, v10
  s_add_u32 m0, s70, 0
  s_nop 0
  buffer_load_dwordx4 v10, s[52:55], s64 offen lds
  s_bfe_u32 s42, s35, 0x20001
  s_mul_i32 s42, s42, 6
  s_add_u32 s42, s42, s48
  s_add_u32 s42, s42, 8
  s_cmp_ge_u32 s42, 24
  s_cselect_b32 s43, 24, 0
  s_sub_u32 s42, s42, s43
  s_lshl_b32 s76, s42, 10
  s_add_u32 s76, s76, 0x6000
  s_and_b32 s43, s42, 1
  s_lshl_b32 s43, s43, 6
  s_mul_i32 s42, s42, 0x2800
  v_xor_b32 v16, s43, v7
  v_add_u32 v16, s42, v16
  s_add_u32 m0, s76, 0
  s_nop 0
  buffer_load_dwordx4 v16, s[56:59], s65 offen lds
  s_lshr_b32 s42, s36, 1
  s_mul_i32 s42, s42, 12
  s_add_u32 s42, s42, s48
  s_add_u32 s42, s42, 12
  s_cmp_ge_u32 s42, 24
  s_cselect_b32 s43, 24, 0
  s_sub_u32 s42, s42, s43
  s_lshl_b32 s71, s42, 10
  s_mul_i32 s43, s42, 0x5556
  s_lshr_b32 s43, s43, 16
  s_mul_i32 s44, s43, 3
  s_sub_u32 s42, s42, s44
  s_lshl_b32 s42, s42, 7
  s_mul_i32 s44, s43, 0x18000
  s_add_u32 s42, s42, s44
  s_and_b32 s43, s43, 1
  s_lshl_b32 s43, s43, 6
  v_xor_b32 v11, s43, v6
  v_add_u32 v11, s42, v11
  s_add_u32 m0, s71, 0
  s_nop 0
  buffer_load_dwordx4 v11, s[52:55], s64 offen lds
  s_bfe_u32 s42, s35, 0x20001
  s_mul_i32 s42, s42, 6
  s_add_u32 s42, s42, s48
  s_add_u32 s42, s42, 12
  s_cmp_ge_u32 s42, 24
  s_cselect_b32 s43, 24, 0
  s_sub_u32 s42, s42, s43
  s_lshl_b32 s77, s42, 10
  s_add_u32 s77, s77, 0x6000
  s_and_b32 s43, s42, 1
  s_lshl_b32 s43, s43, 6
  s_mul_i32 s42, s42, 0x2800
  v_xor_b32 v17, s43, v7
  v_add_u32 v17, s42, v17
  s_add_u32 m0, s77, 0
  s_nop 0
  buffer_load_dwordx4 v17, s[56:59], s65 offen lds
  s_lshr_b32 s42, s36, 1
  s_mul_i32 s42, s42, 12
  s_add_u32 s42, s42, s48
  s_add_u32 s42, s42, 16
  s_cmp_ge_u32 s42, 24
  s_cselect_b32 s43, 24, 0
  s_sub_u32 s42, s42, s43
  s_lshl_b32 s72, s42, 10
  s_mul_i32 s43, s42, 0x5556
  s_lshr_b32 s43, s43, 16
  s_mul_i32 s44, s43, 3
  s_sub_u32 s42, s42, s44
  s_lshl_b32 s42, s42, 7
  s_mul_i32 s44, s43, 0x18000
  s_add_u32 s42, s42, s44
  s_and_b32 s43, s43, 1
  s_lshl_b32 s43, s43, 6
  v_xor_b32 v12, s43, v6
  v_add_u32 v12, s42, v12
  s_add_u32 m0, s72, 0
  s_nop 0
  buffer_load_dwordx4 v12, s[52:55], s64 offen lds
  s_bfe_u32 s42, s35, 0x20001
  s_mul_i32 s42, s42, 6
  s_add_u32 s42, s42, s48
  s_add_u32 s42, s42, 16
  s_cmp_ge_u32 s42, 24
  s_cselect_b32 s43, 24, 0
  s_sub_u32 s42, s42, s43
  s_lshl_b32 s78, s42, 10
  s_add_u32 s78, s78, 0x6000
  s_and_b32 s43, s42, 1
  s_lshl_b32 s43, s43, 6
  s_mul_i32 s42, s42, 0x2800
  v_xor_b32 v18, s43, v7
  v_add_u32 v18, s42, v18
  s_add_u32 m0, s78, 0
  s_nop 0
  buffer_load_dwordx4 v18, s[56:59], s65 offen lds
  s_lshr_b32 s42, s36, 1
  s_mul_i32 s42, s42, 12
  s_add_u32 s42, s42, s48
  s_add_u32 s42, s42, 20
  s_cmp_ge_u32 s42, 24
  s_cselect_b32 s43, 24, 0
  s_sub_u32 s42, s42, s43
  s_lshl_b32 s73, s42, 10
  s_mul_i32 s43, s42, 0x5556
  s_lshr_b32 s43, s43, 16
  s_mul_i32 s44, s43, 3
  s_sub_u32 s42, s42, s44
  s_lshl_b32 s42, s42, 7
  s_mul_i32 s44, s43, 0x18000
  s_add_u32 s42, s42, s44
  s_and_b32 s43, s43, 1
  s_lshl_b32 s43, s43, 6
  v_xor_b32 v13, s43, v6
  v_add_u32 v13, s42, v13
  s_add_u32 m0, s73, 0
  s_nop 0
  buffer_load_dwordx4 v13, s[52:55], s64 offen lds
  s_bfe_u32 s42, s35, 0x20001
  s_mul_i32 s42, s42, 6
  s_add_u32 s42, s42, s48
  s_add_u32 s42, s42, 20
  s_cmp_ge_u32 s42, 24
  s_cselect_b32 s43, 24, 0
  s_sub_u32 s42, s42, s43
  s_lshl_b32 s79, s42, 10
  s_add_u32 s79, s79, 0x6000
  s_and_b32 s43, s42, 1
  s_lshl_b32 s43, s43, 6
  s_mul_i32 s42, s42, 0x2800
  v_xor_b32 v19, s43, v7
  v_add_u32 v19, s42, v19
  s_add_u32 m0, s79, 0
  s_nop 0
  buffer_load_dwordx4 v19, s[56:59], s65 offen lds
  s_cmp_eq_u32 s34, 1
  s_cselect_b32 s46, s20, s10
  s_cselect_b32 s47, s21, s11
  s_lshl_b32 s42, s36, 2
  s_add_u32 s42, s42, s48
  s_lshl_b32 s42, s42, 5
  s_add_u32 s42, s42, s35
  s_mul_i32 s43, s42, 0x4800
  s_add_u32 s60, s46, s43
  s_addc_u32 s61, s47, 0
  s_mov_b32 s62, 0x4800
  s_mov_b32 s63, 0x20000
  s_and_b32 s42, s2, 1
  s_cmp_eq_u32 s42, 0
  s_cselect_b64 s[14:15], -1, 0
  s_cselect_b64 s[24:25], 0, -1
  s_add_u32 s43, s36, s35
  s_and_b32 s43, s43, 1
  s_sub_u32 s44, 0, s43
  s_cmp_eq_u32 s42, 0
  s_cselect_b32 s44, s43, s44
  s_cselect_b32 s43, s43, 0
  s_mul_i32 s4, s44, 0xc0000
  s_mul_i32 s5, s44, 0x80
  s_mul_i32 s6, s43, 0xc0000
  s_mul_i32 s7, s43, 0x80
  s_mov_b32 s66, 0x1800
  s_mov_b32 s67, 0x3000
  v_mul_u32_u24 v3, 0x180, v2
  v_and_b32 v5, 7, v1
  v_lshl_add_u32 v20, v5, 4, v3
  s_mul_i32 s42, s48, 0x1800
  s_add_u32 s42, s42, 0xc000
  v_xor_b32 v5, v5, v4
  v_lshlrev_b32 v3, 7, v2
  v_add_u32 v3, s42, v3
  v_lshl_add_u32 v21, v5, 4, v3
  v_xor_b32 v5, 4, v5
  v_lshl_add_u32 v22, v5, 4, v3
  v_and_b32 v5, 7, v1
  v_xor_b32 v5, v5, v4
  v_mul_u32_u24 v3, 0x180, v2
  v_lshl_add_u32 v122, v5, 4, v3
  v_xor_b32 v123, 64, v122
  s_mov_b32 s64, 0xc0000
  s_add_u32 m0, s68, 0xc000
  s_nop 0
  buffer_load_dwordx4 v8, s[52:55], s64 offen lds
  s_add_u32 m0, s69, 0xc000
  s_nop 0
  buffer_load_dwordx4 v9, s[52:55], s64 offen lds
  s_mov_b32 s65, 0x80
  s_add_u32 m0, s74, 0xc000
  s_nop 0
  buffer_load_dwordx4 v14, s[56:59], s65 offen lds
  s_add_u32 m0, s70, 0xc000
  s_nop 0
  buffer_load_dwordx4 v10, s[52:55], s64 offen lds
  s_add_u32 m0, s75, 0xc000
  s_nop 0
  buffer_load_dwordx4 v15, s[56:59], s65 offen lds
  s_waitcnt vmcnt(5)
  s_barrier
  s_cmp_lg_u32 s48, 0
  s_cbranch_scc1 L_nocount
  s_mov_b32 s19, 1
  s_atomic_add s19, s[30:31], 0x0
L_nocount:
  s_add_u32 m0, s71, 0xc000
  s_nop 0
  buffer_load_dwordx4 v11, s[52:55], s64 offen lds
  s_add_u32 m0, s76, 0xc000
  s_nop 0
  buffer_load_dwordx4 v16, s[56:59], s65 offen lds
  s_add_u32 m0, s72, 0xc000
  s_nop 0
  buffer_load_dwordx4 v12, s[52:55], s64 offen lds
  s_add_u32 m0, s77, 0xc000
  s_nop 0
  buffer_load_dwordx4 v17, s[56:59], s65 offen lds
  s_add_u32 m0, s73, 0xc000
  s_nop 0
  buffer_load_dwordx4 v13, s[52:55], s64 offen lds
  s_add_u32 m0, s78, 0xc000
  s_nop 0
  buffer_load_dwordx4 v18, s[56:59], s65 offen lds
  s_add_u32 m0, s79, 0xc000
  s_nop 0
  buffer_load_dwordx4 v19, s[56:59], s65 offen lds
  s_add_u32 s64, 0x180000, s6
  s_add_u32 s65, 0x100, s7
  s_add_u32 m0, s68, 0x18000
  s_nop 0
  buffer_load_dwordx4 v8, s[52:55], s64 offen lds
  s_add_u32 m0, s69, 0x18000
  s_nop 0
  buffer_load_dwordx4 v9, s[52:55], s64 offen lds
  s_add_u32 m0, s74, 0x18000
  s_nop 0
  buffer_load_dwordx4 v14, s[56:59], s65 offen lds
  s_add_u32 m0, s70, 0x18000
  s_nop 0
  buffer_load_dwordx4 v10, s[52:55], s64 offen lds
  s_add_u32 m0, s75, 0x18000
  s_nop 0
  buffer_load_dwordx4 v15, s[56:59], s65 offen lds
  s_add_u32 m0, s71, 0x18000
  s_nop 0
  buffer_load_dwordx4 v11, s[52:55], s64 offen lds
  v_mov_b32 v112, 0
  s_waitcnt vmcnt(6)
  s_barrier
  s_add_u32 m0, s76, 0x18000
  s_nop 0
  buffer_load_dwordx4 v16, s[56:59], s65 offen lds
  s_add_u32 m0, s72, 0x18000
  s_nop 0
  buffer_load_dwordx4 v12, s[52:55], s64 offen lds
  s_add_u32 m0, s77, 0x18000
  s_nop 0
  buffer_load_dwordx4 v17, s[56:59], s65 offen lds
  s_add_u32 m0, s73, 0x18000
  s_nop 0
  buffer_load_dwordx4 v13, s[52:55], s64 offen lds
  s_add_u32 m0, s78, 0x18000
  s_nop 0
  buffer_load_dwordx4 v18, s[56:59], s65 offen lds
  s_add_u32 m0, s79, 0x18000
  s_nop 0
  buffer_load_dwordx4 v19, s[56:59], s65 offen lds
  s_sub_u32 s64, 0x240000, s4
  s_sub_u32 s65, 0x180, s5
  s_add_u32 m0, s68, 0
  s_nop 0
  buffer_load_dwordx4 v8, s[52:55], s64 offen lds
  s_add_u32 m0, s69, 0
  s_nop 0
  buffer_load_dwordx4 v9, s[52:55], s64 offen lds
  s_add_u32 m0, s74, 0
  s_nop 0
  buffer_load_dwordx4 v14, s[56:59], s65 offen lds
  s_add_u32 m0, s70, 0
  s_nop 0
  buffer_load_dwordx4 v10, s[52:55], s64 offen lds
  s_add_u32 m0, s75, 0
  s_nop 0
  buffer_load_dwordx4 v15, s[56:59], s65 offen lds
  s_mov_b64 exec, s[24:25]
  buffer_load_dwordx4 v[28:31], v20, s[60:63], s67 offen offset:3200 nt
  buffer_load_dwordx4 v[32:35], v20, s[60:63], s67 offen offset:128 nt
  buffer_load_dwordx4 v[36:39], v20, s[60:63], s66 offen offset:3200 nt
  buffer_load_dwordx4 v[40:43], v20, s[60:63], s66 offen offset:128 nt
  s_mov_b64 exec, -1
  s_waitcnt vmcnt(9)
  s_barrier
  s_add_u32 m0, s71, 0
  s_nop 0
  buffer_load_dwordx4 v11, s[52:55], s64 offen lds
  s_add_u32 m0, s76, 0
  s_nop 0
  buffer_load_dwordx4 v16, s[56:59], s65 offen lds
  s_add_u32 m0, s72, 0
  s_nop 0
  buffer_load_dwordx4 v12, s[52:55], s64 offen lds
  s_add_u32 m0, s77, 0
  s_nop 0
  buffer_load_dwordx4 v17, s[56:59], s65 offen lds
  s_add_u32 m0, s73, 0
  s_nop 0
  buffer_load_dwordx4 v13, s[52:55], s64 offen lds
  s_add_u32 m0, s78, 0
  s_nop 0
  buffer_load_dwordx4 v18, s[56:59], s65 offen lds
  s_add_u32 m0, s79, 0
  s_nop 0
  buffer_load_dwordx4 v19, s[56:59], s65 offen lds
  s_add_u32 s64, 0x300000, s4
  s_add_u32 s65, 0x200, s5
  s_add_u32 m0, s68, 0xc000
  s_nop 0
  buffer_load_dwordx4 v8, s[52:55], s64 offen lds
  s_add_u32 m0, s69, 0xc000
  s_nop 0
  buffer_load_dwordx4 v9, s[52:55], s64 offen lds
  s_add_u32 m0, s74, 0xc000
  s_nop 0
  buffer_load_dwordx4 v14, s[56:59], s65 offen lds
  s_add_u32 m0, s70, 0xc000
  s_nop 0
  buffer_load_dwordx4 v10, s[52:55], s64 offen lds
  s_add_u32 m0, s75, 0xc000
  s_nop 0
  buffer_load_dwordx4 v15, s[56:59], s65 offen lds
  s_mov_b64 exec, s[14:15]
  buffer_load_dwordx4 v[28:31], v20, s[60:63], s67 offen offset:3200 nt
  buffer_load_dwordx4 v[32:35], v20, s[60:63], s67 offen offset:128 nt
  buffer_load_dwordx4 v[36:39], v20, s[60:63], s66 offen offset:3200 nt
  buffer_load_dwordx4 v[40:43], v20, s[60:63], s66 offen offset:128 nt
  s_mov_b64 exec, -1
  s_waitcnt vmcnt(9)
  s_barrier
  v_bfe_u32 v3, v1, 1, 2
  v_xor_b32 v3, v3, v4
  v_lshlrev_b32 v3, 5, v3
  v_and_b32 v5, 1, v1
  v_lshl_add_u32 v100, v5, 4, v3
  v_mul_u32_u24 v3, 0x180, v2
  v_add_u32 v3, v3, v100
  s_mul_i32 s42, s40, 6
  s_add_u32 s42, s42, s48
  s_add_u32 s42, s42, 0
  s_cmp_ge_u32 s42, 12
  s_cselect_b32 s43, 12, 0
  s_sub_u32 s42, s42, s43
  s_lshl_b32 s8, s42, 10
  s_cmp_ge_u32 s42, 6
  s_cselect_b32 s43, 0x8b800, 0
  s_mul_i32 s42, s42, 0xc00
  s_add_u32 s42, s42, s43
  v_add_u32 v108, s42, v3
  s_mul_i32 s42, s40, 6
  s_add_u32 s42, s42, s48
  s_add_u32 s42, s42, 4
  s_cmp_ge_u32 s42, 12
  s_cselect_b32 s43, 12, 0
  s_sub_u32 s42, s42, s43
  s_lshl_b32 s9, s42, 10
  s_cmp_ge_u32 s42, 6
  s_cselect_b32 s43, 0x8b800, 0
  s_mul_i32 s42, s42, 0xc00
  s_add_u32 s42, s42, s43
  v_add_u32 v109, s42, v3
  s_mul_i32 s42, s40, 6
  s_add_u32 s42, s42, s48
  s_add_u32 s42, s42, 8
  s_cmp_ge_u32 s42, 12
  s_cselect_b32 s43, 12, 0
  s_sub_u32 s42, s42, s43
  s_lshl_b32 s10, s42, 10
  s_cmp_ge_u32 s42, 6
  s_cselect_b32 s43, 0x8b800, 0
  s_mul_i32 s42, s42, 0xc00
  s_add_u32 s42, s42, s43
  v_add_u32 v110, s42, v3
  s_add_u32 m0, s71, 0xc000
  s_nop 0
  buffer_load_dwordx4 v11, s[52:55], s64 offen lds
  s_add_u32 m0, s76, 0xc000
  s_nop 0
  buffer_load_dwordx4 v16, s[56:59], s65 offen lds
  s_add_u32 m0, s72, 0xc000
  s_nop 0
  buffer_load_dwordx4 v12, s[52:55], s64 offen lds
  s_add_u32 m0, s77, 0xc000
  s_nop 0
  buffer_load_dwordx4 v17, s[56:59], s65 offen lds
  s_add_u32 m0, s73, 0xc000
  s_nop 0
  buffer_load_dwordx4 v13, s[52:55], s64 offen lds
  s_add_u32 m0, s78, 0xc000
  s_nop 0
  buffer_load_dwordx4 v18, s[56:59], s65 offen lds
  s_add_u32 m0, s79, 0xc000
  s_nop 0
  buffer_load_dwordx4 v19, s[56:59], s65 offen lds
  s_sub_u32 s64, 0x3c0000, s4
  s_sub_u32 s65, 0x280, s5
  s_add_u32 m0, s68, 0x18000
  s_nop 0
  buffer_load_dwordx4 v8, s[52:55], s64 offen lds
  s_add_u32 m0, s69, 0x18000
  s_nop 0
  buffer_load_dwordx4 v9, s[52:55], s64 offen lds
  s_add_u32 m0, s74, 0x18000
  s_nop 0
  buffer_load_dwordx4 v14, s[56:59], s65 offen lds
  s_add_u32 m0, s70, 0x18000
  s_nop 0
  buffer_load_dwordx4 v10, s[52:55], s64 offen lds
  s_add_u32 m0, s75, 0x18000
  s_nop 0
  buffer_load_dwordx4 v15, s[56:59], s65 offen lds
  s_mov_b64 exec, s[24:25]
  buffer_load_dwordx4 v[44:47], v20, s[60:63], 0 offen offset:256 nt
  buffer_load_dwordx4 v[48:51], v20, s[60:63], 0 offen offset:3328 nt
  buffer_load_dwordx4 v[52:55], v20, s[60:63], s66 offen offset:256 nt
  s_mov_b64 exec, -1
  s_waitcnt vmcnt(8)
  s_barrier
  v_mul_u32_u24 v3, 0x500, v2
  v_add_u32 v3, v3, v100
  s_mul_i32 s42, s39, 5
  s_lshr_b32 s42, s42, 1
  s_add_u32 s42, s42, s48
  s_add_u32 s42, s42, 0
  s_cmp_ge_u32 s42, 20
  s_cselect_b32 s43, 20, 0
  s_sub_u32 s42, s42, s43
  s_lshl_b32 s98, s42, 10
  s_mul_i32 s43, s42, 0x3334
  s_lshr_b32 s43, s43, 16
  s_mul_i32 s44, s43, 5
  s_sub_u32 s42, s42, s44
  s_lshl_b32 s42, s42, 7
  s_mul_i32 s44, s43, 0x2800
  s_add_u32 s42, s42, s44
  v_add_u32 v102, s42, v3
  s_mul_i32 s42, s39, 5
  s_lshr_b32 s42, s42, 1
  s_add_u32 s42, s42, s48
  s_add_u32 s42, s42, 4
  s_cmp_ge_u32 s42, 20
  s_cselect_b32 s43, 20, 0
  s_sub_u32 s42, s42, s43
  s_lshl_b32 s99, s42, 10
  s_mul_i32 s43, s42, 0x3334
  s_lshr_b32 s43, s43, 16
  s_mul_i32 s44, s43, 5
  s_sub_u32 s42, s42, s44
  s_lshl_b32 s42, s42, 7
  s_mul_i32 s44, s43, 0x2800
  s_add_u32 s42, s42, s44
  v_add_u32 v103, s42, v3
  s_mul_i32 s42, s39, 5
  s_lshr_b32 s42, s42, 1
  s_add_u32 s42, s42, s48
  s_add_u32 s42, s42, 8
  s_cmp_ge_u32 s42, 20
  s_cselect_b32 s43, 20, 0
  s_sub_u32 s42, s42, s43
  s_lshl_b32 s100, s42, 10
  s_mul_i32 s43, s42, 0x3334
  s_lshr_b32 s43, s43, 16
  s_mul_i32 s44, s43, 5
  s_sub_u32 s42, s42, s44
  s_lshl_b32 s42, s42, 7
  s_mul_i32 s44, s43, 0x2800
  s_add_u32 s42, s42, s44
  v_add_u32 v104, s42, v3
  s_mul_i32 s42, s39, 5
  s_lshr_b32 s42, s42, 1
  s_add_u32 s42, s42, s48
  s_add_u32 s42, s42, 12
  s_cmp_ge_u32 s42, 20
  s_cselect_b32 s43, 20, 0
  s_sub_u32 s42, s42, s43
  s_lshl_b32 s101, s42, 10
  s_mul_i32 s43, s42, 0x3334
  s_lshr_b32 s43, s43, 16
  s_mul_i32 s44, s43, 5
  s_sub_u32 s42, s42, s44
  s_lshl_b32 s42, s42, 7
  s_mul_i32 s44, s43, 0x2800
  s_add_u32 s42, s42, s44
  v_add_u32 v105, s42, v3
  s_mul_i32 s42, s39, 5
  s_lshr_b32 s42, s42, 1
  s_add_u32 s42, s42, s48
  s_add_u32 s42, s42, 16
  s_cmp_ge_u32 s42, 20
  s_cselect_b32 s43, 20, 0
  s_sub_u32 s42, s42, s43
  s_lshl_b32 s3, s42, 10
  s_mul_i32 s43, s42, 0x3334
  s_lshr_b32 s43, s43, 16
  s_mul_i32 s44, s43, 5
  s_sub_u32 s42, s42, s44
  s_lshl_b32 s42, s42, 7
  s_mul_i32 s44, s43, 0x2800
  s_add_u32 s42, s42, s44
  v_add_u32 v106, s42, v3
  s_add_u32 m0, s71, 0x18000
  s_nop 0
  buffer_load_dwordx4 v11, s[52:55], s64 offen lds
  s_add_u32 m0, s76, 0x18000
  s_nop 0
  buffer_load_dwordx4 v16, s[56:59], s65 offen lds
  s_add_u32 m0, s72, 0x18000
  s_nop 0
  buffer_load_dwordx4 v12, s[52:55], s64 offen lds
  s_add_u32 m0, s77, 0x18000
  s_nop 0
  buffer_load_dwordx4 v17, s[56:59], s65 offen lds
  s_add_u32 m0, s73, 0x18000
  s_nop 0
  buffer_load_dwordx4 v13, s[52:55], s64 offen lds
  s_add_u32 m0, s78, 0x18000
  s_nop 0
  buffer_load_dwordx4 v18, s[56:59], s65 offen lds
  s_add_u32 m0, s79, 0x18000
  s_nop 0
  buffer_load_dwordx4 v19, s[56:59], s65 offen lds
  s_add_u32 s64, 0x480000, s4
  s_add_u32 s65, 0x300, s5
  s_add_u32 m0, s68, 0
  s_nop 0
  buffer_load_dwordx4 v8, s[52:55], s64 offen lds
  s_add_u32 m0, s69, 0
  s_nop 0
  buffer_load_dwordx4 v9, s[52:55], s64 offen lds
  s_add_u32 m0, s74, 0
  s_nop 0
  buffer_load_dwordx4 v14, s[56:59], s65 offen lds
  s_add_u32 m0, s70, 0
  s_nop 0
  buffer_load_dwordx4 v10, s[52:55], s64 offen lds
  s_add_u32 m0, s75, 0
  s_nop 0
  buffer_load_dwordx4 v15, s[56:59], s65 offen lds
  s_mov_b64 exec, s[14:15]
  buffer_load_dwordx4 v[44:47], v20, s[60:63], 0 offen offset:256 nt
  buffer_load_dwordx4 v[48:51], v20, s[60:63], 0 offen offset:3328 nt
  buffer_load_dwordx4 v[52:55], v20, s[60:63], s66 offen offset:256 nt
  s_mov_b64 exec, -1
  s_waitcnt vmcnt(8)
  s_barrier
  s_mov_b32 s88, s30
  s_mov_b32 s89, s31
  s_mov_b32 s90, 0x100
  s_mov_b32 s91, 0x20000
  buffer_load_dword v113, v112, s[88:91], 0 offen sc1
  v_lshlrev_b32 v111, 4, v1
  s_lshl_b32 s92, s48, 10
  v_add_u32 v111, s92, v111
  s_cmp_eq_u32 s34, 1
  s_cselect_b32 s46, s22, s12
  s_cselect_b32 s47, s23, s13
  s_lshl_b32 s42, s39, 6
  s_lshl_b32 s43, s38, 2
  s_add_u32 s42, s42, s43
  s_mul_i32 s42, s42, 0x4800
  s_add_u32 s84, s46, s42
  s_addc_u32 s85, s47, 0
  s_mov_b32 s86, 0xa2000
  s_mov_b32 s87, 0x20000
  s_cmp_eq_u32 s34, 1
  s_cselect_b32 s46, s26, s16
  s_cselect_b32 s47, s27, s17
  s_mul_i32 s42, s38, 0xf0000
  s_mul_i32 s43, s40, 0x280
  s_add_u32 s42, s42, s43
  s_add_u32 s80, s46, s42
  s_addc_u32 s81, s47, 0
  s_mov_b32 s82, 0
  s_mov_b32 s83, 0x20000
  s_sub_u32 s82, 0x780000, s42
  s_add_u32 m0, s71, 0
  s_nop 0
  buffer_load_dwordx4 v11, s[52:55], s64 offen lds
  s_add_u32 m0, s76, 0
  s_nop 0
  buffer_load_dwordx4 v16, s[56:59], s65 offen lds
  s_add_u32 m0, s72, 0
  s_nop 0
  buffer_load_dwordx4 v12, s[52:55], s64 offen lds
  s_add_u32 m0, s77, 0
  s_nop 0
  buffer_load_dwordx4 v17, s[56:59], s65 offen lds
  s_add_u32 m0, s73, 0
  s_nop 0
  buffer_load_dwordx4 v13, s[52:55], s64 offen lds
  s_add_u32 m0, s78, 0
  s_nop 0
  buffer_load_dwordx4 v18, s[56:59], s65 offen lds
  s_add_u32 m0, s79, 0
  s_nop 0
  buffer_load_dwordx4 v19, s[56:59], s65 offen lds
  s_sub_u32 s64, 0x540000, s4
  s_sub_u32 s65, 0x380, s5
  s_add_u32 m0, s68, 0xc000
  s_nop 0
  buffer_load_dwordx4 v8, s[52:55], s64 offen lds
  s_add_u32 m0, s69, 0xc000
  s_nop 0
  buffer_load_dwordx4 v9, s[52:55], s64 offen lds
  s_add_u32 m0, s74, 0xc000
  s_nop 0
  buffer_load_dwordx4 v14, s[56:59], s65 offen lds
  s_add_u32 m0, s70, 0xc000
  s_nop 0
  buffer_load_dwordx4 v10, s[52:55], s64 offen lds
  s_add_u32 m0, s75, 0xc000
  s_nop 0
  buffer_load_dwordx4 v15, s[56:59], s65 offen lds
  s_mov_b64 exec, s[24:25]
  buffer_load_dwordx4 v[56:59], v20, s[60:63], s66 offen offset:3328 nt
  buffer_load_dwordx4 v[60:63], v20, s[60:63], s67 offen offset:256 nt
  buffer_load_dwordx4 v[64:67], v20, s[60:63], s67 offen offset:3328 nt
  s_mov_b64 exec, -1
  s_waitcnt vmcnt(8)
  s_barrier
  v_cmp_gt_u32 vcc, 256, v113
  s_nop 4
  s_cbranch_vccz L_counted_4
  s_mov_b32 s93, 0x20000
  s_mov_b64 exec, 1
L_poll_5:
  buffer_load_dword v113, v112, s[88:91], 0 offen sc1
  s_sub_u32 s93, s93, 1
  s_cbranch_scc1 L_polled_6
  s_waitcnt vmcnt(0)
  v_cmp_gt_u32 vcc, 256, v113
  s_nop 4
  s_cbranch_vccnz L_poll_5
L_polled_6:
  s_waitcnt vmcnt(0)
  s_mov_b64 exec, -1
L_counted_4:
  s_add_u32 m0, s71, 0xc000
  s_nop 0
  buffer_load_dwordx4 v11, s[52:55], s64 offen lds
  s_add_u32 m0, s76, 0xc000
  s_nop 0
  buffer_load_dwordx4 v16, s[56:59], s65 offen lds
  s_add_u32 m0, s72, 0xc000
  s_nop 0
  buffer_load_dwordx4 v12, s[52:55], s64 offen lds
  s_add_u32 m0, s77, 0xc000
  s_nop 0
  buffer_load_dwordx4 v17, s[56:59], s65 offen lds
  s_add_u32 m0, s73, 0xc000
  s_nop 0
  buffer_load_dwordx4 v13, s[52:55], s64 offen lds
  s_add_u32 m0, s78, 0xc000
  s_nop 0
  buffer_load_dwordx4 v18, s[56:59], s65 offen lds
  s_add_u32 m0, s79, 0xc000
  s_nop 0
  buffer_load_dwordx4 v19, s[56:59], s65 offen lds
  s_add_u32 s64, 0x600000, s4
  s_add_u32 s65, 0x400, s5
  s_add_u32 m0, s68, 0x18000
  s_nop 0
  buffer_load_dwordx4 v8, s[52:55], s64 offen lds
  s_add_u32 m0, s69, 0x18000
  s_nop 0
  buffer_load_dwordx4 v9, s[52:55], s64 offen lds
  s_add_u32 m0, s74, 0x18000
  s_nop 0
  buffer_load_dwordx4 v14, s[56:59], s65 offen lds
  s_add_u32 m0, s70, 0x18000
  s_nop 0
  buffer_load_dwordx4 v10, s[52:55], s64 offen lds
  s_add_u32 m0, s75, 0x18000
  s_nop 0
  buffer_load_dwordx4 v15, s[56:59], s65 offen lds
  s_mov_b64 exec, s[14:15]
  buffer_load_dwordx4 v[56:59], v20, s[60:63], s66 offen offset:3328 nt
  buffer_load_dwordx4 v[60:63], v20, s[60:63], s67 offen offset:256 nt
  buffer_load_dwordx4 v[64:67], v20, s[60:63], s67 offen offset:3328 nt
  s_mov_b64 exec, -1
  s_waitcnt vmcnt(8)
  s_barrier
  s_add_u32 m0, s71, 0x18000
  s_nop 0
  buffer_load_dwordx4 v11, s[52:55], s64 offen lds
  s_add_u32 m0, s76, 0x18000
  s_nop 0
  buffer_load_dwordx4 v16, s[56:59], s65 offen lds
  s_add_u32 m0, s72, 0x18000
  s_nop 0
  buffer_load_dwordx4 v12, s[52:55], s64 offen lds
  s_add_u32 m0, s77, 0x18000
  s_nop 0
  buffer_load_dwordx4 v17, s[56:59], s65 offen lds
  s_add_u32 m0, s73, 0x18000
  s_nop 0
  buffer_load_dwordx4 v13, s[52:55], s64 offen lds
  s_add_u32 m0, s78, 0x18000
  s_nop 0
  buffer_load_dwordx4 v18, s[56:59], s65 offen lds
  s_add_u32 m0, s79, 0x18000
  s_nop 0
  buffer_load_dwordx4 v19, s[56:59], s65 offen lds
  s_sub_u32 s64, 0x6c0000, s6
  s_sub_u32 s65, 0x480, s7
  s_add_u32 m0, s68, 0
  s_nop 0
  buffer_load_dwordx4 v8, s[52:55], s64 offen lds
  s_add_u32 m0, s69, 0
  s_nop 0
  buffer_load_dwordx4 v9, s[52:55], s64 offen lds
  s_add_u32 m0, s74, 0
  s_nop 0
  buffer_load_dwordx4 v14, s[56:59], s65 offen lds
  s_add_u32 m0, s70, 0
  s_nop 0
  buffer_load_dwordx4 v10, s[52:55], s64 offen lds
  s_add_u32 m0, s75, 0
  s_nop 0
  buffer_load_dwordx4 v15, s[56:59], s65 offen lds
  s_add_u32 m0, s71, 0
  s_nop 0
  buffer_load_dwordx4 v11, s[52:55], s64 offen lds
  s_waitcnt vmcnt(6)
  s_barrier
  s_add_u32 m0, s76, 0
  s_nop 0
  buffer_load_dwordx4 v16, s[56:59], s65 offen lds
  s_add_u32 m0, s72, 0
  s_nop 0
  buffer_load_dwordx4 v12, s[52:55], s64 offen lds
  s_add_u32 m0, s77, 0
  s_nop 0
  buffer_load_dwordx4 v17, s[56:59], s65 offen lds
  s_add_u32 m0, s73, 0
  s_nop 0
  buffer_load_dwordx4 v13, s[52:55], s64 offen lds
  s_add_u32 m0, s78, 0
  s_nop 0
  buffer_load_dwordx4 v18, s[56:59], s65 offen lds
  s_add_u32 m0, s79, 0
  s_nop 0
  buffer_load_dwordx4 v19, s[56:59], s65 offen lds
  s_mul_i32 s42, s48, 0x1800
  s_add_u32 m0, s42, 0x12400
  s_mov_b32 s43, 0xc80
  buffer_load_dwordx4 v123, s[60:63], s43 offen nt lds
  s_mul_i32 s42, s48, 0x1800
  s_add_u32 m0, s42, 0x12000
  s_mov_b32 s43, 0x80
  buffer_load_dwordx4 v122, s[60:63], s43 offen nt lds
  s_mul_i32 s42, s48, 0x1800
  s_add_u32 m0, s42, 0xd400
  s_mov_b32 s43, 0x3c00
  buffer_load_dwordx4 v123, s[60:63], s43 offen nt lds
  s_mul_i32 s42, s48, 0x1800
  s_add_u32 m0, s42, 0xd000
  s_mov_b32 s43, 0x3000
  buffer_load_dwordx4 v122, s[60:63], s43 offen nt lds
  s_mul_i32 s42, s48, 0x1800
  s_add_u32 m0, s42, 0xcc00
  s_mov_b32 s43, 0x2400
  buffer_load_dwordx4 v123, s[60:63], s43 offen nt lds
  s_mul_i32 s42, s48, 0x1800
  s_add_u32 m0, s42, 0xc800
  s_mov_b32 s43, 0x1800
  buffer_load_dwordx4 v122, s[60:63], s43 offen nt lds
  s_mul_i32 s42, s48, 0x1800
  s_add_u32 m0, s42, 0xc400
  s_mov_b32 s43, 0xc00
  buffer_load_dwordx4 v123, s[60:63], s43 offen nt lds
  s_mul_i32 s42, s48, 0x1800
  s_add_u32 m0, s42, 0xc000
  s_mov_b32 s43, 0
  buffer_load_dwordx4 v122, s[60:63], s43 offen nt lds
  s_mov_b32 s50, 0
  s_add_u32 m0, s8, 0x25000
  s_nop 0
  buffer_load_dwordx4 v108, s[84:87], s50 offen lds
  s_add_u32 m0, s9, 0x25000
  s_nop 0
  buffer_load_dwordx4 v109, s[84:87], s50 offen lds
  s_add_u32 m0, s10, 0x25000
  s_nop 0
  buffer_load_dwordx4 v110, s[84:87], s50 offen lds
  ds_write_b128 v22, v[28:31] offset:29696
  ds_write_b128 v21, v[32:35] offset:28672
  ds_write_b128 v22, v[36:39] offset:27648
  ds_write_b128 v21, v[40:43] offset:26624
  s_waitcnt vmcnt(11)
  s_barrier
  s_mov_b32 s49, 0
  s_add_u32 m0, s98, 0x1e000
  s_nop 0
  buffer_load_dwordx4 v102, s[80:83], s49 offen lds
  s_add_u32 m0, s99, 0x1e000
  s_nop 0
  buffer_load_dwordx4 v103, s[80:83], s49 offen lds
  s_add_u32 m0, s100, 0x1e000
  s_nop 0
  buffer_load_dwordx4 v104, s[80:83], s49 offen lds
  s_add_u32 m0, s101, 0x1e000
  s_nop 0
  buffer_load_dwordx4 v105, s[80:83], s49 offen lds
  s_add_u32 m0, s3, 0x1e000
  s_nop 0
  buffer_load_dwordx4 v106, s[80:83], s49 offen lds
  ds_write_b128 v21, v[44:47] offset:49152
  ds_write_b128 v22, v[48:51] offset:50176
  ds_write_b128 v21, v[52:55] offset:51200
  ds_write_b128 v22, v[56:59] offset:52224
  ds_write_b128 v21, v[60:63] offset:53248
  ds_write_b128 v22, v[64:67] offset:54272
  s_waitcnt vmcnt(8)
  s_waitcnt lgkmcnt(0)
  s_barrier
  s_mov_b32 s26, 0xa000
  s_add_u32 m0, s98, 0
  s_nop 0
  buffer_load_dwordx4 v102, s[80:83], s26 offen lds
  s_add_u32 m0, s99, 0
  s_nop 0
  buffer_load_dwordx4 v103, s[80:83], s26 offen lds
  s_add_u32 m0, s100, 0
  s_nop 0
  buffer_load_dwordx4 v104, s[80:83], s26 offen lds
  s_add_u32 m0, s101, 0
  s_nop 0
  buffer_load_dwordx4 v105, s[80:83], s26 offen lds
  s_add_u32 m0, s3, 0
  s_nop 0
  buffer_load_dwordx4 v106, s[80:83], s26 offen lds
  s_mov_b32 s50, 0x80
  s_add_u32 m0, s8, 0x5000
  s_nop 0
  buffer_load_dwordx4 v108, s[84:87], s50 offen lds
  s_add_u32 m0, s9, 0x5000
  s_nop 0
  buffer_load_dwordx4 v109, s[84:87], s50 offen lds
  s_add_u32 m0, s10, 0x5000
  s_nop 0
  buffer_load_dwordx4 v110, s[84:87], s50 offen lds
  s_barrier
  s_mov_b32 s49, 0x14000
  s_add_u32 m0, s98, 0x8000
  s_nop 0
  buffer_load_dwordx4 v102, s[80:83], s49 offen lds
  s_add_u32 m0, s99, 0x8000
  s_nop 0
  buffer_load_dwordx4 v103, s[80:83], s49 offen lds
  s_add_u32 m0, s100, 0x8000
  s_nop 0
  buffer_load_dwordx4 v104, s[80:83], s49 offen lds
  s_add_u32 m0, s101, 0x8000
  s_nop 0
  buffer_load_dwordx4 v105, s[80:83], s49 offen lds
  s_add_u32 m0, s3, 0x8000
  s_nop 0
  buffer_load_dwordx4 v106, s[80:83], s49 offen lds
  s_mov_b32 s26, 0x1e000
  s_add_u32 m0, s98, 0xd000
  s_nop 0
  buffer_load_dwordx4 v102, s[80:83], s26 offen lds
  s_add_u32 m0, s99, 0xd000
  s_nop 0
  buffer_load_dwordx4 v103, s[80:83], s26 offen lds
  s_add_u32 m0, s100, 0xd000
  s_nop 0
  buffer_load_dwordx4 v104, s[80:83], s26 offen lds
  s_add_u32 m0, s101, 0xd000
  s_nop 0
  buffer_load_dwordx4 v105, s[80:83], s26 offen lds
  s_add_u32 m0, s3, 0xd000
  s_nop 0
  buffer_load_dwordx4 v106, s[80:83], s26 offen lds
  s_lshl_b32 s42, s34, 3
  s_add_u32 s42, s42, s39
  s_lshl_b32 s42, s42, 5
  s_lshl_b32 s43, s38, 2
  s_add_u32 s42, s42, s43
  s_mul_i32 s42, s42, 0x2400
  s_add_u32 s88, s32, s42
  s_addc_u32 s89, s33, 0
  s_mov_b32 s90, 0x9000
  s_mov_b32 s91, 0x20000
  s_lshl_b32 s42, s34, 2
  s_add_u32 s42, s42, s36
  s_lshl_b32 s42, s42, 3
  s_add_u32 s42, s42, s38
  s_lshl_b32 s42, s42, 8
  s_lshr_b32 s43, s41, 1
  s_lshl_b32 s43, s43, 7
  s_add_u32 s42, s42, s43
  s_add_u32 s42, s42, 0x2000000
  s_add_u32 s52, s32, s42
  s_addc_u32 s53, s33, 0
  s_mov_b32 s54, 32
  s_mov_b32 s55, 0x20000
  v_and_b32 v112, 7, v1
  v_lshlrev_b32 v112, 2, v112
  s_waitcnt vmcnt(18)
  s_barrier
  s_mov_b32 s50, 0x100
  s_add_u32 m0, s8, 0x17000
  s_nop 0
  buffer_load_dwordx4 v108, s[84:87], s50 offen lds
  s_add_u32 m0, s9, 0x17000
  s_nop 0
  buffer_load_dwordx4 v109, s[84:87], s50 offen lds
  s_add_u32 m0, s10, 0x17000
  s_nop 0
  buffer_load_dwordx4 v110, s[84:87], s50 offen lds
  s_mov_b32 s49, 0x28000
  s_add_u32 m0, s98, 0x12000
  s_nop 0
  buffer_load_dwordx4 v102, s[80:83], s49 offen lds
  s_add_u32 m0, s99, 0x12000
  s_nop 0
  buffer_load_dwordx4 v103, s[80:83], s49 offen lds
  s_add_u32 m0, s100, 0x12000
  s_nop 0
  buffer_load_dwordx4 v104, s[80:83], s49 offen lds
  s_add_u32 m0, s101, 0x12000
  s_nop 0
  buffer_load_dwordx4 v105, s[80:83], s49 offen lds
  s_add_u32 m0, s3, 0x12000
  s_nop 0
  buffer_load_dwordx4 v106, s[80:83], s49 offen lds
  s_waitcnt vmcnt(18)
  s_barrier
  s_waitcnt vmcnt(13)
  s_barrier
  s_mov_b32 s26, 0x32000
  s_add_u32 m0, s98, 0x1e000
  s_nop 0
  buffer_load_dwordx4 v102, s[80:83], s26 offen lds
  s_add_u32 m0, s99, 0x1e000
  s_nop 0
  buffer_load_dwordx4 v103, s[80:83], s26 offen lds
  s_add_u32 m0, s100, 0x1e000
  s_nop 0
  buffer_load_dwordx4 v104, s[80:83], s26 offen lds
  s_add_u32 m0, s101, 0x1e000
  s_nop 0
  buffer_load_dwordx4 v105, s[80:83], s26 offen lds
  s_add_u32 m0, s3, 0x1e000
  s_nop 0
  buffer_load_dwordx4 v106, s[80:83], s26 offen lds
  s_mov_b32 s50, 0x4800
  s_add_u32 m0, s8, 0x25000
  s_nop 0
  buffer_load_dwordx4 v108, s[84:87], s50 offen lds
  s_add_u32 m0, s9, 0x25000
  s_nop 0
  buffer_load_dwordx4 v109, s[84:87], s50 offen lds
  s_add_u32 m0, s10, 0x25000
  s_nop 0
  buffer_load_dwordx4 v110, s[84:87], s50 offen lds
  s_waitcnt vmcnt(13)
  s_barrier
  buffer_load_dword v113, v112, s[52:55], 0 offen sc1
  s_mov_b32 s49, 0x3c000
  s_add_u32 m0, s98, 0
  s_nop 0
  buffer_load_dwordx4 v102, s[80:83], s49 offen lds
  s_add_u32 m0, s99, 0
  s_nop 0
  buffer_load_dwordx4 v103, s[80:83], s49 offen lds
  s_add_u32 m0, s100, 0
  s_nop 0
  buffer_load_dwordx4 v104, s[80:83], s49 offen lds
  s_add_u32 m0, s101, 0
  s_nop 0
  buffer_load_dwordx4 v105, s[80:83], s49 offen lds
  s_add_u32 m0, s3, 0
  s_nop 0
  buffer_load_dwordx4 v106, s[80:83], s49 offen lds
  s_waitcnt vmcnt(14)
  s_barrier
  s_waitcnt vmcnt(5)
  v_cmp_ne_u32 vcc, 1, v113
  s_nop 4
  s_cbranch_vccz L_seen_7
  s_mov_b32 s93, 0x20000
  s_mov_b64 exec, 255
L_poll_8:
  buffer_load_dword v113, v112, s[52:55], 0 offen sc1
  s_sub_u32 s93, s93, 1
  s_cbranch_scc1 L_polled_9
  s_waitcnt vmcnt(0)
  v_cmp_ne_u32 vcc, 1, v113
  s_nop 4
  s_cbranch_vccnz L_poll_8
L_polled_9:
  s_waitcnt vmcnt(0)
  s_mov_b64 exec, -1
L_seen_7:
  s_cmp_lg_u32 s48, 0
  s_cbranch_scc1 L_pskip_10
  s_mov_b32 s51, 0x2000
  s_add_u32 m0, s92, 0x1c000
  s_nop 0
  buffer_load_dwordx4 v111, s[88:91], s51 offen sc1 lds
L_pskip_10:
  s_mov_b32 s51, 0
  s_add_u32 m0, s92, 0x1a000
  s_nop 0
  buffer_load_dwordx4 v111, s[88:91], s51 offen sc1 lds
  s_mov_b32 s51, 0x1000
  s_add_u32 m0, s92, 0x1b000
  s_nop 0
  buffer_load_dwordx4 v111, s[88:91], s51 offen sc1 lds
  s_cmp_lg_u32 s48, 0
  s_cbranch_scc1 L_pskip_11
  s_mov_b32 s51, 0x4400
  s_add_u32 m0, s92, 0x1c400
  s_nop 0
  buffer_load_dwordx4 v111, s[88:91], s51 offen sc1 lds
L_pskip_11:
  s_mov_b32 s51, 0x2400
  s_add_u32 m0, s92, 0x23000
  s_nop 0
  buffer_load_dwordx4 v111, s[88:91], s51 offen sc1 lds
  s_mov_b32 s51, 0x3400
  s_add_u32 m0, s92, 0x24000
  s_nop 0
  buffer_load_dwordx4 v111, s[88:91], s51 offen sc1 lds
  s_barrier
  s_mov_b32 s26, 0x46000
  s_add_u32 m0, s98, 0x8000
  s_nop 0
  buffer_load_dwordx4 v102, s[80:83], s26 offen lds
  s_add_u32 m0, s99, 0x8000
  s_nop 0
  buffer_load_dwordx4 v103, s[80:83], s26 offen lds
  s_add_u32 m0, s100, 0x8000
  s_nop 0
  buffer_load_dwordx4 v104, s[80:83], s26 offen lds
  s_add_u32 m0, s101, 0x8000
  s_nop 0
  buffer_load_dwordx4 v105, s[80:83], s26 offen lds
  s_add_u32 m0, s3, 0x8000
  s_nop 0
  buffer_load_dwordx4 v106, s[80:83], s26 offen lds
  s_mov_b32 s50, 0x4880
  s_add_u32 m0, s8, 0x5000
  s_nop 0
  buffer_load_dwordx4 v108, s[84:87], s50 offen lds
  s_add_u32 m0, s9, 0x5000
  s_nop 0
  buffer_load_dwordx4 v109, s[84:87], s50 offen lds
  s_add_u32 m0, s10, 0x5000
  s_nop 0
  buffer_load_dwordx4 v110, s[84:87], s50 offen lds
  s_waitcnt vmcnt(8)
  s_barrier
  s_mov_b32 s49, 0x50000
  s_add_u32 m0, s98, 0xd000
  s_nop 0
  buffer_load_dwordx4 v102, s[80:83], s49 offen lds
  s_add_u32 m0, s99, 0xd000
  s_nop 0
  buffer_load_dwordx4 v103, s[80:83], s49 offen lds
  s_add_u32 m0, s100, 0xd000
  s_nop 0
  buffer_load_dwordx4 v104, s[80:83], s49 offen lds
  s_add_u32 m0, s101, 0xd000
  s_nop 0
  buffer_load_dwordx4 v105, s[80:83], s49 offen lds
  s_add_u32 m0, s3, 0xd000
  s_nop 0
  buffer_load_dwordx4 v106, s[80:83], s49 offen lds
  s_mov_b32 s26, 0x5a000
  s_add_u32 m0, s98, 0x12000
  s_nop 0
  buffer_load_dwordx4 v102, s[80:83], s26 offen lds
  s_add_u32 m0, s99, 0x12000
  s_nop 0
  buffer_load_dwordx4 v103, s[80:83], s26 offen lds
  s_add_u32 m0, s100, 0x12000
  s_nop 0
  buffer_load_dwordx4 v104, s[80:83], s26 offen lds
  s_add_u32 m0, s101, 0x12000
  s_nop 0
  buffer_load_dwordx4 v105, s[80:83], s26 offen lds
  s_add_u32 m0, s3, 0x12000
  s_nop 0
  buffer_load_dwordx4 v106, s[80:83], s26 offen lds
  s_mov_b32 s50, 0x4900
  s_add_u32 m0, s8, 0x17000
  s_nop 0
  buffer_load_dwordx4 v108, s[84:87], s50 offen lds
  s_add_u32 m0, s9, 0x17000
  s_nop 0
  buffer_load_dwordx4 v109, s[84:87], s50 offen lds
  s_add_u32 m0, s10, 0x17000
  s_nop 0
  buffer_load_dwordx4 v110, s[84:87], s50 offen lds
  s_waitcnt vmcnt(13)
  s_barrier
  s_cmp_lg_u32 s48, 0
  s_cbranch_scc1 L_pskip_12
  s_mov_b32 s51, 0x6800
  s_add_u32 m0, s92, 0x1c000
  s_nop 0
  buffer_load_dwordx4 v111, s[88:91], s51 offen sc1 lds
L_pskip_12:
  s_mov_b32 s51, 0x4800
  s_add_u32 m0, s92, 0x1a000
  s_nop 0
  buffer_load_dwordx4 v111, s[88:91], s51 offen sc1 lds
  s_mov_b32 s51, 0x5800
  s_add_u32 m0, s92, 0x1b000
  s_nop 0
  buffer_load_dwordx4 v111, s[88:91], s51 offen sc1 lds
  s_mov_b32 s50, 0x9000
  s_add_u32 m0, s8, 0x25000
  s_nop 0
  buffer_load_dwordx4 v108, s[84:87], s50 offen lds
  s_add_u32 m0, s9, 0x25000
  s_nop 0
  buffer_load_dwordx4 v109, s[84:87], s50 offen lds
  s_add_u32 m0, s10, 0x25000
  s_nop 0
  buffer_load_dwordx4 v110, s[84:87], s50 offen lds
  s_mov_b32 s49, 0x64000
  s_add_u32 m0, s98, 0x1e000
  s_nop 0
  buffer_load_dwordx4 v102, s[80:83], s49 offen lds
  s_add_u32 m0, s99, 0x1e000
  s_nop 0
  buffer_load_dwordx4 v103, s[80:83], s49 offen lds
  s_mov_b32 s26, 0x6e000
  s_add_u32 m0, s98, 0
  s_nop 0
  buffer_load_dwordx4 v102, s[80:83], s26 offen lds
  s_add_u32 m0, s99, 0
  s_nop 0
  buffer_load_dwordx4 v103, s[80:83], s26 offen lds
  s_waitcnt vmcnt(17)
  s_barrier
  s_add_u32 m0, s100, 0x1e000
  s_nop 0
  buffer_load_dwordx4 v104, s[80:83], s49 offen lds
  s_add_u32 m0, s101, 0x1e000
  s_nop 0
  buffer_load_dwordx4 v105, s[80:83], s49 offen lds
  s_add_u32 m0, s3, 0x1e000
  s_nop 0
  buffer_load_dwordx4 v106, s[80:83], s49 offen lds
  s_add_u32 m0, s100, 0
  s_nop 0
  buffer_load_dwordx4 v104, s[80:83], s26 offen lds
  s_add_u32 m0, s101, 0
  s_nop 0
  buffer_load_dwordx4 v105, s[80:83], s26 offen lds
  s_add_u32 m0, s3, 0
  s_nop 0
  buffer_load_dwordx4 v106, s[80:83], s26 offen lds
  s_waitcnt vmcnt(15)
  s_barrier
  s_mov_b32 s50, 0x9080
  s_add_u32 m0, s8, 0x5000
  s_nop 0
  buffer_load_dwordx4 v108, s[84:87], s50 offen lds
  s_add_u32 m0, s9, 0x5000
  s_nop 0
  buffer_load_dwordx4 v109, s[84:87], s50 offen lds
  s_add_u32 m0, s10, 0x5000
  s_nop 0
  buffer_load_dwordx4 v110, s[84:87], s50 offen lds
  s_mov_b32 s49, 0x78000
  s_add_u32 m0, s98, 0x8000
  s_nop 0
  buffer_load_dwordx4 v102, s[80:83], s49 offen lds
  s_add_u32 m0, s99, 0x8000
  s_nop 0
  buffer_load_dwordx4 v103, s[80:83], s49 offen lds
  s_mov_b32 s26, 0x82000
  s_add_u32 m0, s98, 0xd000
  s_nop 0
  buffer_load_dwordx4 v102, s[80:83], s26 offen lds
  s_add_u32 m0, s99, 0xd000
  s_nop 0
  buffer_load_dwordx4 v103, s[80:83], s26 offen lds
  s_add_u32 m0, s100, 0x8000
  s_nop 0
  buffer_load_dwordx4 v104, s[80:83], s49 offen lds
  s_add_u32 m0, s101, 0x8000
  s_nop 0
  buffer_load_dwordx4 v105, s[80:83], s49 offen lds
  s_add_u32 m0, s3, 0x8000
  s_nop 0
  buffer_load_dwordx4 v106, s[80:83], s49 offen lds
  s_waitcnt vmcnt(13)
  s_barrier
  s_add_u32 m0, s100, 0xd000
  s_nop 0
  buffer_load_dwordx4 v104, s[80:83], s26 offen lds
  s_add_u32 m0, s101, 0xd000
  s_nop 0
  buffer_load_dwordx4 v105, s[80:83], s26 offen lds
  s_add_u32 m0, s3, 0xd000
  s_nop 0
  buffer_load_dwordx4 v106, s[80:83], s26 offen lds
  s_waitcnt vmcnt(13)
  s_barrier
  s_cmp_lg_u32 s48, 0
  s_cbranch_scc1 L_pskip_13
  s_mov_b32 s51, 0x8c00
  s_add_u32 m0, s92, 0x1c400
  s_nop 0
  buffer_load_dwordx4 v111, s[88:91], s51 offen sc1 lds
L_pskip_13:
  s_mov_b32 s51, 0x6c00
  s_add_u32 m0, s92, 0x23000
  s_nop 0
  buffer_load_dwordx4 v111, s[88:91], s51 offen sc1 lds
  s_mov_b32 s51, 0x7c00
  s_add_u32 m0, s92, 0x24000
  s_nop 0
  buffer_load_dwordx4 v111, s[88:91], s51 offen sc1 lds
  s_mov_b32 s50, 0x9100
  s_add_u32 m0, s8, 0x17000
  s_nop 0
  buffer_load_dwordx4 v108, s[84:87], s50 offen lds
  s_add_u32 m0, s9, 0x17000
  s_nop 0
  buffer_load_dwordx4 v109, s[84:87], s50 offen lds
  s_add_u32 m0, s10, 0x17000
  s_nop 0
  buffer_load_dwordx4 v110, s[84:87], s50 offen lds
  s_mov_b32 s49, 0x8c000
  s_add_u32 m0, s98, 0x12000
  s_nop 0
  buffer_load_dwordx4 v102, s[80:83], s49 offen lds
  s_add_u32 m0, s99, 0x12000
  s_nop 0
  buffer_load_dwordx4 v103, s[80:83], s49 offen lds
  s_mov_b32 s26, 0x96000
  s_add_u32 m0, s98, 0x1e000
  s_nop 0
  buffer_load_dwordx4 v102, s[80:83], s26 offen lds
  s_add_u32 m0, s99, 0x1e000
  s_nop 0
  buffer_load_dwordx4 v103, s[80:83], s26 offen lds
  s_waitcnt vmcnt(12)
  s_barrier
  s_add_u32 m0, s100, 0x12000
  s_nop 0
  buffer_load_dwordx4 v104, s[80:83], s49 offen lds
  s_add_u32 m0, s101, 0x12000
  s_nop 0
  buffer_load_dwordx4 v105, s[80:83], s49 offen lds
  s_add_u32 m0, s3, 0x12000
  s_nop 0
  buffer_load_dwordx4 v106, s[80:83], s49 offen lds
  s_add_u32 m0, s100, 0x1e000
  s_nop 0
  buffer_load_dwordx4 v104, s[80:83], s26 offen lds
  s_add_u32 m0, s101, 0x1e000
  s_nop 0
  buffer_load_dwordx4 v105, s[80:83], s26 offen lds
  s_add_u32 m0, s3, 0x1e000
  s_nop 0
  buffer_load_dwordx4 v106, s[80:83], s26 offen lds
  s_waitcnt vmcnt(15)
  s_barrier
  s_mov_b32 s50, 0xd800
  s_add_u32 m0, s8, 0x25000
  s_nop 0
  buffer_load_dwordx4 v108, s[84:87], s50 offen lds
  s_add_u32 m0, s9, 0x25000
  s_nop 0
  buffer_load_dwordx4 v109, s[84:87], s50 offen lds
  s_add_u32 m0, s10, 0x25000
  s_nop 0
  buffer_load_dwordx4 v110, s[84:87], s50 offen lds
  s_mov_b32 s49, 0xa0000
  s_add_u32 m0, s98, 0
  s_nop 0
  buffer_load_dwordx4 v102, s[80:83], s49 offen lds
  s_add_u32 m0, s99, 0
  s_nop 0
  buffer_load_dwordx4 v103, s[80:83], s49 offen lds
  s_mov_b32 s26, 0xaa000
  s_add_u32 m0, s98, 0x8000
  s_nop 0
  buffer_load_dwordx4 v102, s[80:83], s26 offen lds
  s_add_u32 m0, s99, 0x8000
  s_nop 0
  buffer_load_dwordx4 v103, s[80:83], s26 offen lds
  s_add_u32 m0, s100, 0
  s_nop 0
  buffer_load_dwordx4 v104, s[80:83], s49 offen lds
  s_add_u32 m0, s101, 0
  s_nop 0
  buffer_load_dwordx4 v105, s[80:83], s49 offen lds
  s_add_u32 m0, s3, 0
  s_nop 0
  buffer_load_dwordx4 v106, s[80:83], s49 offen lds
  s_waitcnt vmcnt(13)
  s_barrier
  s_add_u32 m0, s100, 0x8000
  s_nop 0
  buffer_load_dwordx4 v104, s[80:83], s26 offen lds
  s_add_u32 m0, s101, 0x8000
  s_nop 0
  buffer_load_dwordx4 v105, s[80:83], s26 offen lds
  s_add_u32 m0, s3, 0x8000
  s_nop 0
  buffer_load_dwordx4 v106, s[80:83], s26 offen lds
  s_waitcnt vmcnt(13)
  s_barrier
  s_mov_b32 s50, 0xd880
  s_add_u32 m0, s8, 0x5000
  s_nop 0
  buffer_load_dwordx4 v108, s[84:87], s50 offen lds
  s_add_u32 m0, s9, 0x5000
  s_nop 0
  buffer_load_dwordx4 v109, s[84:87], s50 offen lds
  s_add_u32 m0, s10, 0x5000
  s_nop 0
  buffer_load_dwordx4 v110, s[84:87], s50 offen lds
  s_mov_b32 s49, 0xb4000
  s_add_u32 m0, s98, 0xd000
  s_nop 0
  buffer_load_dwordx4 v102, s[80:83], s49 offen lds
  s_add_u32 m0, s99, 0xd000
  s_nop 0
  buffer_load_dwordx4 v103, s[80:83], s49 offen lds
  s_mov_b32 s26, 0xbe000
  s_add_u32 m0, s98, 0x12000
  s_nop 0
  buffer_load_dwordx4 v102, s[80:83], s26 offen lds
  s_add_u32 m0, s99, 0x12000
  s_nop 0
  buffer_load_dwordx4 v103, s[80:83], s26 offen lds
  s_add_u32 m0, s100, 0xd000
  s_nop 0
  buffer_load_dwordx4 v104, s[80:83], s49 offen lds
  s_add_u32 m0, s101, 0xd000
  s_nop 0
  buffer_load_dwordx4 v105, s[80:83], s49 offen lds
  s_add_u32 m0, s3, 0xd000
  s_nop 0
  buffer_load_dwordx4 v106, s[80:83], s49 offen lds
  s_waitcnt vmcnt(13)
  s_barrier
  s_add_u32 m0, s100, 0x12000
  s_nop 0
  buffer_load_dwordx4 v104, s[80:83], s26 offen lds
  s_add_u32 m0, s101, 0x12000
  s_nop 0
  buffer_load_dwordx4 v105, s[80:83], s26 offen lds
  s_add_u32 m0, s3, 0x12000
  s_nop 0
  buffer_load_dwordx4 v106, s[80:83], s26 offen lds
  s_waitcnt vmcnt(13)
  s_barrier
  s_mov_b32 s50, 0xd900
  s_add_u32 m0, s8, 0x17000
  s_nop 0
  buffer_load_dwordx4 v108, s[84:87], s50 offen lds
  s_add_u32 m0, s9, 0x17000
  s_nop 0
  buffer_load_dwordx4 v109, s[84:87], s50 offen lds
  s_add_u32 m0, s10, 0x17000
  s_nop 0
  buffer_load_dwordx4 v110, s[84:87], s50 offen lds
  s_mov_b32 s49, 0xc8000
  s_add_u32 m0, s98, 0x1e000
  s_nop 0
  buffer_load_dwordx4 v102, s[80:83], s49 offen lds
  s_add_u32 m0, s99, 0x1e000
  s_nop 0
  buffer_load_dwordx4 v103, s[80:83], s49 offen lds
  s_mov_b32 s26, 0xd2000
  s_add_u32 m0, s98, 0
  s_nop 0
  buffer_load_dwordx4 v102, s[80:83], s26 offen lds
  s_add_u32 m0, s99, 0
  s_nop 0
  buffer_load_dwordx4 v103, s[80:83], s26 offen lds
  s_add_u32 m0, s100, 0x1e000
  s_nop 0
  buffer_load_dwordx4 v104, s[80:83], s49 offen lds
  s_add_u32 m0, s101, 0x1e000
  s_nop 0
  buffer_load_dwordx4 v105, s[80:83], s49 offen lds
  s_add_u32 m0, s3, 0x1e000
  s_nop 0
  buffer_load_dwordx4 v106, s[80:83], s49 offen lds
  s_waitcnt vmcnt(13)
  s_barrier
  s_add_u32 m0, s100, 0
  s_nop 0
  buffer_load_dwordx4 v104, s[80:83], s26 offen lds
  s_add_u32 m0, s101, 0
  s_nop 0
  buffer_load_dwordx4 v105, s[80:83], s26 offen lds
  s_add_u32 m0, s3, 0
  s_nop 0
  buffer_load_dwordx4 v106, s[80:83], s26 offen lds
  s_waitcnt vmcnt(13)
  s_barrier
  s_mov_b32 s49, 0xdc000
  s_add_u32 m0, s98, 0x8000
  s_nop 0
  buffer_load_dwordx4 v102, s[80:83], s49 offen lds
  s_add_u32 m0, s99, 0x8000
  s_nop 0
  buffer_load_dwordx4 v103, s[80:83], s49 offen lds
  s_mov_b32 s26, 0xe6000
  s_add_u32 m0, s98, 0xd000
  s_nop 0
  buffer_load_dwordx4 v102, s[80:83], s26 offen lds
  s_add_u32 m0, s99, 0xd000
  s_nop 0
  buffer_load_dwordx4 v103, s[80:83], s26 offen lds
  s_add_u32 m0, s100, 0x8000
  s_nop 0
  buffer_load_dwordx4 v104, s[80:83], s49 offen lds
  s_add_u32 m0, s101, 0x8000
  s_nop 0
  buffer_load_dwordx4 v105, s[80:83], s49 offen lds
  s_add_u32 m0, s3, 0x8000
  s_nop 0
  buffer_load_dwordx4 v106, s[80:83], s49 offen lds
  s_add_u32 m0, s100, 0xd000
  s_nop 0
  buffer_load_dwordx4 v104, s[80:83], s26 offen lds
  s_add_u32 m0, s101, 0xd000
  s_nop 0
  buffer_load_dwordx4 v105, s[80:83], s26 offen lds
  s_add_u32 m0, s3, 0xd000
  s_nop 0
  buffer_load_dwordx4 v106, s[80:83], s26 offen lds
  s_waitcnt vmcnt(13)
  s_barrier
  s_waitcnt vmcnt(10)
  s_barrier
  s_waitcnt vmcnt(0)
  s_barrier
  s_lshl_b32 s44, s34, 3
  s_add_u32 s44, s44, s39
  s_lshl_b32 s44, s44, 1
  s_add_u32 s44, s44, s40
  s_and_b32 s80, s37, 3
  s_lshl_b32 s42, s80, 1
  s_sub_u32 s76, s38, s42
  s_and_b32 s76, s76, 7
  s_mul_i32 s43, s76, 0x5556
  s_lshr_b32 s43, s43, 16
  s_mul_i32 s45, s43, 3
  s_sub_u32 s42, s76, s45
  s_add_u32 s45, s38, 1
  s_and_b32 s45, s45, 7
  s_lshl_b32 s8, s45, 10
  s_add_u32 s45, s38, 2
  s_and_b32 s45, s45, 7
  s_lshl_b32 s9, s45, 10
  s_add_u32 s45, s38, 3
  s_and_b32 s45, s45, 7
  s_lshl_b32 s10, s45, 10
  s_add_u32 s45, s38, 4
  s_and_b32 s45, s45, 7
  s_lshl_b32 s11, s45, 10
  s_add_u32 s45, s38, 5
  s_and_b32 s45, s45, 7
  s_lshl_b32 s12, s45, 10
  s_add_u32 s45, s38, 6
  s_and_b32 s45, s45, 7
  s_lshl_b32 s13, s45, 10
  s_add_u32 s45, s38, 7
  s_and_b32 s45, s45, 7
  s_lshl_b32 s14, s45, 10
  s_lshl_b32 s45, s80, 10
  s_add_u32 s45, s45, 0x1a000
  v_lshlrev_b32 v33, 4, v1
  v_add_u32 v33, s45, v33
  s_lshl_b32 s81, s44, 2
  s_add_u32 s81, s81, s80
  s_lshl_b32 s82, s81, 7
  s_add_u32 s82, s82, 0x2004000
  s_add_u32 s72, s32, s82
  s_addc_u32 s73, s33, 0
  s_mov_b32 s74, 32
  s_mov_b32 s75, 0x20000
  s_mul_i32 s81, s81, 15
  s_mul_i32 s45, s43, 3
  s_add_u32 s81, s81, s45
  s_add_u32 s81, s81, s42
  s_lshl_b32 s81, s81, 13
  s_add_u32 s81, s81, 0x800000
  s_add_u32 s64, s32, s81
  s_addc_u32 s65, s33, 0
  s_mov_b32 s66, 0x2000
  s_mov_b32 s67, 0x20000
  s_lshl_b32 s81, s42, 4
  s_lshl_b32 s82, s43, 7
  s_and_b32 s42, s80, 1
  s_lshl_b32 s43, s39, 1
  s_add_u32 s42, s42, s43
  s_mul_i32 s42, s42, 48
  s_add_u32 s81, s81, s42
  s_lshr_b32 s42, s80, 1
  s_lshl_b32 s42, s42, 6
  s_add_u32 s82, s82, s42
  s_mul_i32 s42, s40, 0x280
  s_add_u32 s82, s82, s42
  s_mul_i32 s42, s34, 0x500
  s_add_u32 s82, s82, s42
  s_mul_i32 s81, s81, 0xa00
  s_add_u32 s81, s81, s82
  s_add_u32 s84, s28, s81
  s_addc_u32 s85, s29, 0
  s_mov_b32 s86, 0x9640
  s_mov_b32 s87, 0x20000
  s_mov_b32 s77, 0xffff0000
  s_mov_b32 s79, 0x1000
  v_lshlrev_b32 v28, 4, v1
  v_lshlrev_b32 v30, 2, v1
  v_and_b32 v31, 15, v1
  v_mul_u32_u24 v29, 0xa00, v31
  v_bfe_u32 v31, v1, 4, 1
  v_lshl_add_u32 v29, v31, 5, v29
  v_lshrrev_b32 v31, 5, v1
  v_lshl_add_u32 v29, v31, 4, v29
  s_barrier
  s_cmp_ge_u32 s76, 15
  s_cbranch_scc1 L_nored_14
  s_mov_b32 s78, 0x20000
  s_mov_b64 exec, 255
L_poll_15:
  buffer_load_dword v31, v30, s[72:75], 0 offen sc1
  s_sub_u32 s78, s78, 1
  s_cbranch_scc1 L_polled_16
  s_waitcnt vmcnt(0)
  v_cmp_ne_u32 vcc, 1, v31
  s_nop 4
  s_cbranch_vccnz L_poll_15
L_polled_16:
  s_waitcnt vmcnt(0)
  s_mov_b64 exec, -1
  ds_read_b128 v[44:47], v33
  buffer_load_dwordx4 v[48:51], v28, s[64:67], s8 offen sc1
  buffer_load_dwordx4 v[52:55], v28, s[64:67], s9 offen sc1
  buffer_load_dwordx4 v[56:59], v28, s[64:67], s10 offen sc1
  buffer_load_dwordx4 v[60:63], v28, s[64:67], s11 offen sc1
  buffer_load_dwordx4 v[64:67], v28, s[64:67], s12 offen sc1
  buffer_load_dwordx4 v[68:71], v28, s[64:67], s13 offen sc1
  buffer_load_dwordx4 v[72:75], v28, s[64:67], s14 offen sc1
  s_waitcnt lgkmcnt(0)
  v_lshlrev_b32 v36, 16, v44
  v_and_b32 v37, s77, v44
  v_lshlrev_b32 v38, 16, v45
  v_and_b32 v39, s77, v45
  v_lshlrev_b32 v40, 16, v46
  v_and_b32 v41, s77, v46
  v_lshlrev_b32 v42, 16, v47
  v_and_b32 v43, s77, v47
  s_waitcnt vmcnt(6)
  v_lshlrev_b32 v31, 16, v48
  v_and_b32 v32, s77, v48
  v_add_f32 v36, v36, v31
  v_add_f32 v37, v37, v32
  v_lshlrev_b32 v31, 16, v49
  v_and_b32 v32, s77, v49
  v_add_f32 v38, v38, v31
  v_add_f32 v39, v39, v32
  v_lshlrev_b32 v31, 16, v50
  v_and_b32 v32, s77, v50
  v_add_f32 v40, v40, v31
  v_add_f32 v41, v41, v32
  v_lshlrev_b32 v31, 16, v51
  v_and_b32 v32, s77, v51
  v_add_f32 v42, v42, v31
  v_add_f32 v43, v43, v32
  s_waitcnt vmcnt(5)
  v_lshlrev_b32 v31, 16, v52
  v_and_b32 v32, s77, v52
  v_add_f32 v36, v36, v31
  v_add_f32 v37, v37, v32
  v_lshlrev_b32 v31, 16, v53
  v_and_b32 v32, s77, v53
  v_add_f32 v38, v38, v31
  v_add_f32 v39, v39, v32
  v_lshlrev_b32 v31, 16, v54
  v_and_b32 v32, s77, v54
  v_add_f32 v40, v40, v31
  v_add_f32 v41, v41, v32
  v_lshlrev_b32 v31, 16, v55
  v_and_b32 v32, s77, v55
  v_add_f32 v42, v42, v31
  v_add_f32 v43, v43, v32
  s_waitcnt vmcnt(4)
  v_lshlrev_b32 v31, 16, v56
  v_and_b32 v32, s77, v56
  v_add_f32 v36, v36, v31
  v_add_f32 v37, v37, v32
  v_lshlrev_b32 v31, 16, v57
  v_and_b32 v32, s77, v57
  v_add_f32 v38, v38, v31
  v_add_f32 v39, v39, v32
  v_lshlrev_b32 v31, 16, v58
  v_and_b32 v32, s77, v58
  v_add_f32 v40, v40, v31
  v_add_f32 v41, v41, v32
  v_lshlrev_b32 v31, 16, v59
  v_and_b32 v32, s77, v59
  v_add_f32 v42, v42, v31
  v_add_f32 v43, v43, v32
  s_waitcnt vmcnt(3)
  v_lshlrev_b32 v31, 16, v60
  v_and_b32 v32, s77, v60
  v_add_f32 v36, v36, v31
  v_add_f32 v37, v37, v32
  v_lshlrev_b32 v31, 16, v61
  v_and_b32 v32, s77, v61
  v_add_f32 v38, v38, v31
  v_add_f32 v39, v39, v32
  v_lshlrev_b32 v31, 16, v62
  v_and_b32 v32, s77, v62
  v_add_f32 v40, v40, v31
  v_add_f32 v41, v41, v32
  v_lshlrev_b32 v31, 16, v63
  v_and_b32 v32, s77, v63
  v_add_f32 v42, v42, v31
  v_add_f32 v43, v43, v32
  s_waitcnt vmcnt(2)
  v_lshlrev_b32 v31, 16, v64
  v_and_b32 v32, s77, v64
  v_add_f32 v36, v36, v31
  v_add_f32 v37, v37, v32
  v_lshlrev_b32 v31, 16, v65
  v_and_b32 v32, s77, v65
  v_add_f32 v38, v38, v31
  v_add_f32 v39, v39, v32
  v_lshlrev_b32 v31, 16, v66
  v_and_b32 v32, s77, v66
  v_add_f32 v40, v40, v31
  v_add_f32 v41, v41, v32
  v_lshlrev_b32 v31, 16, v67
  v_and_b32 v32, s77, v67
  v_add_f32 v42, v42, v31
  v_add_f32 v43, v43, v32
  s_waitcnt vmcnt(1)
  v_lshlrev_b32 v31, 16, v68
  v_and_b32 v32, s77, v68
  v_add_f32 v36, v36, v31
  v_add_f32 v37, v37, v32
  v_lshlrev_b32 v31, 16, v69
  v_and_b32 v32, s77, v69
  v_add_f32 v38, v38, v31
  v_add_f32 v39, v39, v32
  v_lshlrev_b32 v31, 16, v70
  v_and_b32 v32, s77, v70
  v_add_f32 v40, v40, v31
  v_add_f32 v41, v41, v32
  v_lshlrev_b32 v31, 16, v71
  v_and_b32 v32, s77, v71
  v_add_f32 v42, v42, v31
  v_add_f32 v43, v43, v32
  s_waitcnt vmcnt(0)
  v_lshlrev_b32 v31, 16, v72
  v_and_b32 v32, s77, v72
  v_add_f32 v36, v36, v31
  v_add_f32 v37, v37, v32
  v_lshlrev_b32 v31, 16, v73
  v_and_b32 v32, s77, v73
  v_add_f32 v38, v38, v31
  v_add_f32 v39, v39, v32
  v_lshlrev_b32 v31, 16, v74
  v_and_b32 v32, s77, v74
  v_add_f32 v40, v40, v31
  v_add_f32 v41, v41, v32
  v_lshlrev_b32 v31, 16, v75
  v_and_b32 v32, s77, v75
  v_add_f32 v42, v42, v31
  v_add_f32 v43, v43, v32
  v_cvt_pk_bf16_f32 v44, v36, v37
  v_cvt_pk_bf16_f32 v45, v38, v39
  v_cvt_pk_bf16_f32 v46, v40, v41
  v_cvt_pk_bf16_f32 v47, v42, v43
  s_nop 0
  v_permlane16_swap_b32 v44, v46
  v_permlane16_swap_b32 v45, v47
  buffer_store_dwordx4 v[44:47], v29, s[84:87], 0 offen
L_nored_14:
  s_endpgm
L_end:
  s_endpgm
L_code_end:
.section .rodata,"a"
.p2align 6
.amdhsa_kernel concat_heads__gqa_block_cached__gqa_block_cached__near_ridge_kernel
  .amdhsa_next_free_vgpr 256
  .amdhsa_next_free_sgpr 102
  .amdhsa_accum_offset 256
  .amdhsa_group_segment_fixed_size 0
  .amdhsa_kernarg_size 104
  .amdhsa_user_sgpr_count 2
  .amdhsa_user_sgpr_kernarg_segment_ptr 1
  .amdhsa_system_sgpr_workgroup_id_x 1
  .amdhsa_float_denorm_mode_32 3
.end_amdhsa_kernel
```
